```python
import torch

def _softmax(x, axis=-1):
    return torch.softmax(x, dim=axis)
def _gelu(x):
    return torch.nn.functional.gelu(x, approximate="tanh")
def _silu(x):
    return torch.nn.functional.silu(x)
def _sigmoid(x):
    return torch.sigmoid(x)
def _layernorm(x, axis=-1, eps=1e-5):
    m = x.mean(dim=axis, keepdim=True)
    v = x.var(dim=axis, keepdim=True, unbiased=False)
    return (x - m) / torch.sqrt(v + eps)
def _scatter_add(tgt, idx, src, axis=0):
    return tgt.clone().index_add_(axis, idx, src)
def _segment_sum(src, seg, n):
    out = torch.zeros((n,) + src.shape[1:], dtype=src.dtype)
    return out.index_add_(0, seg, src)
def _pad(x, pw):
    flat = tuple(v for pair in reversed(pw) for v in pair)
    return torch.nn.functional.pad(x, flat)

kernel_name = 'standalone__deep_cross_xdeepfm__recsys'

def setup_inputs():

    _w = (lambda a: (lambda t: t.to(torch.bfloat16) if t.is_floating_point() else t)(torch.as_tensor(a)))
    B, F, D, L = 4096, 26, 32, 6
    V = min(100000, 100000)
    Din = F * D
    return {
        "idx": _w((lambda lo, hi, *s: torch.randint(lo, hi, s))(0, V, B, F).to(torch.int64)),
        "table": _w((lambda *s: torch.randn(*s, dtype=torch.bfloat16) * 0.8)(V, D)),
        "ws_cin": _w((lambda *s: torch.randn(*s, dtype=torch.bfloat16) * 0.2)(L, F, F, F) * (1.0 / F)),
        "w_cin_out": _w((lambda *s: torch.randn(*s, dtype=torch.bfloat16) * 0.2)(L * F) * ((L * F) ** -0.5)),
        "w_dnn1": _w((lambda *s: torch.randn(*s, dtype=torch.bfloat16) * 0.8)(Din, Din) * (Din ** -0.5)),
        "b_dnn1": _w((lambda *s: torch.randn(*s, dtype=torch.bfloat16) * 3.2)(Din) * 0.1),
        "w_dnn2": _w((lambda *s: torch.randn(*s, dtype=torch.bfloat16) * 0.2)(Din) * (Din ** -0.5)),
        "b_out": _w((lambda *s: torch.randn(*s, dtype=torch.bfloat16) * 0.2)(1)),
    }

def reference(idx, table, ws_cin, w_cin_out, w_dnn1, b_dnn1, w_dnn2, b_out):
    x0 = table[idx]
    B = x0.shape[0]
    L = ws_cin.shape[0]
    xk = x0
    pooled = []
    for l in range(L):
        xk = torch.einsum('bid,bjd,hij->bhd', xk, x0, ws_cin[l])
        pooled.append(xk.sum(axis=-1))
    p_plus = torch.stack(pooled, axis=1).reshape(B, -1)
    logit_cin = p_plus @ w_cin_out
    h = x0.reshape(B, -1)
    h = _gelu(h @ w_dnn1 + b_dnn1)
    logit_dnn = h @ w_dnn2
    return logit_cin + logit_dnn + b_out
```

```asm
; @launch grid=(256,1,1) block=(768,1,1) lds=163072
.amdgcn_target "amdgcn-amd-amdhsa--gfx950"
.text
.globl standalone__deep_cross_xdeepfm__recsys_kernel
.p2align 8
.type standalone__deep_cross_xdeepfm__recsys_kernel,@function
standalone__deep_cross_xdeepfm__recsys_kernel:
    s_cmp_ge_u32 s2, 256
    s_cbranch_scc1 L_end
    s_load_dwordx16 s[64:79], s[0:1], 0
    s_load_dwordx4 s[80:83], s[0:1], 64
    s_load_dwordx2 s[84:85], s[0:1], 80
    v_lshrrev_b32 v2, 6, v0
    v_and_b32 v1, 63, v0
    v_readfirstlane_b32 s3, v2
    s_getpc_b64 s[56:57]
    s_bfe_u32 s5, s2, 0x30003
    v_lshl_add_u32 v3, v0, 3, s5
    v_cmp_gt_u32 vcc, 362, v3
    v_lshlrev_b32 v3, 7, v3
    s_and_saveexec_b64 s[6:7], vcc
    s_cbranch_execz L_nocpf
    global_load_dword v165, v3, s[56:57]
L_nocpf:
    s_mov_b64 exec, s[6:7]
    v_mov_b32 v3, 0
    v_lshlrev_b32 v4, 2, v1
    v_add_u32 v4, 162720, v4
    v_cmp_gt_u32 vcc, 20, v0
    s_nop 0
    s_and_saveexec_b64 s[6:7], vcc
    ds_write_b32 v4, v3
    s_mov_b64 exec, s[6:7]
    s_and_b32 s6, s2, 7
    s_lshl_b32 s4, s6, 2
    s_lshr_b32 s7, s2, 6
    s_add_u32 s4, s4, s7
    s_lshl_b32 s62, s7, 3
    s_add_u32 s62, s62, s6
    s_bfe_u32 s5, s2, 0x30003
    s_waitcnt lgkmcnt(0)
    s_cmp_lg_u32 s3, 0
    s_cbranch_scc1 L_notouch
    v_mov_b32 v10, s66
    v_mov_b32 v11, s67
    v_min_u32 v12, 3, v1
    v_lshlrev_b32 v12, 21, v12
    v_add_co_u32 v10, vcc, v10, v12
    s_nop 1
    v_addc_co_u32 v11, vcc, 0, v11, vcc
    v_writelane_b32 v10, s64, 4
    v_writelane_b32 v11, s65, 4
    v_writelane_b32 v10, s68, 5
    v_writelane_b32 v11, s69, 5
    s_mov_b64 exec, 0x3f
    global_load_ushort v164, v[10:11], off
    s_mov_b64 exec, -1
L_notouch:
    s_barrier
    s_cmp_lt_u32 s3, 4
    s_cbranch_scc1 L_dh
    s_mov_b32 s12, s68
    s_mov_b32 s13, s69
    s_mov_b32 s14, 0x8950
    s_mov_b32 s15, 0x20000
    v_subrev_u32 v0, 256, v0
    v_lshlrev_b32 v24, 4, v1
    s_lshl_b32 s40, s3, 10
    s_add_u32 s41, s40, 4294963200
    s_add_u32 m0, s41, 85408
    s_nop 0
    buffer_load_dwordx4 v24, s[12:15], s41 offen lds
    s_add_u32 s41, s40, 4096
    s_add_u32 m0, s41, 85408
    s_nop 0
    buffer_load_dwordx4 v24, s[12:15], s41 offen lds
    s_add_u32 s41, s40, 12288
    s_add_u32 m0, s41, 85408
    s_nop 0
    buffer_load_dwordx4 v24, s[12:15], s41 offen lds
    s_add_u32 s41, s40, 20480
    s_add_u32 m0, s41, 85408
    s_nop 0
    buffer_load_dwordx4 v24, s[12:15], s41 offen lds
    s_add_u32 s41, s40, 28672
    s_min_u32 s41, s41, 35840
    s_add_u32 m0, s41, 85408
    s_nop 0
    buffer_load_dwordx4 v24, s[12:15], s41 offen lds
    v_mov_b32 v6, 162720
    v_mov_b32 v3, 1
    s_mov_b64 exec, 1
    ds_add_u32 v6, v3 offset:40
    s_mov_b64 exec, -1
    s_branch L_cin
L_dh:
    s_mov_b32 s16, s64
    s_mov_b32 s17, s65
    s_mov_b32 s18, 0x68000
    s_mov_b32 s19, 0x20000
    s_lshl_b32 s6, s4, 7
    s_lshl_b32 s7, s5, 4
    s_add_u32 s6, s6, s7
    s_lshl_b32 s7, s3, 1
    s_add_u32 s6, s6, s7
    s_mul_i32 s7, s6, 104
    v_and_b32 v2, 60, v1
    v_min_u32 v4, 12, v2
    buffer_load_dword v150, v2, s[16:19], s7 offen offset:0
    buffer_load_dword v151, v2, s[16:19], s7 offen offset:64
    buffer_load_dword v152, v2, s[16:19], s7 offen offset:128
    buffer_load_dword v153, v4, s[16:19], s7 offen offset:192
    buffer_load_dword v154, v2, s[16:19], s7 offen offset:832
    buffer_load_dword v155, v2, s[16:19], s7 offen offset:896
    buffer_load_dword v156, v2, s[16:19], s7 offen offset:960
    buffer_load_dword v157, v4, s[16:19], s7 offen offset:1024
    v_mov_b32 v28, 162720
    v_mov_b32 v29, 1
    s_cmp_lt_u32 s2, 6
    s_cbranch_scc1 L_jh
    s_mov_b32 s8, s66
    s_mov_b32 s9, s67
    s_mov_b32 s10, 0x61a800
    s_mov_b32 s11, 0x20000
    v_and_b32 v23, 3, v1
    v_lshlrev_b32 v23, 4, v23
    s_lshl_b32 s63, s3, 12
    s_mov_b32 s60, 1048576
L_w1:
    ds_read_b32 v2, v28 offset:40
    s_waitcnt lgkmcnt(0)
    v_readfirstlane_b32 s61, v2
    s_nop 0
    s_cmp_ge_u32 s61, 8
    s_cbranch_scc1 L_d2
    s_sub_u32 s60, s60, 1
    s_cbranch_scc1 L_d2
    s_sleep 1
    s_branch L_w1
L_d2:
    s_waitcnt vmcnt(0)
    v_lshl_add_u32 v150, v150, 6, v23
    s_add_u32 m0, s63, 123296
    s_nop 0
    buffer_load_dwordx4 v150, s[8:11], 0 offen nt lds
    v_lshl_add_u32 v151, v151, 6, v23
    s_add_u32 m0, s63, 124320
    s_nop 0
    buffer_load_dwordx4 v151, s[8:11], 0 offen nt lds
    v_lshl_add_u32 v152, v152, 6, v23
    s_add_u32 m0, s63, 125344
    s_nop 0
    buffer_load_dwordx4 v152, s[8:11], 0 offen nt lds
    v_lshl_add_u32 v153, v153, 6, v23
    s_add_u32 m0, s63, 126368
    s_nop 0
    buffer_load_dwordx4 v153, s[8:11], 0 offen nt lds
    s_cmp_lg_u32 s5, 0
    s_cbranch_scc1 L_dnn_go
    s_branch L_dnn
L_jh:
    s_cmp_ge_u32 s2, 4
    s_cbranch_scc1 L_jaf
    s_mov_b32 s8, s68
    s_mov_b32 s9, s69
    s_mov_b32 s10, 0x112a0
    s_mov_b32 s11, 0x20000
    v_lshlrev_b32 v20, 4, v0
    s_mov_b32 s20, 35152
    buffer_load_dwordx4 v[32:35], v20, s[8:11], s20 offen
    s_mov_b32 s20, 39248
    buffer_load_dwordx4 v[36:39], v20, s[8:11], s20 offen
    s_mov_b32 s20, 43344
    buffer_load_dwordx4 v[40:43], v20, s[8:11], s20 offen
    s_mov_b32 s20, 47440
    buffer_load_dwordx4 v[44:47], v20, s[8:11], s20 offen
    s_mov_b32 s20, 51536
    buffer_load_dwordx4 v[48:51], v20, s[8:11], s20 offen
    s_mov_b32 s20, 55632
    buffer_load_dwordx4 v[52:55], v20, s[8:11], s20 offen
    s_mov_b32 s20, 59728
    buffer_load_dwordx4 v[56:59], v20, s[8:11], s20 offen
    s_mov_b32 s20, 63824
    buffer_load_dwordx4 v[60:63], v20, s[8:11], s20 offen
    s_mov_b32 s20, 67920
    buffer_load_dwordx4 v[64:67], v20, s[8:11], s20 offen
    s_branch L_dnn
L_jaf:
    s_mov_b32 s8, s68
    s_mov_b32 s9, s69
    s_mov_b32 s10, 0x337e0
    s_mov_b32 s11, 0x20000
    s_mul_i32 s16, s2, 35152
    s_sub_u32 s16, s16, 71328
    v_lshlrev_b32 v20, 4, v1
    s_lshl_b32 s17, s3, 10
    s_add_u32 s17, s17, 1024
L_jah:
    s_mov_b32 m0, s17
    s_add_u32 s18, s17, s16
    buffer_load_dwordx4 v20, s[8:11], s18 offen lds
    s_add_u32 s17, s17, 4096
    s_cmp_lt_u32 s17, 37888
    s_cbranch_scc1 L_jah
    s_branch L_dnn
L_cin:
    s_sub_u32 s35, s3, 4
    s_mov_b32 s20, s70
    s_mov_b32 s21, s71
    s_mov_b32 s22, 0x138
    s_mov_b32 s23, 0x20000
    v_mov_b32 v9, 0x7ffffff0
    v_and_b32 v14, 15, v0
    v_bfe_u32 v15, v0, 4, 3
    v_mad_u32_u24 v15, v15, 13, v14
    v_lshlrev_b32 v15, 1, v15
    v_cmp_gt_u32 vcc, 13, v14
    s_nop 1
    v_cndmask_b32 v49, v9, v15, vcc
    v_mov_b32 v50, 0
    s_lshl_b32 s6, s4, 7
    s_lshl_b32 s7, s5, 4
    s_add_u32 s6, s6, s7
    s_lshl_b32 s7, s35, 1
    s_add_u32 s36, s6, s7
    s_lshl_b32 s37, s35, 12
    s_add_u32 s37, s37, 123296
    v_and_b32 v25, 3, v1
    v_lshlrev_b32 v25, 4, v25
    v_and_b32 v14, 15, v1
    v_bfe_u32 v12, v1, 4, 1
    v_lshrrev_b32 v15, 5, v1
    v_cmp_gt_u32 s[50:51], 13, v14
    v_min_u32 v13, 12, v14
    v_mad_u32_u24 v13, v15, 13, v13
    v_mul_u32_u24 v13, 1352, v13
    v_lshrrev_b32 v10, 1, v14
    v_xor_b32 v10, v10, v14
    v_bfe_u32 v10, v10, 2, 1
    v_xor_b32 v10, v10, v15
    v_mad_u32_u24 v10, v10, 14, v14
    v_cndmask_b32 v10, 13, v10, s[50:51]
    v_mad_u32_u24 v10, v12, 27, v10
    v_add_u32 v13, 85408, v13
    v_add_u32 v11, 512, v13
    v_mul_u32_u24 v14, 0x0202, v12
    v_lshlrev_b32 v14, 16, v14
    v_add_u32 v20, 0x01000c0c, v14
    v_sub_u32 v21, 0x03020c0c, v14
    v_lshlrev_b32 v14, 1, v14
    v_add_u32 v22, 0x01000c0c, v14
    v_sub_u32 v23, 0x07060c0c, v14
    v_lshlrev_b32 v19, 4, v0
    v_add_u32 v19, 85408, v19
    v_lshlrev_b32 v18, 2, v0
    v_add_u32 v18, 160160, v18
    v_mov_b32 v0, 1
    v_bfe_u32 v15, v1, 2, 2
    v_lshlrev_b32 v15, 6, v15
    v_bfe_u32 v16, v1, 4, 1
    v_lshl_add_u32 v15, v16, 5, v15
    v_lshrrev_b32 v16, 1, v25
    v_add3_u32 v17, v15, v16, s37
    v_and_b32 v14, 3, v1
    v_bfe_u32 v15, v1, 3, 2
    v_lshl_add_u32 v14, v15, 2, v14
    v_lshrrev_b32 v16, 1, v15
    v_xor_b32 v15, v15, v16
    v_lshrrev_b32 v16, 2, v1
    v_xor_b32 v15, v15, v16
    v_and_b32 v15, 1, v15
    v_mad_u32_u24 v15, v15, 14, v14
    v_cmp_gt_u32 vcc, 13, v14
    s_nop 1
    v_cndmask_b32 v15, 13, v15, vcc
    v_lshrrev_b32 v3, 5, v1
    v_mad_u32_u24 v15, v3, 27, v15
    v_lshlrev_b32 v4, 4, v15
    v_add_u32 v4, 65536, v4
    v_lshlrev_b32 v5, 6, v3
    v_add_u32 v5, 161184, v5
    v_lshlrev_b32 v2, 4, v3
    v_cmp_ne_u32 s[38:39], 0, v3
    s_and_b32 s40, s35, 3
    s_mul_i32 s40, s40, 864
    s_add_u32 s40, s40, 65536
    v_mov_b32 v48, v18
    s_waitcnt vmcnt(0)
    s_mov_b64 exec, 1
    ds_add_u32 v6, v0 offset:0
    s_mov_b64 exec, -1
    s_cmp_lg_u32 s3, 4
    s_cbranch_scc1 L_t23
    v_mov_b32 v140, 0
    v_mov_b32 v141, 0
    v_writelane_b32 v140, s72, 0
    v_writelane_b32 v141, s73, 0
    v_writelane_b32 v140, s74, 1
    v_writelane_b32 v141, s75, 1
    v_writelane_b32 v140, s76, 2
    v_writelane_b32 v141, s77, 2
    v_writelane_b32 v140, s70, 3
    v_writelane_b32 v141, s71, 3
    s_add_u32 s6, s82, 0x80
    s_addc_u32 s7, s83, 0
    v_writelane_b32 v140, s6, 4
    v_writelane_b32 v141, s7, 4
    s_add_u32 s6, s84, 0x3f000
    s_addc_u32 s7, s85, 0
    v_writelane_b32 v140, s6, 5
    v_writelane_b32 v141, s7, 5
    v_writelane_b32 v140, s78, 6
    v_writelane_b32 v141, s79, 6
    s_mov_b64 exec, 0x7f
    global_load_ushort v142, v[140:141], off
    s_mov_b64 exec, -1
L_t23:
    v_lshl_add_u32 v18, v10, 4, s40
    s_mov_b32 s60, 1048576
L_w4:
    ds_read_b32 v7, v6 offset:0
    s_waitcnt lgkmcnt(0)
    v_readfirstlane_b32 s61, v7
    s_nop 0
    s_cmp_ge_u32 s61, 8
    s_cbranch_scc1 L_d5
    s_sub_u32 s60, s60, 1
    s_cbranch_scc1 L_d5
    s_branch L_w4
L_d5:
    s_cmp_ge_u32 s35, 4
    s_cbranch_scc1 L_g0
    s_setprio 2
    ds_read_b128 v[96:99], v19 offset:0
    ds_read_b128 v[100:103], v19 offset:4096
    ds_read_b128 v[104:107], v19 offset:8192
    ds_read_b128 v[108:111], v19 offset:12288
    ds_read_b128 v[112:115], v19 offset:16384
    ds_read_b128 v[116:119], v19 offset:20480
    ds_read_b128 v[120:123], v19 offset:24576
    ds_read_b128 v[124:127], v19 offset:28672
    ds_read_b128 v[128:131], v19 offset:32768
    s_waitcnt lgkmcnt(0)
    v_and_b32 v96, 0x7fff7fff, v96
    v_and_b32 v97, 0x7fff7fff, v97
    v_and_b32 v98, 0x7fff7fff, v98
    v_and_b32 v99, 0x7fff7fff, v99
    v_and_b32 v100, 0x7fff7fff, v100
    v_and_b32 v101, 0x7fff7fff, v101
    v_and_b32 v102, 0x7fff7fff, v102
    v_and_b32 v103, 0x7fff7fff, v103
    v_and_b32 v104, 0x7fff7fff, v104
    v_and_b32 v105, 0x7fff7fff, v105
    v_and_b32 v106, 0x7fff7fff, v106
    v_and_b32 v107, 0x7fff7fff, v107
    v_and_b32 v108, 0x7fff7fff, v108
    v_and_b32 v109, 0x7fff7fff, v109
    v_and_b32 v110, 0x7fff7fff, v110
    v_and_b32 v111, 0x7fff7fff, v111
    v_and_b32 v112, 0x7fff7fff, v112
    v_and_b32 v113, 0x7fff7fff, v113
    v_and_b32 v114, 0x7fff7fff, v114
    v_and_b32 v115, 0x7fff7fff, v115
    v_and_b32 v116, 0x7fff7fff, v116
    v_and_b32 v117, 0x7fff7fff, v117
    v_and_b32 v118, 0x7fff7fff, v118
    v_and_b32 v119, 0x7fff7fff, v119
    v_and_b32 v120, 0x7fff7fff, v120
    v_and_b32 v121, 0x7fff7fff, v121
    v_and_b32 v122, 0x7fff7fff, v122
    v_and_b32 v123, 0x7fff7fff, v123
    v_and_b32 v124, 0x7fff7fff, v124
    v_and_b32 v125, 0x7fff7fff, v125
    v_and_b32 v126, 0x7fff7fff, v126
    v_and_b32 v127, 0x7fff7fff, v127
    v_and_b32 v128, 0x7fff7fff, v128
    v_and_b32 v129, 0x7fff7fff, v129
    v_and_b32 v130, 0x7fff7fff, v130
    v_and_b32 v131, 0x7fff7fff, v131
    v_pk_max_u16 v14, v96, v97
    v_pk_maximum3_f16 v14, v14, v98, v99
    v_pk_maximum3_f16 v14, v14, v100, v101
    v_pk_maximum3_f16 v14, v14, v102, v103
    v_pk_maximum3_f16 v14, v14, v104, v105
    v_pk_maximum3_f16 v14, v14, v106, v107
    v_pk_maximum3_f16 v14, v14, v108, v109
    v_pk_maximum3_f16 v14, v14, v110, v111
    v_pk_maximum3_f16 v14, v14, v112, v113
    v_pk_maximum3_f16 v14, v14, v114, v115
    v_pk_maximum3_f16 v14, v14, v116, v117
    v_pk_maximum3_f16 v14, v14, v118, v119
    v_pk_maximum3_f16 v14, v14, v120, v121
    v_pk_maximum3_f16 v14, v14, v122, v123
    v_pk_maximum3_f16 v14, v14, v124, v125
    v_pk_maximum3_f16 v14, v14, v126, v127
    v_pk_maximum3_f16 v14, v14, v128, v129
    v_pk_maximum3_f16 v14, v14, v130, v131
    v_lshrrev_b32 v15, 16, v14
    v_and_b32 v14, 0xffff, v14
    v_max_u32 v14, v14, v15
    s_nop 1
    v_max_u32_dpp v14, v14, v14 row_shr:1 row_mask:0xf bank_mask:0xf
    s_nop 1
    v_max_u32_dpp v14, v14, v14 row_shr:2 row_mask:0xf bank_mask:0xf
    s_nop 1
    v_max_u32_dpp v14, v14, v14 row_shr:4 row_mask:0xf bank_mask:0xf
    s_nop 1
    v_max_u32_dpp v14, v14, v14 row_shr:8 row_mask:0xf bank_mask:0xf
    s_nop 1
    v_max_u32_dpp v14, v14, v14 row_bcast:15 row_mask:0xa bank_mask:0xf
    s_nop 1
    v_max_u32_dpp v14, v14, v14 row_bcast:31 row_mask:0xc bank_mask:0xf
    s_nop 0
    v_readlane_b32 s6, v14, 63
    s_lshl_b32 s7, s35, 2
    v_add_u32 v15, s7, v6
    v_mov_b32 v14, s6
    ds_write_b32 v15, v14 offset:80
    s_waitcnt lgkmcnt(0)
    s_mov_b64 exec, 1
    ds_add_u32 v6, v0 offset:64
    s_mov_b64 exec, -1
    s_setprio 0
    s_branch L_lox
L_g0:
    s_cmp_lg_u32 s35, 4
    s_cbranch_scc1 L_g1
    ds_read2_b32 v[52:53], v13 offset0:0 offset1:13
    ds_read2_b32 v[54:55], v13 offset0:0 offset1:13
    ds_read2_b32 v[56:57], v13 offset0:27 offset1:40
    ds_read2_b32 v[58:59], v13 offset0:27 offset1:40
    ds_read2_b32 v[60:61], v13 offset0:54 offset1:67
    ds_read2_b32 v[62:63], v13 offset0:54 offset1:67
    ds_read2_b32 v[64:65], v13 offset0:81 offset1:94
    ds_read2_b32 v[66:67], v13 offset0:81 offset1:94
    ds_read2_b32 v[68:69], v13 offset0:82 offset1:95
    ds_read2_b32 v[70:71], v13 offset0:107 offset1:120
    ds_read2_b32 v[72:73], v13 offset0:109 offset1:122
    ds_read2_b32 v[74:75], v11 offset0:6 offset1:19
    ds_read2_b32 v[76:77], v11 offset0:8 offset1:21
    ds_read2_b32 v[78:79], v11 offset0:33 offset1:46
    ds_read2_b32 v[80:81], v11 offset0:35 offset1:48
    ds_read2_b32 v[82:83], v11 offset0:60 offset1:73
    ds_read2_b32 v[84:85], v11 offset0:36 offset1:49
    ds_read2_b32 v[86:87], v11 offset0:86 offset1:99
    ds_read2_b32 v[88:89], v11 offset0:63 offset1:76
    ds_read2_b32 v[90:91], v11 offset0:113 offset1:126
    ds_read2_b32 v[92:93], v11 offset0:90 offset1:103
    ds_read2_b32 v[94:95], v11 offset0:140 offset1:153
    ds_read2_b32 v[96:97], v11 offset0:117 offset1:130
    ds_read2_b32 v[98:99], v11 offset0:167 offset1:180
    ds_read2_b32 v[100:101], v11 offset0:118 offset1:131
    ds_read2_b32 v[102:103], v11 offset0:193 offset1:206
    ds_read2_b32 v[104:105], v11 offset0:132 offset1:145
    ds_read2_b32 v[106:107], v13 offset0:10 offset1:23
    ds_read2_b32 v[108:109], v11 offset0:159 offset1:172
    ds_read2_b32 v[110:111], v13 offset0:37 offset1:50
    ds_read2_b32 v[112:113], v11 offset0:186 offset1:199
    ds_read2_b32 v[114:115], v13 offset0:64 offset1:77
    ds_read2_b32 v[116:117], v11 offset0:187 offset1:200
    ds_read2_b32 v[118:119], v13 offset0:90 offset1:103
    ds_read2_b32 v[120:121], v13 offset0:5 offset1:18
    ds_read2_b32 v[122:123], v11 offset0:2 offset1:15
    ds_read2_b32 v[124:125], v13 offset0:32 offset1:45
    ds_read2_b32 v[126:127], v11 offset0:29 offset1:42
    ds_read2_b32 v[128:129], v13 offset0:59 offset1:72
    ds_read2_b32 v[130:131], v11 offset0:56 offset1:69
    ds_read2_b32 v[132:133], v13 offset0:60 offset1:73
    ds_read2_b32 v[134:135], v11 offset0:82 offset1:95
    ds_read2_b32 v[136:137], v13 offset0:87 offset1:100
    ds_read2_b32 v[138:139], v11 offset0:109 offset1:122
    ds_read2_b32 v[140:141], v13 offset0:114 offset1:127
    ds_read2_b32 v[142:143], v11 offset0:136 offset1:149
    ds_read2_b32 v[144:145], v11 offset0:13 offset1:26
    ds_read2_b32 v[146:147], v11 offset0:163 offset1:176
    s_branch L_gd
L_g1:
    s_cmp_lg_u32 s35, 5
    s_cbranch_scc1 L_g2
    ds_read2_b32 v[52:53], v13 offset0:108 offset1:121
    ds_read2_b32 v[54:55], v13 offset0:108 offset1:121
    ds_read2_b32 v[56:57], v11 offset0:7 offset1:20
    ds_read2_b32 v[58:59], v11 offset0:7 offset1:20
    ds_read2_b32 v[60:61], v11 offset0:34 offset1:47
    ds_read2_b32 v[62:63], v11 offset0:34 offset1:47
    ds_read2_b32 v[64:65], v11 offset0:61 offset1:74
    ds_read2_b32 v[66:67], v11 offset0:61 offset1:74
    ds_read2_b32 v[68:69], v11 offset0:62 offset1:75
    ds_read2_b32 v[70:71], v11 offset0:87 offset1:100
    ds_read2_b32 v[72:73], v11 offset0:89 offset1:102
    ds_read2_b32 v[74:75], v11 offset0:114 offset1:127
    ds_read2_b32 v[76:77], v11 offset0:116 offset1:129
    ds_read2_b32 v[78:79], v11 offset0:141 offset1:154
    ds_read2_b32 v[80:81], v11 offset0:143 offset1:156
    ds_read2_b32 v[82:83], v11 offset0:168 offset1:181
    ds_read2_b32 v[84:85], v11 offset0:144 offset1:157
    ds_read2_b32 v[86:87], v11 offset0:194 offset1:207
    ds_read2_b32 v[88:89], v11 offset0:158 offset1:171
    ds_read2_b32 v[90:91], v13 offset0:11 offset1:24
    ds_read2_b32 v[92:93], v11 offset0:185 offset1:198
    ds_read2_b32 v[94:95], v13 offset0:38 offset1:51
    ds_read2_b32 v[96:97], v13 offset0:3 offset1:16
    ds_read2_b32 v[98:99], v13 offset0:78 offset1:91
    ds_read2_b32 v[100:101], v13 offset0:4 offset1:17
    ds_read2_b32 v[102:103], v13 offset0:104 offset1:117
    ds_read2_b32 v[104:105], v13 offset0:31 offset1:44
    ds_read2_b32 v[106:107], v11 offset0:3 offset1:16
    ds_read2_b32 v[108:109], v13 offset0:58 offset1:71
    ds_read2_b32 v[110:111], v11 offset0:30 offset1:43
    ds_read2_b32 v[112:113], v13 offset0:85 offset1:98
    ds_read2_b32 v[114:115], v11 offset0:57 offset1:70
    ds_read2_b32 v[116:117], v13 offset0:86 offset1:99
    ds_read2_b32 v[118:119], v11 offset0:83 offset1:96
    ds_read2_b32 v[120:121], v13 offset0:113 offset1:126
    ds_read2_b32 v[122:123], v11 offset0:110 offset1:123
    ds_read2_b32 v[124:125], v11 offset0:12 offset1:25
    ds_read2_b32 v[126:127], v11 offset0:137 offset1:150
    ds_read2_b32 v[128:129], v11 offset0:39 offset1:52
    ds_read2_b32 v[130:131], v11 offset0:164 offset1:177
    ds_read2_b32 v[132:133], v11 offset0:40 offset1:53
    ds_read2_b32 v[134:135], v11 offset0:190 offset1:203
    ds_read2_b32 v[136:137], v11 offset0:54 offset1:67
    ds_read2_b32 v[138:139], v13 offset0:7 offset1:20
    ds_read2_b32 v[140:141], v11 offset0:81 offset1:94
    ds_read2_b32 v[142:143], v13 offset0:34 offset1:47
    ds_read2_b32 v[144:145], v11 offset0:108 offset1:121
    ds_read2_b32 v[146:147], v13 offset0:61 offset1:74
    s_branch L_gd
L_g2:
    s_cmp_lg_u32 s35, 6
    s_cbranch_scc1 L_g3
    ds_read2_b32 v[52:53], v11 offset0:88 offset1:101
    ds_read2_b32 v[54:55], v11 offset0:88 offset1:101
    ds_read2_b32 v[56:57], v11 offset0:115 offset1:128
    ds_read2_b32 v[58:59], v11 offset0:115 offset1:128
    ds_read2_b32 v[60:61], v11 offset0:142 offset1:155
    ds_read2_b32 v[62:63], v11 offset0:142 offset1:155
    ds_read2_b32 v[64:65], v11 offset0:169 offset1:182
    ds_read2_b32 v[66:67], v11 offset0:169 offset1:182
    ds_read2_b32 v[68:69], v11 offset0:170 offset1:183
    ds_read2_b32 v[70:71], v11 offset0:195 offset1:208
    ds_read2_b32 v[72:73], v11 offset0:184 offset1:197
    ds_read2_b32 v[74:75], v13 offset0:12 offset1:25
    ds_read2_b32 v[76:77], v13 offset0:2 offset1:15
    ds_read2_b32 v[78:79], v13 offset0:52 offset1:65
    ds_read2_b32 v[80:81], v13 offset0:29 offset1:42
    ds_read2_b32 v[82:83], v13 offset0:79 offset1:92
    ds_read2_b32 v[84:85], v13 offset0:30 offset1:43
    ds_read2_b32 v[86:87], v13 offset0:105 offset1:118
    ds_read2_b32 v[88:89], v13 offset0:57 offset1:70
    ds_read2_b32 v[90:91], v11 offset0:4 offset1:17
    ds_read2_b32 v[92:93], v13 offset0:84 offset1:97
    ds_read2_b32 v[94:95], v11 offset0:31 offset1:44
    ds_read2_b32 v[96:97], v13 offset0:111 offset1:124
    ds_read2_b32 v[98:99], v11 offset0:58 offset1:71
    ds_read2_b32 v[100:101], v13 offset0:112 offset1:125
    ds_read2_b32 v[102:103], v11 offset0:84 offset1:97
    ds_read2_b32 v[104:105], v11 offset0:11 offset1:24
    ds_read2_b32 v[106:107], v11 offset0:111 offset1:124
    ds_read2_b32 v[108:109], v11 offset0:38 offset1:51
    ds_read2_b32 v[110:111], v11 offset0:138 offset1:151
    ds_read2_b32 v[112:113], v11 offset0:65 offset1:78
    ds_read2_b32 v[114:115], v11 offset0:165 offset1:178
    ds_read2_b32 v[116:117], v11 offset0:66 offset1:79
    ds_read2_b32 v[118:119], v11 offset0:191 offset1:204
    ds_read2_b32 v[120:121], v11 offset0:80 offset1:93
    ds_read2_b32 v[122:123], v13 offset0:8 offset1:21
    ds_read2_b32 v[124:125], v11 offset0:107 offset1:120
    ds_read2_b32 v[126:127], v13 offset0:35 offset1:48
    ds_read2_b32 v[128:129], v11 offset0:134 offset1:147
    ds_read2_b32 v[130:131], v13 offset0:62 offset1:75
    ds_read2_b32 v[132:133], v11 offset0:135 offset1:148
    ds_read2_b32 v[134:135], v13 offset0:88 offset1:101
    ds_read2_b32 v[136:137], v11 offset0:162 offset1:175
    ds_read2_b32 v[138:139], v13 offset0:115 offset1:128
    ds_read2_b32 v[140:141], v11 offset0:189 offset1:202
    ds_read2_b32 v[142:143], v11 offset0:14 offset1:27
    ds_read2_b32 v[144:145], v11 offset0:189 offset1:202
    ds_read2_b32 v[146:147], v11 offset0:14 offset1:27
    s_branch L_gd
L_g3:
    ds_read2_b32 v[52:53], v11 offset0:196 offset1:209
    ds_read2_b32 v[54:55], v11 offset0:196 offset1:209
    ds_read2_b32 v[56:57], v13 offset0:1 offset1:14
    ds_read2_b32 v[58:59], v13 offset0:26 offset1:39
    ds_read2_b32 v[60:61], v13 offset0:28 offset1:41
    ds_read2_b32 v[62:63], v13 offset0:53 offset1:66
    ds_read2_b32 v[64:65], v13 offset0:55 offset1:68
    ds_read2_b32 v[66:67], v13 offset0:80 offset1:93
    ds_read2_b32 v[68:69], v13 offset0:56 offset1:69
    ds_read2_b32 v[70:71], v13 offset0:106 offset1:119
    ds_read2_b32 v[72:73], v13 offset0:83 offset1:96
    ds_read2_b32 v[74:75], v11 offset0:5 offset1:18
    ds_read2_b32 v[76:77], v13 offset0:110 offset1:123
    ds_read2_b32 v[78:79], v11 offset0:32 offset1:45
    ds_read2_b32 v[80:81], v11 offset0:9 offset1:22
    ds_read2_b32 v[82:83], v11 offset0:59 offset1:72
    ds_read2_b32 v[84:85], v11 offset0:10 offset1:23
    ds_read2_b32 v[86:87], v11 offset0:85 offset1:98
    ds_read2_b32 v[88:89], v11 offset0:37 offset1:50
    ds_read2_b32 v[90:91], v11 offset0:112 offset1:125
    ds_read2_b32 v[92:93], v11 offset0:64 offset1:77
    ds_read2_b32 v[94:95], v11 offset0:139 offset1:152
    ds_read2_b32 v[96:97], v11 offset0:91 offset1:104
    ds_read2_b32 v[98:99], v11 offset0:166 offset1:179
    ds_read2_b32 v[100:101], v11 offset0:92 offset1:105
    ds_read2_b32 v[102:103], v11 offset0:192 offset1:205
    ds_read2_b32 v[104:105], v11 offset0:106 offset1:119
    ds_read2_b32 v[106:107], v13 offset0:9 offset1:22
    ds_read2_b32 v[108:109], v11 offset0:133 offset1:146
    ds_read2_b32 v[110:111], v13 offset0:36 offset1:49
    ds_read2_b32 v[112:113], v11 offset0:160 offset1:173
    ds_read2_b32 v[114:115], v13 offset0:63 offset1:76
    ds_read2_b32 v[116:117], v11 offset0:161 offset1:174
    ds_read2_b32 v[118:119], v13 offset0:89 offset1:102
    ds_read2_b32 v[120:121], v11 offset0:188 offset1:201
    ds_read2_b32 v[122:123], v13 offset0:116 offset1:129
    ds_read2_b32 v[124:125], v13 offset0:6 offset1:19
    ds_read2_b32 v[126:127], v11 offset0:28 offset1:41
    ds_read2_b32 v[128:129], v13 offset0:33 offset1:46
    ds_read2_b32 v[130:131], v11 offset0:55 offset1:68
    ds_read2_b32 v[132:133], v11 offset0:189 offset1:202
    ds_read2_b32 v[134:135], v11 offset0:14 offset1:27
    ds_read2_b32 v[136:137], v11 offset0:189 offset1:202
    ds_read2_b32 v[138:139], v11 offset0:14 offset1:27
    ds_read2_b32 v[140:141], v11 offset0:189 offset1:202
    ds_read2_b32 v[142:143], v11 offset0:14 offset1:27
    ds_read2_b32 v[144:145], v11 offset0:189 offset1:202
    ds_read2_b32 v[146:147], v11 offset0:14 offset1:27
L_gd:
    s_setprio 1
    s_waitcnt lgkmcnt(8)
    v_perm_b32 v14, v55, v54, v22
    v_perm_b32 v15, v55, v54, v23
    v_perm_b32 v52, v52, v52, v20
    v_perm_b32 v53, v53, v53, v21
    v_add_f32 v52, v52, v14
    v_add_f32 v53, v53, v15
    v_perm_b32 v14, v59, v58, v22
    v_perm_b32 v15, v59, v58, v23
    v_perm_b32 v56, v56, v56, v20
    v_perm_b32 v57, v57, v57, v21
    v_add_f32 v56, v56, v14
    v_add_f32 v57, v57, v15
    v_perm_b32 v14, v63, v62, v22
    v_perm_b32 v15, v63, v62, v23
    v_perm_b32 v60, v60, v60, v20
    v_perm_b32 v61, v61, v61, v21
    v_add_f32 v60, v60, v14
    v_add_f32 v61, v61, v15
    v_perm_b32 v14, v67, v66, v22
    v_perm_b32 v15, v67, v66, v23
    v_perm_b32 v64, v64, v64, v20
    v_perm_b32 v65, v65, v65, v21
    v_add_f32 v64, v64, v14
    v_add_f32 v65, v65, v15
    v_perm_b32 v14, v71, v70, v22
    v_perm_b32 v15, v71, v70, v23
    v_perm_b32 v68, v68, v68, v20
    v_perm_b32 v69, v69, v69, v21
    v_add_f32 v68, v68, v14
    v_add_f32 v69, v69, v15
    v_perm_b32 v14, v75, v74, v22
    v_perm_b32 v15, v75, v74, v23
    v_perm_b32 v72, v72, v72, v20
    v_perm_b32 v73, v73, v73, v21
    v_add_f32 v72, v72, v14
    v_add_f32 v73, v73, v15
    v_perm_b32 v14, v79, v78, v22
    v_perm_b32 v15, v79, v78, v23
    v_perm_b32 v76, v76, v76, v20
    v_perm_b32 v77, v77, v77, v21
    v_add_f32 v76, v76, v14
    v_add_f32 v77, v77, v15
    v_perm_b32 v14, v83, v82, v22
    v_perm_b32 v15, v83, v82, v23
    v_perm_b32 v80, v80, v80, v20
    v_perm_b32 v81, v81, v81, v21
    v_add_f32 v80, v80, v14
    v_add_f32 v81, v81, v15
    v_perm_b32 v14, v87, v86, v22
    v_perm_b32 v15, v87, v86, v23
    v_perm_b32 v84, v84, v84, v20
    v_perm_b32 v85, v85, v85, v21
    v_add_f32 v84, v84, v14
    v_add_f32 v85, v85, v15
    v_perm_b32 v14, v91, v90, v22
    v_perm_b32 v15, v91, v90, v23
    v_perm_b32 v88, v88, v88, v20
    v_perm_b32 v89, v89, v89, v21
    v_add_f32 v88, v88, v14
    v_add_f32 v89, v89, v15
    v_perm_b32 v14, v95, v94, v22
    v_perm_b32 v15, v95, v94, v23
    v_perm_b32 v92, v92, v92, v20
    v_perm_b32 v93, v93, v93, v21
    v_add_f32 v92, v92, v14
    v_add_f32 v93, v93, v15
    v_perm_b32 v14, v99, v98, v22
    v_perm_b32 v15, v99, v98, v23
    v_perm_b32 v96, v96, v96, v20
    v_perm_b32 v97, v97, v97, v21
    v_add_f32 v96, v96, v14
    v_add_f32 v97, v97, v15
    v_perm_b32 v14, v103, v102, v22
    v_perm_b32 v15, v103, v102, v23
    v_perm_b32 v100, v100, v100, v20
    v_perm_b32 v101, v101, v101, v21
    v_add_f32 v100, v100, v14
    v_add_f32 v101, v101, v15
    v_perm_b32 v14, v107, v106, v22
    v_perm_b32 v15, v107, v106, v23
    v_perm_b32 v104, v104, v104, v20
    v_perm_b32 v105, v105, v105, v21
    v_add_f32 v104, v104, v14
    v_add_f32 v105, v105, v15
    v_perm_b32 v14, v111, v110, v22
    v_perm_b32 v15, v111, v110, v23
    v_perm_b32 v108, v108, v108, v20
    v_perm_b32 v109, v109, v109, v21
    v_add_f32 v108, v108, v14
    v_add_f32 v109, v109, v15
    v_perm_b32 v14, v115, v114, v22
    v_perm_b32 v15, v115, v114, v23
    v_perm_b32 v112, v112, v112, v20
    v_perm_b32 v113, v113, v113, v21
    v_add_f32 v112, v112, v14
    v_add_f32 v113, v113, v15
    v_perm_b32 v14, v119, v118, v22
    v_perm_b32 v15, v119, v118, v23
    v_perm_b32 v116, v116, v116, v20
    v_perm_b32 v117, v117, v117, v21
    v_add_f32 v116, v116, v14
    v_add_f32 v117, v117, v15
    v_perm_b32 v14, v123, v122, v22
    v_perm_b32 v15, v123, v122, v23
    v_perm_b32 v120, v120, v120, v20
    v_perm_b32 v121, v121, v121, v21
    v_add_f32 v120, v120, v14
    v_add_f32 v121, v121, v15
    v_perm_b32 v14, v127, v126, v22
    v_perm_b32 v15, v127, v126, v23
    v_perm_b32 v124, v124, v124, v20
    v_perm_b32 v125, v125, v125, v21
    v_add_f32 v124, v124, v14
    v_add_f32 v125, v125, v15
    v_perm_b32 v14, v131, v130, v22
    v_perm_b32 v15, v131, v130, v23
    v_perm_b32 v128, v128, v128, v20
    v_perm_b32 v129, v129, v129, v21
    v_add_f32 v128, v128, v14
    v_add_f32 v129, v129, v15
    s_waitcnt lgkmcnt(0)
    v_perm_b32 v14, v135, v134, v22
    v_perm_b32 v15, v135, v134, v23
    v_perm_b32 v132, v132, v132, v20
    v_perm_b32 v133, v133, v133, v21
    v_add_f32 v132, v132, v14
    v_add_f32 v133, v133, v15
    v_perm_b32 v14, v139, v138, v22
    v_perm_b32 v15, v139, v138, v23
    v_perm_b32 v136, v136, v136, v20
    v_perm_b32 v137, v137, v137, v21
    v_add_f32 v136, v136, v14
    v_add_f32 v137, v137, v15
    v_perm_b32 v14, v143, v142, v22
    v_perm_b32 v15, v143, v142, v23
    v_perm_b32 v140, v140, v140, v20
    v_perm_b32 v141, v141, v141, v21
    v_add_f32 v140, v140, v14
    v_add_f32 v141, v141, v15
    v_perm_b32 v14, v147, v146, v22
    v_perm_b32 v15, v147, v146, v23
    v_perm_b32 v144, v144, v144, v20
    v_perm_b32 v145, v145, v145, v21
    v_add_f32 v144, v144, v14
    v_add_f32 v145, v145, v15
    s_mov_b32 s60, 1048576
L_w6:
    ds_read_b32 v7, v6 offset:64
    s_waitcnt lgkmcnt(0)
    v_readfirstlane_b32 s61, v7
    s_nop 0
    s_cmp_ge_u32 s61, 4
    s_cbranch_scc1 L_d7
    s_sub_u32 s60, s60, 1
    s_cbranch_scc1 L_d7
    s_branch L_w6
L_d7:
    ds_read_b128 v[24:27], v6 offset:80
    s_waitcnt lgkmcnt(0)
    v_max3_u32 v24, v24, v25, v26
    v_max_u32 v24, v24, v27
    s_nop 0
    v_readfirstlane_b32 s44, v24
    s_nop 0
    s_add_u32 s44, s44, 0x80
    s_lshr_b32 s44, s44, 7
    s_sub_i32 s44, 134, s44
    s_min_i32 s44, s44, 126
    s_max_i32 s44, s44, -120
    s_add_i32 s54, s44, 127
    s_lshl_b32 s54, s54, 23
    v_mov_b32 v32, s54
    v_cndmask_b32 v32, 0, v32, s[50:51]
    s_lshl_b32 s41, s35, 2
    s_cmp_lt_u32 s41, 29
    s_cselect_b32 s40, 0.5, 1.0
    v_mul_f32 v33, s40, v32
    s_cmp_lt_u32 s41, 28
    s_cselect_b32 s40, 0.5, 1.0
    v_mul_f32 v34, s40, v32
    s_cmp_lt_u32 s41, 27
    s_cselect_b32 s40, 0.5, 1.0
    v_mul_f32 v35, s40, v32
    s_cmp_lt_u32 s41, 26
    s_cselect_b32 s40, 0.5, 1.0
    v_mul_f32 v36, s40, v32
    s_cmp_eq_u32 s35, 6
    s_cselect_b32 s40, 0, 1.0
    v_mul_f32 v37, s40, v32
    v_mul_f32 v52, v33, v52
    v_mul_f32 v53, v33, v53
    v_cvt_pk_f16_f32 v148, v52, v53
    v_mul_f32 v56, v34, v56
    v_mul_f32 v57, v34, v57
    v_cvt_pk_f16_f32 v149, v56, v57
    v_mul_f32 v60, v35, v60
    v_mul_f32 v61, v35, v61
    v_cvt_pk_f16_f32 v150, v60, v61
    v_mul_f32 v64, v36, v64
    v_mul_f32 v65, v36, v65
    v_cvt_pk_f16_f32 v151, v64, v65
    ds_write_b128 v18, v[148:151] offset:0
    v_mul_f32 v68, v32, v68
    v_mul_f32 v69, v32, v69
    v_cvt_pk_f16_f32 v152, v68, v69
    v_mul_f32 v72, v32, v72
    v_mul_f32 v73, v32, v73
    v_cvt_pk_f16_f32 v153, v72, v73
    v_mul_f32 v76, v32, v76
    v_mul_f32 v77, v32, v77
    v_cvt_pk_f16_f32 v154, v76, v77
    v_mul_f32 v80, v32, v80
    v_mul_f32 v81, v32, v81
    v_cvt_pk_f16_f32 v155, v80, v81
    ds_write_b128 v18, v[152:155] offset:3456
    v_mul_f32 v84, v32, v84
    v_mul_f32 v85, v32, v85
    v_cvt_pk_f16_f32 v156, v84, v85
    v_mul_f32 v88, v32, v88
    v_mul_f32 v89, v32, v89
    v_cvt_pk_f16_f32 v157, v88, v89
    v_mul_f32 v92, v32, v92
    v_mul_f32 v93, v32, v93
    v_cvt_pk_f16_f32 v158, v92, v93
    v_mul_f32 v96, v32, v96
    v_mul_f32 v97, v32, v97
    v_cvt_pk_f16_f32 v159, v96, v97
    ds_write_b128 v18, v[156:159] offset:6912
    v_mul_f32 v100, v32, v100
    v_mul_f32 v101, v32, v101
    v_cvt_pk_f16_f32 v160, v100, v101
    v_mul_f32 v104, v32, v104
    v_mul_f32 v105, v32, v105
    v_cvt_pk_f16_f32 v161, v104, v105
    v_mul_f32 v108, v32, v108
    v_mul_f32 v109, v32, v109
    v_cvt_pk_f16_f32 v162, v108, v109
    v_mul_f32 v112, v32, v112
    v_mul_f32 v113, v32, v113
    v_cvt_pk_f16_f32 v163, v112, v113
    ds_write_b128 v18, v[160:163] offset:10368
    s_waitcnt lgkmcnt(2)
    v_mul_f32 v116, v32, v116
    v_mul_f32 v117, v32, v117
    v_cvt_pk_f16_f32 v148, v116, v117
    v_mul_f32 v120, v32, v120
    v_mul_f32 v121, v32, v121
    v_cvt_pk_f16_f32 v149, v120, v121
    v_mul_f32 v124, v32, v124
    v_mul_f32 v125, v32, v125
    v_cvt_pk_f16_f32 v150, v124, v125
    v_mul_f32 v128, v32, v128
    v_mul_f32 v129, v32, v129
    v_cvt_pk_f16_f32 v151, v128, v129
    ds_write_b128 v18, v[148:151] offset:13824
    v_mul_f32 v132, v32, v132
    v_mul_f32 v133, v32, v133
    v_cvt_pk_f16_f32 v152, v132, v133
    v_mul_f32 v136, v32, v136
    v_mul_f32 v137, v32, v137
    v_cvt_pk_f16_f32 v153, v136, v137
    v_mul_f32 v140, v32, v140
    v_mul_f32 v141, v32, v141
    v_cvt_pk_f16_f32 v154, v140, v141
    v_mul_f32 v144, v37, v144
    v_mul_f32 v145, v37, v145
    v_cvt_pk_f16_f32 v155, v144, v145
    s_cmp_eq_u32 s35, 7
    s_cbranch_scc1 L_noq0
    ds_write_b128 v18, v[152:155] offset:17280
L_noq0:
    s_waitcnt lgkmcnt(0)
    v_mov_b32 v3, 2
    s_mov_b64 exec, 1
    ds_add_u32 v6, v3 offset:4
    s_mov_b64 exec, -1
    s_setprio 0
L_lox:
    s_lshr_b32 s47, s35, 1
    s_cmp_lg_u32 s47, 2
    s_cbranch_scc1 L_nowl
    buffer_load_short_d16_hi v50, v49, s[20:23], 0 offen
L_nowl:
    s_and_b32 s41, s35, 3
    s_lshl_b32 s41, s41, 2
    v_add_u32 v3, s41, v6
    s_lshr_b32 s41, s35, 2
    s_add_u32 s41, s41, 1
    s_mov_b32 s60, 1048576
L_w8:
    ds_read_b32 v7, v3 offset:48
    s_waitcnt lgkmcnt(0)
    v_readfirstlane_b32 s61, v7
    s_nop 0
    s_cmp_ge_u32 s61, s41
    s_cbranch_scc1 L_d9
    s_sub_u32 s60, s60, 1
    s_cbranch_scc1 L_d9
    s_sleep 1
    s_branch L_w8
L_d9:
    ds_read_b64_tr_b16 v[52:53], v17 offset:0
    ds_read_b64_tr_b16 v[54:55], v17 offset:256
    ds_read_b64_tr_b16 v[56:57], v17 offset:512
    ds_read_b64_tr_b16 v[58:59], v17 offset:768
    ds_read_b64_tr_b16 v[60:61], v17 offset:1024
    ds_read_b64_tr_b16 v[62:63], v17 offset:1280
    ds_read_b64_tr_b16 v[64:65], v17 offset:1536
    ds_read_b64_tr_b16 v[66:67], v17 offset:1664
    ds_read_b64_tr_b16 v[68:69], v17 offset:1920
    ds_read_b64_tr_b16 v[70:71], v17 offset:2176
    ds_read_b64_tr_b16 v[72:73], v17 offset:2432
    ds_read_b64_tr_b16 v[74:75], v17 offset:2688
    ds_read_b64_tr_b16 v[76:77], v17 offset:2944
    ds_read_b64_tr_b16 v[78:79], v17 offset:3200
    s_mov_b32 s40, 0x80008000
    s_waitcnt vmcnt(0) lgkmcnt(0)
    s_mov_b64 exec, 1
    ds_add_u32 v6, v0 offset:36
    s_mov_b64 exec, -1
    s_cmp_lg_u32 s47, 2
    s_cbranch_scc1 L_noww
    ds_write_b32 v48, v50
    s_waitcnt lgkmcnt(0)
    s_mov_b64 exec, 1
    ds_add_u32 v6, v0 offset:40
    s_mov_b64 exec, -1
L_noww:
    v_and_b32 v80, 0x7fff7fff, v52
    v_and_b32 v81, 0x7fff7fff, v53
    v_and_b32 v82, 0x7fff7fff, v54
    v_and_b32 v83, 0x7fff7fff, v55
    v_and_b32 v84, 0x7fff7fff, v56
    v_and_b32 v85, 0x7fff7fff, v57
    v_and_b32 v86, 0x7fff7fff, v58
    v_and_b32 v87, 0x7fff7fff, v59
    v_and_b32 v88, 0x7fff7fff, v60
    v_and_b32 v89, 0x7fff7fff, v61
    v_and_b32 v90, 0x7fff7fff, v62
    v_and_b32 v91, 0x7fff7fff, v63
    v_and_b32 v92, 0x7fff7fff, v64
    v_pk_max_u16 v14, v80, v81
    v_pk_max_u16 v15, v82, v83
    v_pk_max_u16 v14, v14, v84
    v_pk_max_u16 v15, v15, v85
    v_pk_max_u16 v14, v14, v86
    v_pk_max_u16 v15, v15, v87
    v_pk_max_u16 v14, v14, v88
    v_pk_max_u16 v15, v15, v89
    v_pk_max_u16 v14, v14, v90
    v_pk_max_u16 v15, v15, v91
    v_pk_max_u16 v14, v14, v92
    v_pk_max_u16 v14, v14, v15
    v_pk_max_u16 v14, v14, v14 op_sel:[0,1] op_sel_hi:[1,0]
    v_bfe_u32 v14, v14, 7, 8
    v_max_u32 v14, 15, v14
    v_subrev_u32 v10, 127, v14
    v_subrev_u32 v14, 15, v14
    v_mul_u32_u24 v14, 0x800080, v14
    v_mov_b32 v12, 0
    v_pk_sub_u16 v80, v80, v14 clamp
    v_pk_sub_u16 v81, v81, v14 clamp
    v_pk_sub_u16 v82, v82, v14 clamp
    v_pk_sub_u16 v83, v83, v14 clamp
    v_pk_sub_u16 v84, v84, v14 clamp
    v_pk_sub_u16 v85, v85, v14 clamp
    v_pk_sub_u16 v86, v86, v14 clamp
    v_pk_sub_u16 v87, v87, v14 clamp
    v_pk_sub_u16 v88, v88, v14 clamp
    v_pk_sub_u16 v89, v89, v14 clamp
    v_pk_sub_u16 v90, v90, v14 clamp
    v_pk_sub_u16 v91, v91, v14 clamp
    v_pk_sub_u16 v92, v92, v14 clamp
    v_lshlrev_b32 v80, 3, v80
    v_lshlrev_b32 v81, 3, v81
    v_lshlrev_b32 v82, 3, v82
    v_lshlrev_b32 v83, 3, v83
    v_lshlrev_b32 v84, 3, v84
    v_lshlrev_b32 v85, 3, v85
    v_lshlrev_b32 v86, 3, v86
    v_lshlrev_b32 v87, 3, v87
    v_lshlrev_b32 v88, 3, v88
    v_lshlrev_b32 v89, 3, v89
    v_lshlrev_b32 v90, 3, v90
    v_lshlrev_b32 v91, 3, v91
    v_lshlrev_b32 v92, 3, v92
    v_and_or_b32 v20, v52, s40, v80
    v_and_or_b32 v21, v53, s40, v81
    v_and_or_b32 v22, v54, s40, v82
    v_and_or_b32 v23, v55, s40, v83
    v_and_or_b32 v24, v56, s40, v84
    v_and_or_b32 v25, v57, s40, v85
    v_and_or_b32 v26, v58, s40, v86
    v_and_or_b32 v27, v59, s40, v87
    v_and_or_b32 v28, v60, s40, v88
    v_and_or_b32 v29, v61, s40, v89
    v_and_or_b32 v30, v62, s40, v90
    v_and_or_b32 v31, v63, s40, v91
    v_and_or_b32 v32, v64, s40, v92
    v_and_b32 v80, 0x7fff7fff, v66
    v_and_b32 v81, 0x7fff7fff, v67
    v_and_b32 v82, 0x7fff7fff, v68
    v_and_b32 v83, 0x7fff7fff, v69
    v_and_b32 v84, 0x7fff7fff, v70
    v_and_b32 v85, 0x7fff7fff, v71
    v_and_b32 v86, 0x7fff7fff, v72
    v_and_b32 v87, 0x7fff7fff, v73
    v_and_b32 v88, 0x7fff7fff, v74
    v_and_b32 v89, 0x7fff7fff, v75
    v_and_b32 v90, 0x7fff7fff, v76
    v_and_b32 v91, 0x7fff7fff, v77
    v_and_b32 v92, 0x7fff7fff, v78
    v_pk_max_u16 v17, v80, v81
    v_pk_max_u16 v18, v82, v83
    v_pk_max_u16 v17, v17, v84
    v_pk_max_u16 v18, v18, v85
    v_pk_max_u16 v17, v17, v86
    v_pk_max_u16 v18, v18, v87
    v_pk_max_u16 v17, v17, v88
    v_pk_max_u16 v18, v18, v89
    v_pk_max_u16 v17, v17, v90
    v_pk_max_u16 v18, v18, v91
    v_pk_max_u16 v17, v17, v92
    v_pk_max_u16 v17, v17, v18
    v_pk_max_u16 v17, v17, v17 op_sel:[0,1] op_sel_hi:[1,0]
    v_bfe_u32 v17, v17, 7, 8
    v_max_u32 v17, 15, v17
    v_subrev_u32 v11, 127, v17
    v_subrev_u32 v17, 15, v17
    v_mul_u32_u24 v17, 0x800080, v17
    v_mov_b32 v13, 0
    v_pk_sub_u16 v80, v80, v17 clamp
    v_pk_sub_u16 v81, v81, v17 clamp
    v_pk_sub_u16 v82, v82, v17 clamp
    v_pk_sub_u16 v83, v83, v17 clamp
    v_pk_sub_u16 v84, v84, v17 clamp
    v_pk_sub_u16 v85, v85, v17 clamp
    v_pk_sub_u16 v86, v86, v17 clamp
    v_pk_sub_u16 v87, v87, v17 clamp
    v_pk_sub_u16 v88, v88, v17 clamp
    v_pk_sub_u16 v89, v89, v17 clamp
    v_pk_sub_u16 v90, v90, v17 clamp
    v_pk_sub_u16 v91, v91, v17 clamp
    v_pk_sub_u16 v92, v92, v17 clamp
    v_lshlrev_b32 v80, 3, v80
    v_lshlrev_b32 v81, 3, v81
    v_lshlrev_b32 v82, 3, v82
    v_lshlrev_b32 v83, 3, v83
    v_lshlrev_b32 v84, 3, v84
    v_lshlrev_b32 v85, 3, v85
    v_lshlrev_b32 v86, 3, v86
    v_lshlrev_b32 v87, 3, v87
    v_lshlrev_b32 v88, 3, v88
    v_lshlrev_b32 v89, 3, v89
    v_lshlrev_b32 v90, 3, v90
    v_lshlrev_b32 v91, 3, v91
    v_lshlrev_b32 v92, 3, v92
    v_and_or_b32 v33, v66, s40, v80
    v_and_or_b32 v34, v67, s40, v81
    v_and_or_b32 v35, v68, s40, v82
    v_and_or_b32 v36, v69, s40, v83
    v_and_or_b32 v37, v70, s40, v84
    v_and_or_b32 v38, v71, s40, v85
    v_and_or_b32 v39, v72, s40, v86
    v_and_or_b32 v40, v73, s40, v87
    v_and_or_b32 v41, v74, s40, v88
    v_and_or_b32 v42, v75, s40, v89
    v_and_or_b32 v43, v76, s40, v90
    v_and_or_b32 v44, v77, s40, v91
    v_and_or_b32 v45, v78, s40, v92
    s_mov_b32 s60, 1048576
L_w10:
    ds_read_b32 v7, v6 offset:4
    s_waitcnt lgkmcnt(0)
    v_readfirstlane_b32 s61, v7
    s_nop 0
    s_cmp_ge_u32 s61, 8
    s_cbranch_scc1 L_d11
    s_sub_u32 s60, s60, 1
    s_cbranch_scc1 L_d11
    s_sleep 1
    s_branch L_w10
L_d11:
    s_setprio 3
    ds_read_b128 v[60:63], v4 offset:0
    ds_read_b128 v[64:67], v4 offset:864
    ds_read_b128 v[68:71], v4 offset:1728
    v_alignbit_b32 v108, v20, v20, v2
    v_alignbit_b32 v109, v21, v21, v2
    v_alignbit_b32 v110, v22, v22, v2
    v_alignbit_b32 v111, v23, v23, v2
    v_alignbit_b32 v112, v24, v24, v2
    v_alignbit_b32 v113, v25, v25, v2
    v_alignbit_b32 v114, v26, v26, v2
    v_alignbit_b32 v115, v27, v27, v2
    v_alignbit_b32 v116, v28, v28, v2
    v_alignbit_b32 v117, v29, v29, v2
    v_alignbit_b32 v118, v30, v30, v2
    v_alignbit_b32 v119, v31, v31, v2
    v_alignbit_b32 v120, v32, v32, v2
    v_alignbit_b32 v121, v33, v33, v2
    v_alignbit_b32 v122, v34, v34, v2
    v_alignbit_b32 v123, v35, v35, v2
    v_alignbit_b32 v124, v36, v36, v2
    v_alignbit_b32 v125, v37, v37, v2
    v_alignbit_b32 v126, v38, v38, v2
    v_alignbit_b32 v127, v39, v39, v2
    v_alignbit_b32 v128, v40, v40, v2
    v_alignbit_b32 v129, v41, v41, v2
    v_alignbit_b32 v130, v42, v42, v2
    v_alignbit_b32 v131, v43, v43, v2
    v_alignbit_b32 v132, v44, v44, v2
    v_alignbit_b32 v133, v45, v45, v2
    v_pk_mul_f16 v52, v20, v108
    v_pk_mul_f16 v53, v21, v109
    v_pk_mul_f16 v54, v22, v110
    v_pk_mul_f16 v55, v23, v111
    v_pk_mul_f16 v56, v33, v121
    v_pk_mul_f16 v57, v34, v122
    v_pk_mul_f16 v58, v35, v123
    v_pk_mul_f16 v59, v36, v124
    s_waitcnt lgkmcnt(2)
    v_mfma_f32_32x32x16_f16 v[76:91], v[60:63], v[52:55], 0
    v_pk_mul_f16 v46, v24, v112
    v_pk_mul_f16 v47, v25, v113
    v_pk_mul_f16 v48, v26, v114
    v_pk_mul_f16 v49, v27, v115
    v_mfma_f32_32x32x16_f16 v[92:107], v[60:63], v[56:59], 0
    ds_read_b128 v[72:75], v4 offset:2592
    v_pk_mul_f16 v52, v37, v125
    v_pk_mul_f16 v53, v38, v126
    v_pk_mul_f16 v54, v39, v127
    v_pk_mul_f16 v55, v40, v128
    s_waitcnt lgkmcnt(2)
    v_mfma_f32_32x32x16_f16 v[76:91], v[64:67], v[46:49], v[76:91]
    v_pk_mul_f16 v56, v28, v116
    v_pk_mul_f16 v57, v29, v117
    v_pk_mul_f16 v58, v30, v118
    v_pk_mul_f16 v59, v31, v119
    v_mfma_f32_32x32x16_f16 v[92:107], v[64:67], v[52:55], v[92:107]
    ds_read_b128 v[60:63], v4 offset:3456
    v_pk_mul_f16 v46, v41, v129
    v_pk_mul_f16 v47, v42, v130
    v_pk_mul_f16 v48, v43, v131
    v_pk_mul_f16 v49, v44, v132
    s_waitcnt lgkmcnt(2)
    v_mfma_f32_32x32x16_f16 v[76:91], v[68:71], v[56:59], v[76:91]
    v_pk_mul_f16 v52, v32, v120
    v_pk_mul_f16 v53, v20, v109
    v_pk_mul_f16 v54, v21, v110
    v_pk_mul_f16 v55, v22, v111
    v_mfma_f32_32x32x16_f16 v[92:107], v[68:71], v[46:49], v[92:107]
    ds_read_b128 v[64:67], v4 offset:4320
    v_pk_mul_f16 v56, v45, v133
    v_pk_mul_f16 v57, v33, v122
    v_pk_mul_f16 v58, v34, v123
    v_pk_mul_f16 v59, v35, v124
    s_waitcnt lgkmcnt(2)
    v_mfma_f32_32x32x16_f16 v[76:91], v[72:75], v[52:55], v[76:91]
    v_pk_mul_f16 v46, v23, v112
    v_pk_mul_f16 v47, v24, v113
    v_pk_mul_f16 v48, v25, v114
    v_pk_mul_f16 v49, v26, v115
    v_mfma_f32_32x32x16_f16 v[92:107], v[72:75], v[56:59], v[92:107]
    ds_read_b128 v[68:71], v4 offset:5184
    v_pk_mul_f16 v52, v36, v125
    v_pk_mul_f16 v53, v37, v126
    v_pk_mul_f16 v54, v38, v127
    v_pk_mul_f16 v55, v39, v128
    s_waitcnt lgkmcnt(2)
    v_mfma_f32_32x32x16_f16 v[76:91], v[60:63], v[46:49], v[76:91]
    v_pk_mul_f16 v56, v27, v116
    v_pk_mul_f16 v57, v28, v117
    v_pk_mul_f16 v58, v29, v118
    v_pk_mul_f16 v59, v30, v119
    v_mfma_f32_32x32x16_f16 v[92:107], v[60:63], v[52:55], v[92:107]
    ds_read_b128 v[72:75], v4 offset:6048
    v_pk_mul_f16 v46, v40, v129
    v_pk_mul_f16 v47, v41, v130
    v_pk_mul_f16 v48, v42, v131
    v_pk_mul_f16 v49, v43, v132
    s_waitcnt lgkmcnt(2)
    v_mfma_f32_32x32x16_f16 v[76:91], v[64:67], v[56:59], v[76:91]
    v_pk_mul_f16 v52, v31, v120
    v_pk_mul_f16 v53, v32, v108
    v_pk_mul_f16 v54, v20, v110
    v_pk_mul_f16 v55, v21, v111
    v_mfma_f32_32x32x16_f16 v[92:107], v[64:67], v[46:49], v[92:107]
    ds_read_b128 v[60:63], v4 offset:6912
    v_pk_mul_f16 v56, v44, v133
    v_pk_mul_f16 v57, v45, v121
    v_pk_mul_f16 v58, v33, v123
    v_pk_mul_f16 v59, v34, v124
    s_waitcnt lgkmcnt(2)
    v_mfma_f32_32x32x16_f16 v[76:91], v[68:71], v[52:55], v[76:91]
    v_pk_mul_f16 v46, v22, v112
    v_pk_mul_f16 v47, v23, v113
    v_pk_mul_f16 v48, v24, v114
    v_pk_mul_f16 v49, v25, v115
    v_mfma_f32_32x32x16_f16 v[92:107], v[68:71], v[56:59], v[92:107]
    ds_read_b128 v[64:67], v4 offset:7776
    v_pk_mul_f16 v52, v35, v125
    v_pk_mul_f16 v53, v36, v126
    v_pk_mul_f16 v54, v37, v127
    v_pk_mul_f16 v55, v38, v128
    s_waitcnt lgkmcnt(2)
    v_mfma_f32_32x32x16_f16 v[76:91], v[72:75], v[46:49], v[76:91]
    v_pk_mul_f16 v56, v26, v116
    v_pk_mul_f16 v57, v27, v117
    v_pk_mul_f16 v58, v28, v118
    v_pk_mul_f16 v59, v29, v119
    v_mfma_f32_32x32x16_f16 v[92:107], v[72:75], v[52:55], v[92:107]
    ds_read_b128 v[68:71], v4 offset:8640
    v_pk_mul_f16 v46, v39, v129
    v_pk_mul_f16 v47, v40, v130
    v_pk_mul_f16 v48, v41, v131
    v_pk_mul_f16 v49, v42, v132
    s_waitcnt lgkmcnt(2)
    v_mfma_f32_32x32x16_f16 v[76:91], v[60:63], v[56:59], v[76:91]
    v_pk_mul_f16 v52, v30, v120
    v_pk_mul_f16 v53, v31, v108
    v_pk_mul_f16 v54, v32, v109
    v_pk_mul_f16 v55, v20, v111
    v_mfma_f32_32x32x16_f16 v[92:107], v[60:63], v[46:49], v[92:107]
    ds_read_b128 v[72:75], v4 offset:9504
    v_pk_mul_f16 v56, v43, v133
    v_pk_mul_f16 v57, v44, v121
    v_pk_mul_f16 v58, v45, v122
    v_pk_mul_f16 v59, v33, v124
    s_waitcnt lgkmcnt(2)
    v_mfma_f32_32x32x16_f16 v[76:91], v[64:67], v[52:55], v[76:91]
    v_pk_mul_f16 v46, v21, v112
    v_pk_mul_f16 v47, v22, v113
    v_pk_mul_f16 v48, v23, v114
    v_pk_mul_f16 v49, v24, v115
    v_mfma_f32_32x32x16_f16 v[92:107], v[64:67], v[56:59], v[92:107]
    ds_read_b128 v[60:63], v4 offset:10368
    v_pk_mul_f16 v52, v34, v125
    v_pk_mul_f16 v53, v35, v126
    v_pk_mul_f16 v54, v36, v127
    v_pk_mul_f16 v55, v37, v128
    s_waitcnt lgkmcnt(2)
    v_mfma_f32_32x32x16_f16 v[76:91], v[68:71], v[46:49], v[76:91]
    v_pk_mul_f16 v56, v25, v116
    v_pk_mul_f16 v57, v26, v117
    v_pk_mul_f16 v58, v27, v118
    v_pk_mul_f16 v59, v28, v119
    v_mfma_f32_32x32x16_f16 v[92:107], v[68:71], v[52:55], v[92:107]
    ds_read_b128 v[64:67], v4 offset:11232
    v_pk_mul_f16 v46, v38, v129
    v_pk_mul_f16 v47, v39, v130
    v_pk_mul_f16 v48, v40, v131
    v_pk_mul_f16 v49, v41, v132
    s_waitcnt lgkmcnt(2)
    v_mfma_f32_32x32x16_f16 v[76:91], v[72:75], v[56:59], v[76:91]
    v_pk_mul_f16 v52, v29, v120
    v_pk_mul_f16 v53, v30, v108
    v_pk_mul_f16 v54, v31, v109
    v_pk_mul_f16 v55, v32, v110
    v_mfma_f32_32x32x16_f16 v[92:107], v[72:75], v[46:49], v[92:107]
    ds_read_b128 v[68:71], v4 offset:12096
    v_pk_mul_f16 v56, v42, v133
    v_pk_mul_f16 v57, v43, v121
    v_pk_mul_f16 v58, v44, v122
    v_pk_mul_f16 v59, v45, v123
    s_waitcnt lgkmcnt(2)
    v_mfma_f32_32x32x16_f16 v[76:91], v[60:63], v[52:55], v[76:91]
    v_pk_mul_f16 v46, v20, v112
    v_pk_mul_f16 v47, v21, v113
    v_pk_mul_f16 v48, v22, v114
    v_pk_mul_f16 v49, v23, v115
    v_mfma_f32_32x32x16_f16 v[92:107], v[60:63], v[56:59], v[92:107]
    ds_read_b128 v[72:75], v4 offset:12960
    v_pk_mul_f16 v52, v33, v125
    v_pk_mul_f16 v53, v34, v126
    v_pk_mul_f16 v54, v35, v127
    v_pk_mul_f16 v55, v36, v128
    s_waitcnt lgkmcnt(2)
    v_mfma_f32_32x32x16_f16 v[76:91], v[64:67], v[46:49], v[76:91]
    v_pk_mul_f16 v56, v24, v116
    v_pk_mul_f16 v57, v25, v117
    v_pk_mul_f16 v58, v26, v118
    v_pk_mul_f16 v59, v27, v119
    v_mfma_f32_32x32x16_f16 v[92:107], v[64:67], v[52:55], v[92:107]
    ds_read_b128 v[60:63], v4 offset:13824
    v_pk_mul_f16 v46, v37, v129
    v_pk_mul_f16 v47, v38, v130
    v_pk_mul_f16 v48, v39, v131
    v_pk_mul_f16 v49, v40, v132
    s_waitcnt lgkmcnt(2)
    v_mfma_f32_32x32x16_f16 v[76:91], v[68:71], v[56:59], v[76:91]
    v_pk_mul_f16 v52, v28, v120
    v_pk_mul_f16 v53, v29, v108
    v_pk_mul_f16 v54, v30, v109
    v_pk_mul_f16 v55, v31, v110
    v_mfma_f32_32x32x16_f16 v[92:107], v[68:71], v[46:49], v[92:107]
    ds_read_b128 v[64:67], v4 offset:14688
    v_pk_mul_f16 v56, v41, v133
    v_pk_mul_f16 v57, v42, v121
    v_pk_mul_f16 v58, v43, v122
    v_pk_mul_f16 v59, v44, v123
    s_waitcnt lgkmcnt(2)
    v_mfma_f32_32x32x16_f16 v[76:91], v[72:75], v[52:55], v[76:91]
    v_pk_mul_f16 v46, v32, v111
    v_pk_mul_f16 v47, v20, v113
    v_pk_mul_f16 v48, v21, v114
    v_pk_mul_f16 v49, v22, v115
    v_mfma_f32_32x32x16_f16 v[92:107], v[72:75], v[56:59], v[92:107]
    ds_read_b128 v[68:71], v4 offset:15552
    v_pk_mul_f16 v52, v45, v124
    v_pk_mul_f16 v53, v33, v126
    v_pk_mul_f16 v54, v34, v127
    v_pk_mul_f16 v55, v35, v128
    s_waitcnt lgkmcnt(2)
    v_mfma_f32_32x32x16_f16 v[76:91], v[60:63], v[46:49], v[76:91]
    v_pk_mul_f16 v56, v23, v116
    v_pk_mul_f16 v57, v24, v117
    v_pk_mul_f16 v58, v25, v118
    v_pk_mul_f16 v59, v26, v119
    v_mfma_f32_32x32x16_f16 v[92:107], v[60:63], v[52:55], v[92:107]
    ds_read_b128 v[72:75], v4 offset:16416
    v_pk_mul_f16 v46, v36, v129
    v_pk_mul_f16 v47, v37, v130
    v_pk_mul_f16 v48, v38, v131
    v_pk_mul_f16 v49, v39, v132
    s_waitcnt lgkmcnt(2)
    v_mfma_f32_32x32x16_f16 v[76:91], v[64:67], v[56:59], v[76:91]
    v_pk_mul_f16 v52, v27, v120
    v_pk_mul_f16 v53, v28, v108
    v_pk_mul_f16 v54, v29, v109
    v_pk_mul_f16 v55, v30, v110
    v_mfma_f32_32x32x16_f16 v[92:107], v[64:67], v[46:49], v[92:107]
    ds_read_b128 v[60:63], v4 offset:17280
    v_pk_mul_f16 v56, v40, v133
    v_pk_mul_f16 v57, v41, v121
    v_pk_mul_f16 v58, v42, v122
    v_pk_mul_f16 v59, v43, v123
    s_waitcnt lgkmcnt(2)
    v_mfma_f32_32x32x16_f16 v[76:91], v[68:71], v[52:55], v[76:91]
    v_pk_mul_f16 v46, v31, v111
    v_pk_mul_f16 v47, v32, v112
    v_pk_mul_f16 v48, v20, v114
    v_pk_mul_f16 v49, v21, v115
    v_mfma_f32_32x32x16_f16 v[92:107], v[68:71], v[56:59], v[92:107]
    ds_read_b128 v[64:67], v4 offset:18144
    v_pk_mul_f16 v52, v44, v124
    v_pk_mul_f16 v53, v45, v125
    v_pk_mul_f16 v54, v33, v127
    v_pk_mul_f16 v55, v34, v128
    s_waitcnt lgkmcnt(2)
    v_mfma_f32_32x32x16_f16 v[76:91], v[72:75], v[46:49], v[76:91]
    v_pk_mul_f16 v56, v22, v116
    v_pk_mul_f16 v57, v23, v117
    v_pk_mul_f16 v58, v24, v118
    v_pk_mul_f16 v59, v25, v119
    v_mfma_f32_32x32x16_f16 v[92:107], v[72:75], v[52:55], v[92:107]
    ds_read_b128 v[68:71], v4 offset:19008
    v_pk_mul_f16 v46, v35, v129
    v_pk_mul_f16 v47, v36, v130
    v_pk_mul_f16 v48, v37, v131
    v_pk_mul_f16 v49, v38, v132
    s_waitcnt lgkmcnt(2)
    v_mfma_f32_32x32x16_f16 v[76:91], v[60:63], v[56:59], v[76:91]
    v_pk_mul_f16 v52, v26, v120
    v_pk_mul_f16 v53, v27, v108
    v_pk_mul_f16 v54, v28, v109
    v_pk_mul_f16 v55, v29, v110
    v_mfma_f32_32x32x16_f16 v[92:107], v[60:63], v[46:49], v[92:107]
    v_pk_mul_f16 v56, v39, v133
    v_pk_mul_f16 v57, v40, v121
    v_pk_mul_f16 v58, v41, v122
    v_pk_mul_f16 v59, v42, v123
    s_waitcnt lgkmcnt(1)
    v_mfma_f32_32x32x16_f16 v[76:91], v[64:67], v[52:55], v[76:91]
    v_pk_mul_f16 v46, v30, v111
    v_pk_mul_f16 v47, v31, v112
    v_pk_mul_f16 v48, v32, v113
    v_mov_b32 v49, 0
    v_mfma_f32_32x32x16_f16 v[92:107], v[64:67], v[56:59], v[92:107]
    v_pk_mul_f16 v52, v43, v124
    v_pk_mul_f16 v53, v44, v125
    v_pk_mul_f16 v54, v45, v126
    v_mov_b32 v55, 0
    s_waitcnt lgkmcnt(0)
    v_mfma_f32_32x32x16_f16 v[76:91], v[68:71], v[46:49], v[76:91]
    v_mfma_f32_32x32x16_f16 v[92:107], v[68:71], v[52:55], v[92:107]
    s_setprio 2
    s_mov_b64 exec, 1
    ds_add_u32 v6, v0 offset:68
    s_mov_b64 exec, -1
    s_waitcnt vmcnt(0)
    s_mov_b32 s60, 1048576
L_w12:
    ds_read_b32 v7, v6 offset:40
    s_waitcnt lgkmcnt(0)
    v_readfirstlane_b32 s61, v7
    s_nop 0
    s_cmp_ge_u32 s61, 10
    s_cbranch_scc1 L_d13
    s_sub_u32 s60, s60, 1
    s_cbranch_scc1 L_d13
    s_sleep 1
    s_branch L_w12
L_d13:
    ds_read_b128 v[60:63], v6 offset:80
    s_waitcnt lgkmcnt(0)
    v_max3_u32 v60, v60, v61, v62
    v_max_u32 v60, v60, v63
    s_nop 0
    v_readfirstlane_b32 s44, v60
    s_nop 0
    s_add_u32 s44, s44, 0x80
    s_lshr_b32 s44, s44, 7
    s_sub_i32 s44, 134, s44
    s_min_i32 s44, s44, 126
    s_max_i32 s44, s44, -120
    s_add_i32 s54, s44, 127
    s_lshl_b32 s54, s54, 23
    s_sub_i32 s44, 0, s44
    v_lshl_add_u32 v8, v10, 1, s44
    v_lshl_add_u32 v9, v11, 1, s44
    v_add_u32 v4, 19888, v4
    s_mov_b32 s42, 0
    v_add_u32 v3, 8, v6
    s_mov_b32 s46, 85408
    s_mov_b32 s49, 1
    s_nop 7
L_layer:
    ds_read_b128 v[134:137], v5 offset:0
    ds_read_b128 v[138:141], v5 offset:16
    ds_read_b128 v[142:145], v5 offset:32
    ds_read_b128 v[146:149], v5 offset:48
    v_max3_f32 v14, |v76|, |v77|, |v78|
    v_max3_f32 v15, |v79|, |v80|, |v81|
    v_max3_f32 v14, v14, |v82|, |v83|
    v_max3_f32 v15, v15, |v84|, |v85|
    v_max3_f32 v14, v14, |v86|, |v87|
    v_max3_f32 v14, v14, v15, |v88|
    v_subrev_u32 v15, 1.0, v14
    v_max3_f32 v17, |v92|, |v93|, |v94|
    v_max3_f32 v18, |v95|, |v96|, |v97|
    v_max3_f32 v17, v17, |v98|, |v99|
    v_max3_f32 v18, v18, |v100|, |v101|
    v_max3_f32 v17, v17, |v102|, |v103|
    v_max3_f32 v17, v17, v18, |v104|
    v_subrev_u32 v18, 1.0, v17
    v_max_u32 v7, v15, v18
    v_cmp_le_u32 vcc, 0x7000000, v7
    s_waitcnt lgkmcnt(0)
    v_mul_f32 v16, v134, v76
    v_fmac_f32 v16, v135, v77
    v_fmac_f32 v16, v136, v78
    v_fmac_f32 v16, v137, v79
    v_fmac_f32 v16, v138, v80
    v_fmac_f32 v16, v139, v81
    v_fmac_f32 v16, v140, v82
    v_fmac_f32 v16, v141, v83
    v_fmac_f32 v16, v142, v84
    v_fmac_f32 v16, v143, v85
    v_fmac_f32 v16, v144, v86
    v_fmac_f32 v16, v145, v87
    v_fmac_f32 v16, v146, v88
    v_ldexp_f32 v16, v16, v8
    v_add_f32 v12, v12, v16
    v_add_u32 v8, v8, v10
    v_mul_f32 v19, v134, v92
    v_fmac_f32 v19, v135, v93
    v_fmac_f32 v19, v136, v94
    v_fmac_f32 v19, v137, v95
    v_fmac_f32 v19, v138, v96
    v_fmac_f32 v19, v139, v97
    v_fmac_f32 v19, v140, v98
    v_fmac_f32 v19, v141, v99
    v_fmac_f32 v19, v142, v100
    v_fmac_f32 v19, v143, v101
    v_fmac_f32 v19, v144, v102
    v_fmac_f32 v19, v145, v103
    v_fmac_f32 v19, v146, v104
    v_ldexp_f32 v19, v19, v9
    v_add_f32 v13, v13, v19
    v_add_u32 v9, v9, v11
    s_cbranch_vccz L_fast
    v_mov_b32 v15, v14
    v_mov_b32 v18, v17
    s_nop 0
    v_permlane32_swap_b32 v14, v15
    v_permlane32_swap_b32 v17, v18
    v_max_f32 v14, v14, v15
    v_frexp_exp_i32_f32 v14, v14
    v_sub_u32 v14, 8, v14
    v_min_i32 v14, 126, v14
    v_ldexp_f32 v15, 1.0, v14
    v_sub_u32 v8, v8, v14
    v_mul_f32 v76, v15, v76
    v_mul_f32 v77, v15, v77
    v_mul_f32 v78, v15, v78
    v_mul_f32 v79, v15, v79
    v_mul_f32 v80, v15, v80
    v_mul_f32 v81, v15, v81
    v_mul_f32 v82, v15, v82
    v_mul_f32 v83, v15, v83
    v_mul_f32 v84, v15, v84
    v_mul_f32 v85, v15, v85
    v_mul_f32 v86, v15, v86
    v_mul_f32 v87, v15, v87
    v_mul_f32 v88, v15, v88
    v_max_f32 v17, v17, v18
    v_frexp_exp_i32_f32 v17, v17
    v_sub_u32 v17, 8, v17
    v_min_i32 v17, 126, v17
    v_ldexp_f32 v18, 1.0, v17
    v_sub_u32 v9, v9, v17
    v_mul_f32 v92, v18, v92
    v_mul_f32 v93, v18, v93
    v_mul_f32 v94, v18, v94
    v_mul_f32 v95, v18, v95
    v_mul_f32 v96, v18, v96
    v_mul_f32 v97, v18, v97
    v_mul_f32 v98, v18, v98
    v_mul_f32 v99, v18, v99
    v_mul_f32 v100, v18, v100
    v_mul_f32 v101, v18, v101
    v_mul_f32 v102, v18, v102
    v_mul_f32 v103, v18, v103
    v_mul_f32 v104, v18, v104
L_fast:
    v_cvt_pk_f16_f32 v108, v76, v77
    v_cvt_pk_f16_f32 v109, v78, v79
    v_cvt_pk_f16_f32 v110, v80, v81
    v_cvt_pk_f16_f32 v111, v82, v83
    v_cvt_pk_f16_f32 v112, v84, v85
    v_cvt_pk_f16_f32 v113, v86, v87
    v_cvt_pk_f16_f32 v114, v88, v88
    v_cvt_pk_f16_f32 v115, v92, v93
    v_cvt_pk_f16_f32 v116, v94, v95
    v_cvt_pk_f16_f32 v117, v96, v97
    v_cvt_pk_f16_f32 v118, v98, v99
    v_cvt_pk_f16_f32 v119, v100, v101
    v_cvt_pk_f16_f32 v120, v102, v103
    v_cvt_pk_f16_f32 v121, v104, v104
    s_mov_b32 s60, 1048576
L_w14:
    ds_read_b32 v7, v3 offset:0
    s_waitcnt lgkmcnt(0)
    v_readfirstlane_b32 s61, v7
    s_nop 0
    s_cmp_ge_u32 s61, 12
    s_cbranch_scc1 L_d15
    s_sub_u32 s60, s60, 1
    s_cbranch_scc1 L_d15
    s_sleep 1
    s_branch L_w14
L_d15:
    v_mov_b32 v7, s46
    ds_read_b32 v7, v7
    ds_read_b128 v[60:63], v4 offset:0
    ds_read_b128 v[64:67], v4 offset:864
    ds_read_b128 v[68:71], v4 offset:1728
    s_waitcnt lgkmcnt(3)
    v_sub_u32 v8, v8, v7
    v_sub_u32 v9, v9, v7
    v_pk_mul_f16 v52, v108, v20 op_sel:[0,0] op_sel_hi:[0,1]
    v_pk_mul_f16 v53, v108, v21 op_sel:[0,0] op_sel_hi:[0,1]
    v_pk_mul_f16 v54, v108, v22 op_sel:[0,0] op_sel_hi:[0,1]
    v_pk_mul_f16 v55, v108, v23 op_sel:[0,0] op_sel_hi:[0,1]
    v_pk_mul_f16 v56, v115, v33 op_sel:[0,0] op_sel_hi:[0,1]
    v_pk_mul_f16 v57, v115, v34 op_sel:[0,0] op_sel_hi:[0,1]
    v_pk_mul_f16 v58, v115, v35 op_sel:[0,0] op_sel_hi:[0,1]
    v_pk_mul_f16 v59, v115, v36 op_sel:[0,0] op_sel_hi:[0,1]
    s_waitcnt lgkmcnt(2)
    v_mfma_f32_32x32x16_f16 v[76:91], v[60:63], v[52:55], 0
    v_pk_mul_f16 v46, v108, v24 op_sel:[0,0] op_sel_hi:[0,1]
    v_pk_mul_f16 v47, v108, v25 op_sel:[0,0] op_sel_hi:[0,1]
    v_pk_mul_f16 v48, v108, v26 op_sel:[0,0] op_sel_hi:[0,1]
    v_pk_mul_f16 v49, v108, v27 op_sel:[0,0] op_sel_hi:[0,1]
    v_mfma_f32_32x32x16_f16 v[92:107], v[60:63], v[56:59], 0
    ds_read_b128 v[72:75], v4 offset:2592
    v_pk_mul_f16 v52, v115, v37 op_sel:[0,0] op_sel_hi:[0,1]
    v_pk_mul_f16 v53, v115, v38 op_sel:[0,0] op_sel_hi:[0,1]
    v_pk_mul_f16 v54, v115, v39 op_sel:[0,0] op_sel_hi:[0,1]
    v_pk_mul_f16 v55, v115, v40 op_sel:[0,0] op_sel_hi:[0,1]
    s_waitcnt lgkmcnt(2)
    v_mfma_f32_32x32x16_f16 v[76:91], v[64:67], v[46:49], v[76:91]
    v_pk_mul_f16 v56, v108, v28 op_sel:[0,0] op_sel_hi:[0,1]
    v_pk_mul_f16 v57, v108, v29 op_sel:[0,0] op_sel_hi:[0,1]
    v_pk_mul_f16 v58, v108, v30 op_sel:[0,0] op_sel_hi:[0,1]
    v_pk_mul_f16 v59, v108, v31 op_sel:[0,0] op_sel_hi:[0,1]
    v_mfma_f32_32x32x16_f16 v[92:107], v[64:67], v[52:55], v[92:107]
    ds_read_b128 v[60:63], v4 offset:3456
    v_pk_mul_f16 v46, v115, v41 op_sel:[0,0] op_sel_hi:[0,1]
    v_pk_mul_f16 v47, v115, v42 op_sel:[0,0] op_sel_hi:[0,1]
    v_pk_mul_f16 v48, v115, v43 op_sel:[0,0] op_sel_hi:[0,1]
    v_pk_mul_f16 v49, v115, v44 op_sel:[0,0] op_sel_hi:[0,1]
    s_waitcnt lgkmcnt(2)
    v_mfma_f32_32x32x16_f16 v[76:91], v[68:71], v[56:59], v[76:91]
    v_pk_mul_f16 v52, v108, v32 op_sel:[0,0] op_sel_hi:[0,1]
    v_pk_mul_f16 v53, v108, v20 op_sel:[1,0] op_sel_hi:[1,1]
    v_pk_mul_f16 v54, v108, v21 op_sel:[1,0] op_sel_hi:[1,1]
    v_pk_mul_f16 v55, v108, v22 op_sel:[1,0] op_sel_hi:[1,1]
    v_mfma_f32_32x32x16_f16 v[92:107], v[68:71], v[46:49], v[92:107]
    ds_read_b128 v[64:67], v4 offset:4320
    v_pk_mul_f16 v56, v115, v45 op_sel:[0,0] op_sel_hi:[0,1]
    v_pk_mul_f16 v57, v115, v33 op_sel:[1,0] op_sel_hi:[1,1]
    v_pk_mul_f16 v58, v115, v34 op_sel:[1,0] op_sel_hi:[1,1]
    v_pk_mul_f16 v59, v115, v35 op_sel:[1,0] op_sel_hi:[1,1]
    s_waitcnt lgkmcnt(2)
    v_mfma_f32_32x32x16_f16 v[76:91], v[72:75], v[52:55], v[76:91]
    v_pk_mul_f16 v46, v108, v23 op_sel:[1,0] op_sel_hi:[1,1]
    v_pk_mul_f16 v47, v108, v24 op_sel:[1,0] op_sel_hi:[1,1]
    v_pk_mul_f16 v48, v108, v25 op_sel:[1,0] op_sel_hi:[1,1]
    v_pk_mul_f16 v49, v108, v26 op_sel:[1,0] op_sel_hi:[1,1]
    v_mfma_f32_32x32x16_f16 v[92:107], v[72:75], v[56:59], v[92:107]
    ds_read_b128 v[68:71], v4 offset:5184
    v_pk_mul_f16 v52, v115, v36 op_sel:[1,0] op_sel_hi:[1,1]
    v_pk_mul_f16 v53, v115, v37 op_sel:[1,0] op_sel_hi:[1,1]
    v_pk_mul_f16 v54, v115, v38 op_sel:[1,0] op_sel_hi:[1,1]
    v_pk_mul_f16 v55, v115, v39 op_sel:[1,0] op_sel_hi:[1,1]
    s_waitcnt lgkmcnt(2)
    v_mfma_f32_32x32x16_f16 v[76:91], v[60:63], v[46:49], v[76:91]
    v_pk_mul_f16 v56, v108, v27 op_sel:[1,0] op_sel_hi:[1,1]
    v_pk_mul_f16 v57, v108, v28 op_sel:[1,0] op_sel_hi:[1,1]
    v_pk_mul_f16 v58, v108, v29 op_sel:[1,0] op_sel_hi:[1,1]
    v_pk_mul_f16 v59, v108, v30 op_sel:[1,0] op_sel_hi:[1,1]
    v_mfma_f32_32x32x16_f16 v[92:107], v[60:63], v[52:55], v[92:107]
    ds_read_b128 v[72:75], v4 offset:6048
    v_pk_mul_f16 v46, v115, v40 op_sel:[1,0] op_sel_hi:[1,1]
    v_pk_mul_f16 v47, v115, v41 op_sel:[1,0] op_sel_hi:[1,1]
    v_pk_mul_f16 v48, v115, v42 op_sel:[1,0] op_sel_hi:[1,1]
    v_pk_mul_f16 v49, v115, v43 op_sel:[1,0] op_sel_hi:[1,1]
    s_waitcnt lgkmcnt(2)
    v_mfma_f32_32x32x16_f16 v[76:91], v[64:67], v[56:59], v[76:91]
    v_pk_mul_f16 v52, v108, v31 op_sel:[1,0] op_sel_hi:[1,1]
    v_pk_mul_f16 v53, v108, v32 op_sel:[1,0] op_sel_hi:[1,1]
    v_pk_mul_f16 v54, v109, v20 op_sel:[0,0] op_sel_hi:[0,1]
    v_pk_mul_f16 v55, v109, v21 op_sel:[0,0] op_sel_hi:[0,1]
    v_mfma_f32_32x32x16_f16 v[92:107], v[64:67], v[46:49], v[92:107]
    ds_read_b128 v[60:63], v4 offset:6912
    v_pk_mul_f16 v56, v115, v44 op_sel:[1,0] op_sel_hi:[1,1]
    v_pk_mul_f16 v57, v115, v45 op_sel:[1,0] op_sel_hi:[1,1]
    v_pk_mul_f16 v58, v116, v33 op_sel:[0,0] op_sel_hi:[0,1]
    v_pk_mul_f16 v59, v116, v34 op_sel:[0,0] op_sel_hi:[0,1]
    s_waitcnt lgkmcnt(2)
    s_cmp_lg_u32 s49, 0
    s_cbranch_scc1 L_pr16
    s_setprio 2
L_pr16:
    v_mfma_f32_32x32x16_f16 v[76:91], v[68:71], v[52:55], v[76:91]
    v_pk_mul_f16 v46, v109, v22 op_sel:[0,0] op_sel_hi:[0,1]
    v_pk_mul_f16 v47, v109, v23 op_sel:[0,0] op_sel_hi:[0,1]
    v_pk_mul_f16 v48, v109, v24 op_sel:[0,0] op_sel_hi:[0,1]
    v_pk_mul_f16 v49, v109, v25 op_sel:[0,0] op_sel_hi:[0,1]
    v_mfma_f32_32x32x16_f16 v[92:107], v[68:71], v[56:59], v[92:107]
    ds_read_b128 v[64:67], v4 offset:7776
    v_pk_mul_f16 v52, v116, v35 op_sel:[0,0] op_sel_hi:[0,1]
    v_pk_mul_f16 v53, v116, v36 op_sel:[0,0] op_sel_hi:[0,1]
    v_pk_mul_f16 v54, v116, v37 op_sel:[0,0] op_sel_hi:[0,1]
    v_pk_mul_f16 v55, v116, v38 op_sel:[0,0] op_sel_hi:[0,1]
    s_waitcnt lgkmcnt(2)
    v_mfma_f32_32x32x16_f16 v[76:91], v[72:75], v[46:49], v[76:91]
    v_pk_mul_f16 v56, v109, v26 op_sel:[0,0] op_sel_hi:[0,1]
    v_pk_mul_f16 v57, v109, v27 op_sel:[0,0] op_sel_hi:[0,1]
    v_pk_mul_f16 v58, v109, v28 op_sel:[0,0] op_sel_hi:[0,1]
    v_pk_mul_f16 v59, v109, v29 op_sel:[0,0] op_sel_hi:[0,1]
    v_mfma_f32_32x32x16_f16 v[92:107], v[72:75], v[52:55], v[92:107]
    ds_read_b128 v[68:71], v4 offset:8640
    v_pk_mul_f16 v46, v116, v39 op_sel:[0,0] op_sel_hi:[0,1]
    v_pk_mul_f16 v47, v116, v40 op_sel:[0,0] op_sel_hi:[0,1]
    v_pk_mul_f16 v48, v116, v41 op_sel:[0,0] op_sel_hi:[0,1]
    v_pk_mul_f16 v49, v116, v42 op_sel:[0,0] op_sel_hi:[0,1]
    s_waitcnt lgkmcnt(2)
    v_mfma_f32_32x32x16_f16 v[76:91], v[60:63], v[56:59], v[76:91]
    v_pk_mul_f16 v52, v109, v30 op_sel:[0,0] op_sel_hi:[0,1]
    v_pk_mul_f16 v53, v109, v31 op_sel:[0,0] op_sel_hi:[0,1]
    v_pk_mul_f16 v54, v109, v32 op_sel:[0,0] op_sel_hi:[0,1]
    v_pk_mul_f16 v55, v109, v20 op_sel:[1,0] op_sel_hi:[1,1]
    v_mfma_f32_32x32x16_f16 v[92:107], v[60:63], v[46:49], v[92:107]
    ds_read_b128 v[72:75], v4 offset:9504
    v_pk_mul_f16 v56, v116, v43 op_sel:[0,0] op_sel_hi:[0,1]
    v_pk_mul_f16 v57, v116, v44 op_sel:[0,0] op_sel_hi:[0,1]
    v_pk_mul_f16 v58, v116, v45 op_sel:[0,0] op_sel_hi:[0,1]
    v_pk_mul_f16 v59, v116, v33 op_sel:[1,0] op_sel_hi:[1,1]
    s_waitcnt lgkmcnt(2)
    v_mfma_f32_32x32x16_f16 v[76:91], v[64:67], v[52:55], v[76:91]
    v_pk_mul_f16 v46, v109, v21 op_sel:[1,0] op_sel_hi:[1,1]
    v_pk_mul_f16 v47, v109, v22 op_sel:[1,0] op_sel_hi:[1,1]
    v_pk_mul_f16 v48, v109, v23 op_sel:[1,0] op_sel_hi:[1,1]
    v_pk_mul_f16 v49, v109, v24 op_sel:[1,0] op_sel_hi:[1,1]
    v_mfma_f32_32x32x16_f16 v[92:107], v[64:67], v[56:59], v[92:107]
    ds_read_b128 v[60:63], v4 offset:10368
    v_pk_mul_f16 v52, v116, v34 op_sel:[1,0] op_sel_hi:[1,1]
    v_pk_mul_f16 v53, v116, v35 op_sel:[1,0] op_sel_hi:[1,1]
    v_pk_mul_f16 v54, v116, v36 op_sel:[1,0] op_sel_hi:[1,1]
    v_pk_mul_f16 v55, v116, v37 op_sel:[1,0] op_sel_hi:[1,1]
    s_waitcnt lgkmcnt(2)
    v_mfma_f32_32x32x16_f16 v[76:91], v[68:71], v[46:49], v[76:91]
    v_pk_mul_f16 v56, v109, v25 op_sel:[1,0] op_sel_hi:[1,1]
    v_pk_mul_f16 v57, v109, v26 op_sel:[1,0] op_sel_hi:[1,1]
    v_pk_mul_f16 v58, v109, v27 op_sel:[1,0] op_sel_hi:[1,1]
    v_pk_mul_f16 v59, v109, v28 op_sel:[1,0] op_sel_hi:[1,1]
    v_mfma_f32_32x32x16_f16 v[92:107], v[68:71], v[52:55], v[92:107]
    ds_read_b128 v[64:67], v4 offset:11232
    v_pk_mul_f16 v46, v116, v38 op_sel:[1,0] op_sel_hi:[1,1]
    v_pk_mul_f16 v47, v116, v39 op_sel:[1,0] op_sel_hi:[1,1]
    v_pk_mul_f16 v48, v116, v40 op_sel:[1,0] op_sel_hi:[1,1]
    v_pk_mul_f16 v49, v116, v41 op_sel:[1,0] op_sel_hi:[1,1]
    s_waitcnt lgkmcnt(2)
    v_mfma_f32_32x32x16_f16 v[76:91], v[72:75], v[56:59], v[76:91]
    v_pk_mul_f16 v52, v109, v29 op_sel:[1,0] op_sel_hi:[1,1]
    v_pk_mul_f16 v53, v109, v30 op_sel:[1,0] op_sel_hi:[1,1]
    v_pk_mul_f16 v54, v109, v31 op_sel:[1,0] op_sel_hi:[1,1]
    v_pk_mul_f16 v55, v109, v32 op_sel:[1,0] op_sel_hi:[1,1]
    v_mfma_f32_32x32x16_f16 v[92:107], v[72:75], v[46:49], v[92:107]
    ds_read_b128 v[68:71], v4 offset:12096
    v_pk_mul_f16 v56, v116, v42 op_sel:[1,0] op_sel_hi:[1,1]
    v_pk_mul_f16 v57, v116, v43 op_sel:[1,0] op_sel_hi:[1,1]
    v_pk_mul_f16 v58, v116, v44 op_sel:[1,0] op_sel_hi:[1,1]
    v_pk_mul_f16 v59, v116, v45 op_sel:[1,0] op_sel_hi:[1,1]
    s_waitcnt lgkmcnt(2)
    v_mfma_f32_32x32x16_f16 v[76:91], v[60:63], v[52:55], v[76:91]
    v_pk_mul_f16 v46, v110, v20 op_sel:[0,0] op_sel_hi:[0,1]
    v_pk_mul_f16 v47, v110, v21 op_sel:[0,0] op_sel_hi:[0,1]
    v_pk_mul_f16 v48, v110, v22 op_sel:[0,0] op_sel_hi:[0,1]
    v_pk_mul_f16 v49, v110, v23 op_sel:[0,0] op_sel_hi:[0,1]
    v_mfma_f32_32x32x16_f16 v[92:107], v[60:63], v[56:59], v[92:107]
    ds_read_b128 v[72:75], v4 offset:12960
    v_pk_mul_f16 v52, v117, v33 op_sel:[0,0] op_sel_hi:[0,1]
    v_pk_mul_f16 v53, v117, v34 op_sel:[0,0] op_sel_hi:[0,1]
    v_pk_mul_f16 v54, v117, v35 op_sel:[0,0] op_sel_hi:[0,1]
    v_pk_mul_f16 v55, v117, v36 op_sel:[0,0] op_sel_hi:[0,1]
    s_waitcnt lgkmcnt(2)
    v_mfma_f32_32x32x16_f16 v[76:91], v[64:67], v[46:49], v[76:91]
    v_pk_mul_f16 v56, v110, v24 op_sel:[0,0] op_sel_hi:[0,1]
    v_pk_mul_f16 v57, v110, v25 op_sel:[0,0] op_sel_hi:[0,1]
    v_pk_mul_f16 v58, v110, v26 op_sel:[0,0] op_sel_hi:[0,1]
    v_pk_mul_f16 v59, v110, v27 op_sel:[0,0] op_sel_hi:[0,1]
    v_mfma_f32_32x32x16_f16 v[92:107], v[64:67], v[52:55], v[92:107]
    ds_read_b128 v[60:63], v4 offset:13824
    v_pk_mul_f16 v46, v117, v37 op_sel:[0,0] op_sel_hi:[0,1]
    v_pk_mul_f16 v47, v117, v38 op_sel:[0,0] op_sel_hi:[0,1]
    v_pk_mul_f16 v48, v117, v39 op_sel:[0,0] op_sel_hi:[0,1]
    v_pk_mul_f16 v49, v117, v40 op_sel:[0,0] op_sel_hi:[0,1]
    s_waitcnt lgkmcnt(2)
    v_mfma_f32_32x32x16_f16 v[76:91], v[68:71], v[56:59], v[76:91]
    v_pk_mul_f16 v52, v110, v28 op_sel:[0,0] op_sel_hi:[0,1]
    v_pk_mul_f16 v53, v110, v29 op_sel:[0,0] op_sel_hi:[0,1]
    v_pk_mul_f16 v54, v110, v30 op_sel:[0,0] op_sel_hi:[0,1]
    v_pk_mul_f16 v55, v110, v31 op_sel:[0,0] op_sel_hi:[0,1]
    v_mfma_f32_32x32x16_f16 v[92:107], v[68:71], v[46:49], v[92:107]
    ds_read_b128 v[64:67], v4 offset:14688
    v_pk_mul_f16 v56, v117, v41 op_sel:[0,0] op_sel_hi:[0,1]
    v_pk_mul_f16 v57, v117, v42 op_sel:[0,0] op_sel_hi:[0,1]
    v_pk_mul_f16 v58, v117, v43 op_sel:[0,0] op_sel_hi:[0,1]
    v_pk_mul_f16 v59, v117, v44 op_sel:[0,0] op_sel_hi:[0,1]
    s_waitcnt lgkmcnt(2)
    v_mfma_f32_32x32x16_f16 v[76:91], v[72:75], v[52:55], v[76:91]
    v_pk_mul_f16 v46, v110, v32 op_sel:[0,0] op_sel_hi:[0,1]
    v_pk_mul_f16 v47, v110, v20 op_sel:[1,0] op_sel_hi:[1,1]
    v_pk_mul_f16 v48, v110, v21 op_sel:[1,0] op_sel_hi:[1,1]
    v_pk_mul_f16 v49, v110, v22 op_sel:[1,0] op_sel_hi:[1,1]
    v_mfma_f32_32x32x16_f16 v[92:107], v[72:75], v[56:59], v[92:107]
    ds_read_b128 v[68:71], v4 offset:15552
    v_pk_mul_f16 v52, v117, v45 op_sel:[0,0] op_sel_hi:[0,1]
    v_pk_mul_f16 v53, v117, v33 op_sel:[1,0] op_sel_hi:[1,1]
    v_pk_mul_f16 v54, v117, v34 op_sel:[1,0] op_sel_hi:[1,1]
    v_pk_mul_f16 v55, v117, v35 op_sel:[1,0] op_sel_hi:[1,1]
    s_waitcnt lgkmcnt(2)
    v_mfma_f32_32x32x16_f16 v[76:91], v[60:63], v[46:49], v[76:91]
    v_pk_mul_f16 v56, v110, v23 op_sel:[1,0] op_sel_hi:[1,1]
    v_pk_mul_f16 v57, v110, v24 op_sel:[1,0] op_sel_hi:[1,1]
    v_pk_mul_f16 v58, v110, v25 op_sel:[1,0] op_sel_hi:[1,1]
    v_pk_mul_f16 v59, v110, v26 op_sel:[1,0] op_sel_hi:[1,1]
    v_mfma_f32_32x32x16_f16 v[92:107], v[60:63], v[52:55], v[92:107]
    ds_read_b128 v[72:75], v4 offset:16416
    v_pk_mul_f16 v46, v117, v36 op_sel:[1,0] op_sel_hi:[1,1]
    v_pk_mul_f16 v47, v117, v37 op_sel:[1,0] op_sel_hi:[1,1]
    v_pk_mul_f16 v48, v117, v38 op_sel:[1,0] op_sel_hi:[1,1]
    v_pk_mul_f16 v49, v117, v39 op_sel:[1,0] op_sel_hi:[1,1]
    s_waitcnt lgkmcnt(2)
    v_mfma_f32_32x32x16_f16 v[76:91], v[64:67], v[56:59], v[76:91]
    v_pk_mul_f16 v52, v110, v27 op_sel:[1,0] op_sel_hi:[1,1]
    v_pk_mul_f16 v53, v110, v28 op_sel:[1,0] op_sel_hi:[1,1]
    v_pk_mul_f16 v54, v110, v29 op_sel:[1,0] op_sel_hi:[1,1]
    v_pk_mul_f16 v55, v110, v30 op_sel:[1,0] op_sel_hi:[1,1]
    v_mfma_f32_32x32x16_f16 v[92:107], v[64:67], v[46:49], v[92:107]
    ds_read_b128 v[60:63], v4 offset:17280
    v_pk_mul_f16 v56, v117, v40 op_sel:[1,0] op_sel_hi:[1,1]
    v_pk_mul_f16 v57, v117, v41 op_sel:[1,0] op_sel_hi:[1,1]
    v_pk_mul_f16 v58, v117, v42 op_sel:[1,0] op_sel_hi:[1,1]
    v_pk_mul_f16 v59, v117, v43 op_sel:[1,0] op_sel_hi:[1,1]
    s_waitcnt lgkmcnt(2)
    v_mfma_f32_32x32x16_f16 v[76:91], v[68:71], v[52:55], v[76:91]
    v_pk_mul_f16 v46, v110, v31 op_sel:[1,0] op_sel_hi:[1,1]
    v_pk_mul_f16 v47, v110, v32 op_sel:[1,0] op_sel_hi:[1,1]
    v_pk_mul_f16 v48, v111, v20 op_sel:[0,0] op_sel_hi:[0,1]
    v_pk_mul_f16 v49, v111, v21 op_sel:[0,0] op_sel_hi:[0,1]
    v_mfma_f32_32x32x16_f16 v[92:107], v[68:71], v[56:59], v[92:107]
    ds_read_b128 v[64:67], v4 offset:18144
    v_pk_mul_f16 v52, v117, v44 op_sel:[1,0] op_sel_hi:[1,1]
    v_pk_mul_f16 v53, v117, v45 op_sel:[1,0] op_sel_hi:[1,1]
    v_pk_mul_f16 v54, v118, v33 op_sel:[0,0] op_sel_hi:[0,1]
    v_pk_mul_f16 v55, v118, v34 op_sel:[0,0] op_sel_hi:[0,1]
    s_waitcnt lgkmcnt(2)
    v_mfma_f32_32x32x16_f16 v[76:91], v[72:75], v[46:49], v[76:91]
    v_pk_mul_f16 v56, v111, v22 op_sel:[0,0] op_sel_hi:[0,1]
    v_pk_mul_f16 v57, v111, v23 op_sel:[0,0] op_sel_hi:[0,1]
    v_pk_mul_f16 v58, v111, v24 op_sel:[0,0] op_sel_hi:[0,1]
    v_pk_mul_f16 v59, v111, v25 op_sel:[0,0] op_sel_hi:[0,1]
    v_mfma_f32_32x32x16_f16 v[92:107], v[72:75], v[52:55], v[92:107]
    ds_read_b128 v[68:71], v4 offset:19008
    v_pk_mul_f16 v46, v118, v35 op_sel:[0,0] op_sel_hi:[0,1]
    v_pk_mul_f16 v47, v118, v36 op_sel:[0,0] op_sel_hi:[0,1]
    v_pk_mul_f16 v48, v118, v37 op_sel:[0,0] op_sel_hi:[0,1]
    v_pk_mul_f16 v49, v118, v38 op_sel:[0,0] op_sel_hi:[0,1]
    s_waitcnt lgkmcnt(2)
    v_mfma_f32_32x32x16_f16 v[76:91], v[60:63], v[56:59], v[76:91]
    v_pk_mul_f16 v52, v111, v26 op_sel:[0,0] op_sel_hi:[0,1]
    v_pk_mul_f16 v53, v111, v27 op_sel:[0,0] op_sel_hi:[0,1]
    v_pk_mul_f16 v54, v111, v28 op_sel:[0,0] op_sel_hi:[0,1]
    v_pk_mul_f16 v55, v111, v29 op_sel:[0,0] op_sel_hi:[0,1]
    v_mfma_f32_32x32x16_f16 v[92:107], v[60:63], v[46:49], v[92:107]
    ds_read_b128 v[72:75], v4 offset:19872
    v_pk_mul_f16 v56, v118, v39 op_sel:[0,0] op_sel_hi:[0,1]
    v_pk_mul_f16 v57, v118, v40 op_sel:[0,0] op_sel_hi:[0,1]
    v_pk_mul_f16 v58, v118, v41 op_sel:[0,0] op_sel_hi:[0,1]
    v_pk_mul_f16 v59, v118, v42 op_sel:[0,0] op_sel_hi:[0,1]
    s_waitcnt lgkmcnt(2)
    v_mfma_f32_32x32x16_f16 v[76:91], v[64:67], v[52:55], v[76:91]
    v_pk_mul_f16 v46, v111, v30 op_sel:[0,0] op_sel_hi:[0,1]
    v_pk_mul_f16 v47, v111, v31 op_sel:[0,0] op_sel_hi:[0,1]
    v_pk_mul_f16 v48, v111, v32 op_sel:[0,0] op_sel_hi:[0,1]
    v_pk_mul_f16 v49, v111, v20 op_sel:[1,0] op_sel_hi:[1,1]
    v_mfma_f32_32x32x16_f16 v[92:107], v[64:67], v[56:59], v[92:107]
    ds_read_b128 v[60:63], v4 offset:20736
    v_pk_mul_f16 v52, v118, v43 op_sel:[0,0] op_sel_hi:[0,1]
    v_pk_mul_f16 v53, v118, v44 op_sel:[0,0] op_sel_hi:[0,1]
    v_pk_mul_f16 v54, v118, v45 op_sel:[0,0] op_sel_hi:[0,1]
    v_pk_mul_f16 v55, v118, v33 op_sel:[1,0] op_sel_hi:[1,1]
    s_waitcnt lgkmcnt(2)
    v_mfma_f32_32x32x16_f16 v[76:91], v[68:71], v[46:49], v[76:91]
    v_pk_mul_f16 v56, v111, v21 op_sel:[1,0] op_sel_hi:[1,1]
    v_pk_mul_f16 v57, v111, v22 op_sel:[1,0] op_sel_hi:[1,1]
    v_pk_mul_f16 v58, v111, v23 op_sel:[1,0] op_sel_hi:[1,1]
    v_pk_mul_f16 v59, v111, v24 op_sel:[1,0] op_sel_hi:[1,1]
    v_mfma_f32_32x32x16_f16 v[92:107], v[68:71], v[52:55], v[92:107]
    ds_read_b128 v[64:67], v4 offset:21600
    v_pk_mul_f16 v46, v118, v34 op_sel:[1,0] op_sel_hi:[1,1]
    v_pk_mul_f16 v47, v118, v35 op_sel:[1,0] op_sel_hi:[1,1]
    v_pk_mul_f16 v48, v118, v36 op_sel:[1,0] op_sel_hi:[1,1]
    v_pk_mul_f16 v49, v118, v37 op_sel:[1,0] op_sel_hi:[1,1]
    s_waitcnt lgkmcnt(2)
    v_mfma_f32_32x32x16_f16 v[76:91], v[72:75], v[56:59], v[76:91]
    v_pk_mul_f16 v52, v111, v25 op_sel:[1,0] op_sel_hi:[1,1]
    v_pk_mul_f16 v53, v111, v26 op_sel:[1,0] op_sel_hi:[1,1]
    v_pk_mul_f16 v54, v111, v27 op_sel:[1,0] op_sel_hi:[1,1]
    v_pk_mul_f16 v55, v111, v28 op_sel:[1,0] op_sel_hi:[1,1]
    v_mfma_f32_32x32x16_f16 v[92:107], v[72:75], v[46:49], v[92:107]
    ds_read_b128 v[68:71], v4 offset:22464
    v_pk_mul_f16 v56, v118, v38 op_sel:[1,0] op_sel_hi:[1,1]
    v_pk_mul_f16 v57, v118, v39 op_sel:[1,0] op_sel_hi:[1,1]
    v_pk_mul_f16 v58, v118, v40 op_sel:[1,0] op_sel_hi:[1,1]
    v_pk_mul_f16 v59, v118, v41 op_sel:[1,0] op_sel_hi:[1,1]
    s_waitcnt lgkmcnt(2)
    v_mfma_f32_32x32x16_f16 v[76:91], v[60:63], v[52:55], v[76:91]
    v_pk_mul_f16 v46, v111, v29 op_sel:[1,0] op_sel_hi:[1,1]
    v_pk_mul_f16 v47, v111, v30 op_sel:[1,0] op_sel_hi:[1,1]
    v_pk_mul_f16 v48, v111, v31 op_sel:[1,0] op_sel_hi:[1,1]
    v_pk_mul_f16 v49, v111, v32 op_sel:[1,0] op_sel_hi:[1,1]
    v_mfma_f32_32x32x16_f16 v[92:107], v[60:63], v[56:59], v[92:107]
    ds_read_b128 v[72:75], v4 offset:23328
    v_pk_mul_f16 v52, v118, v42 op_sel:[1,0] op_sel_hi:[1,1]
    v_pk_mul_f16 v53, v118, v43 op_sel:[1,0] op_sel_hi:[1,1]
    v_pk_mul_f16 v54, v118, v44 op_sel:[1,0] op_sel_hi:[1,1]
    v_pk_mul_f16 v55, v118, v45 op_sel:[1,0] op_sel_hi:[1,1]
    s_waitcnt lgkmcnt(2)
    v_mfma_f32_32x32x16_f16 v[76:91], v[64:67], v[46:49], v[76:91]
    v_pk_mul_f16 v56, v112, v20 op_sel:[0,0] op_sel_hi:[0,1]
    v_pk_mul_f16 v57, v112, v21 op_sel:[0,0] op_sel_hi:[0,1]
    v_pk_mul_f16 v58, v112, v22 op_sel:[0,0] op_sel_hi:[0,1]
    v_pk_mul_f16 v59, v112, v23 op_sel:[0,0] op_sel_hi:[0,1]
    v_mfma_f32_32x32x16_f16 v[92:107], v[64:67], v[52:55], v[92:107]
    ds_read_b128 v[60:63], v4 offset:24192
    v_pk_mul_f16 v46, v119, v33 op_sel:[0,0] op_sel_hi:[0,1]
    v_pk_mul_f16 v47, v119, v34 op_sel:[0,0] op_sel_hi:[0,1]
    v_pk_mul_f16 v48, v119, v35 op_sel:[0,0] op_sel_hi:[0,1]
    v_pk_mul_f16 v49, v119, v36 op_sel:[0,0] op_sel_hi:[0,1]
    s_waitcnt lgkmcnt(2)
    v_mfma_f32_32x32x16_f16 v[76:91], v[68:71], v[56:59], v[76:91]
    v_pk_mul_f16 v52, v112, v24 op_sel:[0,0] op_sel_hi:[0,1]
    v_pk_mul_f16 v53, v112, v25 op_sel:[0,0] op_sel_hi:[0,1]
    v_pk_mul_f16 v54, v112, v26 op_sel:[0,0] op_sel_hi:[0,1]
    v_pk_mul_f16 v55, v112, v27 op_sel:[0,0] op_sel_hi:[0,1]
    v_mfma_f32_32x32x16_f16 v[92:107], v[68:71], v[46:49], v[92:107]
    ds_read_b128 v[64:67], v4 offset:25056
    v_pk_mul_f16 v56, v119, v37 op_sel:[0,0] op_sel_hi:[0,1]
    v_pk_mul_f16 v57, v119, v38 op_sel:[0,0] op_sel_hi:[0,1]
    v_pk_mul_f16 v58, v119, v39 op_sel:[0,0] op_sel_hi:[0,1]
    v_pk_mul_f16 v59, v119, v40 op_sel:[0,0] op_sel_hi:[0,1]
    s_waitcnt lgkmcnt(2)
    v_mfma_f32_32x32x16_f16 v[76:91], v[72:75], v[52:55], v[76:91]
    v_pk_mul_f16 v46, v112, v28 op_sel:[0,0] op_sel_hi:[0,1]
    v_pk_mul_f16 v47, v112, v29 op_sel:[0,0] op_sel_hi:[0,1]
    v_pk_mul_f16 v48, v112, v30 op_sel:[0,0] op_sel_hi:[0,1]
    v_pk_mul_f16 v49, v112, v31 op_sel:[0,0] op_sel_hi:[0,1]
    v_mfma_f32_32x32x16_f16 v[92:107], v[72:75], v[56:59], v[92:107]
    ds_read_b128 v[68:71], v4 offset:25920
    v_pk_mul_f16 v52, v119, v41 op_sel:[0,0] op_sel_hi:[0,1]
    v_pk_mul_f16 v53, v119, v42 op_sel:[0,0] op_sel_hi:[0,1]
    v_pk_mul_f16 v54, v119, v43 op_sel:[0,0] op_sel_hi:[0,1]
    v_pk_mul_f16 v55, v119, v44 op_sel:[0,0] op_sel_hi:[0,1]
    s_waitcnt lgkmcnt(2)
    v_mfma_f32_32x32x16_f16 v[76:91], v[60:63], v[46:49], v[76:91]
    v_pk_mul_f16 v56, v112, v32 op_sel:[0,0] op_sel_hi:[0,1]
    v_pk_mul_f16 v57, v112, v20 op_sel:[1,0] op_sel_hi:[1,1]
    v_pk_mul_f16 v58, v112, v21 op_sel:[1,0] op_sel_hi:[1,1]
    v_pk_mul_f16 v59, v112, v22 op_sel:[1,0] op_sel_hi:[1,1]
    v_mfma_f32_32x32x16_f16 v[92:107], v[60:63], v[52:55], v[92:107]
    ds_read_b128 v[72:75], v4 offset:26784
    v_pk_mul_f16 v46, v119, v45 op_sel:[0,0] op_sel_hi:[0,1]
    v_pk_mul_f16 v47, v119, v33 op_sel:[1,0] op_sel_hi:[1,1]
    v_pk_mul_f16 v48, v119, v34 op_sel:[1,0] op_sel_hi:[1,1]
    v_pk_mul_f16 v49, v119, v35 op_sel:[1,0] op_sel_hi:[1,1]
    s_waitcnt lgkmcnt(2)
    v_mfma_f32_32x32x16_f16 v[76:91], v[64:67], v[56:59], v[76:91]
    v_pk_mul_f16 v52, v112, v23 op_sel:[1,0] op_sel_hi:[1,1]
    v_pk_mul_f16 v53, v112, v24 op_sel:[1,0] op_sel_hi:[1,1]
    v_pk_mul_f16 v54, v112, v25 op_sel:[1,0] op_sel_hi:[1,1]
    v_pk_mul_f16 v55, v112, v26 op_sel:[1,0] op_sel_hi:[1,1]
    v_mfma_f32_32x32x16_f16 v[92:107], v[64:67], v[46:49], v[92:107]
    ds_read_b128 v[60:63], v4 offset:27648
    v_pk_mul_f16 v56, v119, v36 op_sel:[1,0] op_sel_hi:[1,1]
    v_pk_mul_f16 v57, v119, v37 op_sel:[1,0] op_sel_hi:[1,1]
    v_pk_mul_f16 v58, v119, v38 op_sel:[1,0] op_sel_hi:[1,1]
    v_pk_mul_f16 v59, v119, v39 op_sel:[1,0] op_sel_hi:[1,1]
    s_waitcnt lgkmcnt(2)
    v_mfma_f32_32x32x16_f16 v[76:91], v[68:71], v[52:55], v[76:91]
    v_pk_mul_f16 v46, v112, v27 op_sel:[1,0] op_sel_hi:[1,1]
    v_pk_mul_f16 v47, v112, v28 op_sel:[1,0] op_sel_hi:[1,1]
    v_pk_mul_f16 v48, v112, v29 op_sel:[1,0] op_sel_hi:[1,1]
    v_pk_mul_f16 v49, v112, v30 op_sel:[1,0] op_sel_hi:[1,1]
    v_mfma_f32_32x32x16_f16 v[92:107], v[68:71], v[56:59], v[92:107]
    ds_read_b128 v[64:67], v4 offset:28512
    v_pk_mul_f16 v52, v119, v40 op_sel:[1,0] op_sel_hi:[1,1]
    v_pk_mul_f16 v53, v119, v41 op_sel:[1,0] op_sel_hi:[1,1]
    v_pk_mul_f16 v54, v119, v42 op_sel:[1,0] op_sel_hi:[1,1]
    v_pk_mul_f16 v55, v119, v43 op_sel:[1,0] op_sel_hi:[1,1]
    s_waitcnt lgkmcnt(2)
    v_mfma_f32_32x32x16_f16 v[76:91], v[72:75], v[46:49], v[76:91]
    v_pk_mul_f16 v56, v112, v31 op_sel:[1,0] op_sel_hi:[1,1]
    v_pk_mul_f16 v57, v112, v32 op_sel:[1,0] op_sel_hi:[1,1]
    v_pk_mul_f16 v58, v113, v20 op_sel:[0,0] op_sel_hi:[0,1]
    v_pk_mul_f16 v59, v113, v21 op_sel:[0,0] op_sel_hi:[0,1]
    v_mfma_f32_32x32x16_f16 v[92:107], v[72:75], v[52:55], v[92:107]
    ds_read_b128 v[68:71], v4 offset:29376
    v_pk_mul_f16 v46, v119, v44 op_sel:[1,0] op_sel_hi:[1,1]
    v_pk_mul_f16 v47, v119, v45 op_sel:[1,0] op_sel_hi:[1,1]
    v_pk_mul_f16 v48, v120, v33 op_sel:[0,0] op_sel_hi:[0,1]
    v_pk_mul_f16 v49, v120, v34 op_sel:[0,0] op_sel_hi:[0,1]
    s_waitcnt lgkmcnt(2)
    v_mfma_f32_32x32x16_f16 v[76:91], v[60:63], v[56:59], v[76:91]
    v_pk_mul_f16 v52, v113, v22 op_sel:[0,0] op_sel_hi:[0,1]
    v_pk_mul_f16 v53, v113, v23 op_sel:[0,0] op_sel_hi:[0,1]
    v_pk_mul_f16 v54, v113, v24 op_sel:[0,0] op_sel_hi:[0,1]
    v_pk_mul_f16 v55, v113, v25 op_sel:[0,0] op_sel_hi:[0,1]
    v_mfma_f32_32x32x16_f16 v[92:107], v[60:63], v[46:49], v[92:107]
    ds_read_b128 v[72:75], v4 offset:30240
    v_pk_mul_f16 v56, v120, v35 op_sel:[0,0] op_sel_hi:[0,1]
    v_pk_mul_f16 v57, v120, v36 op_sel:[0,0] op_sel_hi:[0,1]
    v_pk_mul_f16 v58, v120, v37 op_sel:[0,0] op_sel_hi:[0,1]
    v_pk_mul_f16 v59, v120, v38 op_sel:[0,0] op_sel_hi:[0,1]
    s_waitcnt lgkmcnt(2)
    v_mfma_f32_32x32x16_f16 v[76:91], v[64:67], v[52:55], v[76:91]
    v_pk_mul_f16 v46, v113, v26 op_sel:[0,0] op_sel_hi:[0,1]
    v_pk_mul_f16 v47, v113, v27 op_sel:[0,0] op_sel_hi:[0,1]
    v_pk_mul_f16 v48, v113, v28 op_sel:[0,0] op_sel_hi:[0,1]
    v_pk_mul_f16 v49, v113, v29 op_sel:[0,0] op_sel_hi:[0,1]
    v_mfma_f32_32x32x16_f16 v[92:107], v[64:67], v[56:59], v[92:107]
    ds_read_b128 v[60:63], v4 offset:31104
    v_pk_mul_f16 v52, v120, v39 op_sel:[0,0] op_sel_hi:[0,1]
    v_pk_mul_f16 v53, v120, v40 op_sel:[0,0] op_sel_hi:[0,1]
    v_pk_mul_f16 v54, v120, v41 op_sel:[0,0] op_sel_hi:[0,1]
    v_pk_mul_f16 v55, v120, v42 op_sel:[0,0] op_sel_hi:[0,1]
    s_waitcnt lgkmcnt(2)
    v_mfma_f32_32x32x16_f16 v[76:91], v[68:71], v[46:49], v[76:91]
    v_pk_mul_f16 v56, v113, v30 op_sel:[0,0] op_sel_hi:[0,1]
    v_pk_mul_f16 v57, v113, v31 op_sel:[0,0] op_sel_hi:[0,1]
    v_pk_mul_f16 v58, v113, v32 op_sel:[0,0] op_sel_hi:[0,1]
    v_pk_mul_f16 v59, v113, v20 op_sel:[1,0] op_sel_hi:[1,1]
    v_mfma_f32_32x32x16_f16 v[92:107], v[68:71], v[52:55], v[92:107]
    ds_read_b128 v[64:67], v4 offset:31968
    v_pk_mul_f16 v46, v120, v43 op_sel:[0,0] op_sel_hi:[0,1]
    v_pk_mul_f16 v47, v120, v44 op_sel:[0,0] op_sel_hi:[0,1]
    v_pk_mul_f16 v48, v120, v45 op_sel:[0,0] op_sel_hi:[0,1]
    v_pk_mul_f16 v49, v120, v33 op_sel:[1,0] op_sel_hi:[1,1]
    s_waitcnt lgkmcnt(2)
    v_mfma_f32_32x32x16_f16 v[76:91], v[72:75], v[56:59], v[76:91]
    v_pk_mul_f16 v52, v113, v21 op_sel:[1,0] op_sel_hi:[1,1]
    v_pk_mul_f16 v53, v113, v22 op_sel:[1,0] op_sel_hi:[1,1]
    v_pk_mul_f16 v54, v113, v23 op_sel:[1,0] op_sel_hi:[1,1]
    v_pk_mul_f16 v55, v113, v24 op_sel:[1,0] op_sel_hi:[1,1]
    v_mfma_f32_32x32x16_f16 v[92:107], v[72:75], v[46:49], v[92:107]
    ds_read_b128 v[68:71], v4 offset:32832
    v_pk_mul_f16 v56, v120, v34 op_sel:[1,0] op_sel_hi:[1,1]
    v_pk_mul_f16 v57, v120, v35 op_sel:[1,0] op_sel_hi:[1,1]
    v_pk_mul_f16 v58, v120, v36 op_sel:[1,0] op_sel_hi:[1,1]
    v_pk_mul_f16 v59, v120, v37 op_sel:[1,0] op_sel_hi:[1,1]
    s_waitcnt lgkmcnt(2)
    v_mfma_f32_32x32x16_f16 v[76:91], v[60:63], v[52:55], v[76:91]
    v_pk_mul_f16 v46, v113, v25 op_sel:[1,0] op_sel_hi:[1,1]
    v_pk_mul_f16 v47, v113, v26 op_sel:[1,0] op_sel_hi:[1,1]
    v_pk_mul_f16 v48, v113, v27 op_sel:[1,0] op_sel_hi:[1,1]
    v_pk_mul_f16 v49, v113, v28 op_sel:[1,0] op_sel_hi:[1,1]
    v_mfma_f32_32x32x16_f16 v[92:107], v[60:63], v[56:59], v[92:107]
    ds_read_b128 v[72:75], v4 offset:33696
    v_pk_mul_f16 v52, v120, v38 op_sel:[1,0] op_sel_hi:[1,1]
    v_pk_mul_f16 v53, v120, v39 op_sel:[1,0] op_sel_hi:[1,1]
    v_pk_mul_f16 v54, v120, v40 op_sel:[1,0] op_sel_hi:[1,1]
    v_pk_mul_f16 v55, v120, v41 op_sel:[1,0] op_sel_hi:[1,1]
    s_waitcnt lgkmcnt(2)
    v_mfma_f32_32x32x16_f16 v[76:91], v[64:67], v[46:49], v[76:91]
    v_pk_mul_f16 v56, v113, v29 op_sel:[1,0] op_sel_hi:[1,1]
    v_pk_mul_f16 v57, v113, v30 op_sel:[1,0] op_sel_hi:[1,1]
    v_pk_mul_f16 v58, v113, v31 op_sel:[1,0] op_sel_hi:[1,1]
    v_pk_mul_f16 v59, v113, v32 op_sel:[1,0] op_sel_hi:[1,1]
    v_mfma_f32_32x32x16_f16 v[92:107], v[64:67], v[52:55], v[92:107]
    ds_read_b128 v[60:63], v4 offset:34560
    v_pk_mul_f16 v46, v120, v42 op_sel:[1,0] op_sel_hi:[1,1]
    v_pk_mul_f16 v47, v120, v43 op_sel:[1,0] op_sel_hi:[1,1]
    v_pk_mul_f16 v48, v120, v44 op_sel:[1,0] op_sel_hi:[1,1]
    v_pk_mul_f16 v49, v120, v45 op_sel:[1,0] op_sel_hi:[1,1]
    s_waitcnt lgkmcnt(2)
    v_mfma_f32_32x32x16_f16 v[76:91], v[68:71], v[56:59], v[76:91]
    v_pk_mul_f16 v52, v114, v20 op_sel:[0,0] op_sel_hi:[0,1]
    v_pk_mul_f16 v53, v114, v21 op_sel:[0,0] op_sel_hi:[0,1]
    v_pk_mul_f16 v54, v114, v22 op_sel:[0,0] op_sel_hi:[0,1]
    v_pk_mul_f16 v55, v114, v23 op_sel:[0,0] op_sel_hi:[0,1]
    v_mfma_f32_32x32x16_f16 v[92:107], v[68:71], v[46:49], v[92:107]
    ds_read_b128 v[64:67], v4 offset:35424
    v_pk_mul_f16 v56, v121, v33 op_sel:[0,0] op_sel_hi:[0,1]
    v_pk_mul_f16 v57, v121, v34 op_sel:[0,0] op_sel_hi:[0,1]
    v_pk_mul_f16 v58, v121, v35 op_sel:[0,0] op_sel_hi:[0,1]
    v_pk_mul_f16 v59, v121, v36 op_sel:[0,0] op_sel_hi:[0,1]
    s_waitcnt lgkmcnt(2)
    v_mfma_f32_32x32x16_f16 v[76:91], v[72:75], v[52:55], v[76:91]
    v_pk_mul_f16 v46, v114, v24 op_sel:[0,0] op_sel_hi:[0,1]
    v_pk_mul_f16 v47, v114, v25 op_sel:[0,0] op_sel_hi:[0,1]
    v_pk_mul_f16 v48, v114, v26 op_sel:[0,0] op_sel_hi:[0,1]
    v_pk_mul_f16 v49, v114, v27 op_sel:[0,0] op_sel_hi:[0,1]
    v_mfma_f32_32x32x16_f16 v[92:107], v[72:75], v[56:59], v[92:107]
    ds_read_b128 v[68:71], v4 offset:36288
    v_pk_mul_f16 v52, v121, v37 op_sel:[0,0] op_sel_hi:[0,1]
    v_pk_mul_f16 v53, v121, v38 op_sel:[0,0] op_sel_hi:[0,1]
    v_pk_mul_f16 v54, v121, v39 op_sel:[0,0] op_sel_hi:[0,1]
    v_pk_mul_f16 v55, v121, v40 op_sel:[0,0] op_sel_hi:[0,1]
    s_waitcnt lgkmcnt(2)
    v_mfma_f32_32x32x16_f16 v[76:91], v[60:63], v[46:49], v[76:91]
    v_pk_mul_f16 v56, v114, v28 op_sel:[0,0] op_sel_hi:[0,1]
    v_pk_mul_f16 v57, v114, v29 op_sel:[0,0] op_sel_hi:[0,1]
    v_pk_mul_f16 v58, v114, v30 op_sel:[0,0] op_sel_hi:[0,1]
    v_pk_mul_f16 v59, v114, v31 op_sel:[0,0] op_sel_hi:[0,1]
    v_mfma_f32_32x32x16_f16 v[92:107], v[60:63], v[52:55], v[92:107]
    v_pk_mul_f16 v46, v121, v41 op_sel:[0,0] op_sel_hi:[0,1]
    v_pk_mul_f16 v47, v121, v42 op_sel:[0,0] op_sel_hi:[0,1]
    v_pk_mul_f16 v48, v121, v43 op_sel:[0,0] op_sel_hi:[0,1]
    v_pk_mul_f16 v49, v121, v44 op_sel:[0,0] op_sel_hi:[0,1]
    s_waitcnt lgkmcnt(1)
    v_mfma_f32_32x32x16_f16 v[76:91], v[64:67], v[56:59], v[76:91]
    v_pk_mul_f16 v52, v114, v32 op_sel:[0,0] op_sel_hi:[0,1]
    v_mov_b32 v53, 0
    v_mov_b32 v54, 0
    v_mov_b32 v55, 0
    v_mfma_f32_32x32x16_f16 v[92:107], v[64:67], v[46:49], v[92:107]
    v_pk_mul_f16 v56, v121, v45 op_sel:[0,0] op_sel_hi:[0,1]
    v_mov_b32 v57, 0
    v_mov_b32 v58, 0
    v_mov_b32 v59, 0
    s_waitcnt lgkmcnt(0)
    v_mfma_f32_32x32x16_f16 v[76:91], v[68:71], v[52:55], v[76:91]
    v_mfma_f32_32x32x16_f16 v[92:107], v[68:71], v[56:59], v[92:107]
    s_setprio 1
    s_cmp_lg_u32 s42, 0
    s_cbranch_scc1 L_not0
    s_setprio 1
    s_mov_b64 exec, 1
    ds_add_u32 v6, v0 offset:32
    s_mov_b64 exec, -1
L_not0:
    v_add_u32 v5, 128, v5
    s_lshr_b32 s41, s35, 2
    s_mov_b32 s43, 37152
    s_cmp_eq_u32 s42, 0
    s_cselect_b32 s43, 37888, s43
    s_cmp_eq_u32 s42, 1
    s_cselect_b32 s43, 0xfffe1e50, s43
    s_mov_b32 s46, 123296
    s_cselect_b32 s46, 58760, s46
    s_xor_b32 s49, s41, 1
    v_add_u32 v4, s43, v4
    v_add_u32 v3, 4, v3
    s_add_u32 s42, s42, 1
    s_cmp_lt_u32 s42, 3
    s_cbranch_scc1 L_layer
    s_mov_b64 exec, 1
    ds_add_u32 v6, v0 offset:44
    s_mov_b64 exec, -1
    ds_read_b128 v[134:137], v5 offset:0
    ds_read_b128 v[138:141], v5 offset:16
    ds_read_b128 v[142:145], v5 offset:32
    ds_read_b128 v[146:149], v5 offset:48
    ds_read_b128 v[72:75], v4 offset:19872
    ds_read_b128 v[60:63], v4 offset:20736
    v_mov_b32 v7, 58752
    ds_read_b64 v[50:51], v7
    v_cndmask_b32 v108, v20, v27, s[38:39]
    v_cndmask_b32 v109, v21, v28, s[38:39]
    v_cndmask_b32 v110, v22, v29, s[38:39]
    v_cndmask_b32 v111, v23, v30, s[38:39]
    v_cndmask_b32 v112, v24, v31, s[38:39]
    v_cndmask_b32 v113, v25, v32, s[38:39]
    v_cndmask_b32 v114, v26, 0, s[38:39]
    v_mov_b32 v115, 0
    v_cndmask_b32 v116, v33, v40, s[38:39]
    v_cndmask_b32 v117, v34, v41, s[38:39]
    v_cndmask_b32 v118, v35, v42, s[38:39]
    v_cndmask_b32 v119, v36, v43, s[38:39]
    v_cndmask_b32 v120, v37, v44, s[38:39]
    v_cndmask_b32 v121, v38, v45, s[38:39]
    v_cndmask_b32 v122, v39, 0, s[38:39]
    v_mov_b32 v123, 0
    s_waitcnt lgkmcnt(0)
    v_mul_f32 v16, v134, v76
    v_fmac_f32 v16, v135, v77
    v_fmac_f32 v16, v136, v78
    v_fmac_f32 v16, v137, v79
    v_fmac_f32 v16, v138, v80
    v_fmac_f32 v16, v139, v81
    v_fmac_f32 v16, v140, v82
    v_fmac_f32 v16, v141, v83
    v_fmac_f32 v16, v142, v84
    v_fmac_f32 v16, v143, v85
    v_fmac_f32 v16, v144, v86
    v_fmac_f32 v16, v145, v87
    v_fmac_f32 v16, v146, v88
    v_ldexp_f32 v16, v16, v8
    v_add_f32 v12, v12, v16
    v_mul_f32 v19, v134, v92
    v_fmac_f32 v19, v135, v93
    v_fmac_f32 v19, v136, v94
    v_fmac_f32 v19, v137, v95
    v_fmac_f32 v19, v138, v96
    v_fmac_f32 v19, v139, v97
    v_fmac_f32 v19, v140, v98
    v_fmac_f32 v19, v141, v99
    v_fmac_f32 v19, v142, v100
    v_fmac_f32 v19, v143, v101
    v_fmac_f32 v19, v144, v102
    v_fmac_f32 v19, v145, v103
    v_fmac_f32 v19, v146, v104
    v_ldexp_f32 v19, v19, v9
    v_add_f32 v13, v13, v19
    v_mfma_f32_32x32x16_f16 v[134:149], v[72:75], v[108:111], 0
    v_mfma_f32_32x32x16_f16 v[150:165], v[72:75], v[116:119], 0
    v_mfma_f32_32x32x16_f16 v[134:149], v[60:63], v[112:115], v[134:149]
    v_mfma_f32_32x32x16_f16 v[150:165], v[60:63], v[120:123], v[150:165]
    ds_read_b128 v[60:63], v4 offset:0
    ds_read_b128 v[64:67], v4 offset:864
    ds_read_b128 v[68:71], v4 offset:1728
    v_alignbit_b32 v108, v20, v20, v2
    v_alignbit_b32 v109, v21, v21, v2
    v_alignbit_b32 v110, v22, v22, v2
    v_alignbit_b32 v111, v23, v23, v2
    v_alignbit_b32 v112, v24, v24, v2
    v_alignbit_b32 v113, v25, v25, v2
    v_alignbit_b32 v114, v26, v26, v2
    v_alignbit_b32 v115, v27, v27, v2
    v_alignbit_b32 v116, v28, v28, v2
    v_alignbit_b32 v117, v29, v29, v2
    v_alignbit_b32 v118, v30, v30, v2
    v_alignbit_b32 v119, v31, v31, v2
    v_alignbit_b32 v120, v32, v32, v2
    v_alignbit_b32 v121, v33, v33, v2
    v_alignbit_b32 v122, v34, v34, v2
    v_alignbit_b32 v123, v35, v35, v2
    v_alignbit_b32 v124, v36, v36, v2
    v_alignbit_b32 v125, v37, v37, v2
    v_alignbit_b32 v126, v38, v38, v2
    v_alignbit_b32 v127, v39, v39, v2
    v_alignbit_b32 v128, v40, v40, v2
    v_alignbit_b32 v129, v41, v41, v2
    v_alignbit_b32 v130, v42, v42, v2
    v_alignbit_b32 v131, v43, v43, v2
    v_alignbit_b32 v132, v44, v44, v2
    v_alignbit_b32 v133, v45, v45, v2
    v_add_u32 v8, v8, v10
    v_sub_u32 v14, v8, v51
    v_mul_f32 v16, v134, v76
    v_fmac_f32 v16, v135, v77
    v_fmac_f32 v16, v136, v78
    v_fmac_f32 v16, v137, v79
    v_fmac_f32 v16, v138, v80
    v_fmac_f32 v16, v139, v81
    v_fmac_f32 v16, v140, v82
    v_fmac_f32 v16, v141, v83
    v_fmac_f32 v16, v142, v84
    v_fmac_f32 v16, v143, v85
    v_fmac_f32 v16, v144, v86
    v_fmac_f32 v16, v145, v87
    v_fmac_f32 v16, v146, v88
    v_ldexp_f32 v16, v16, v14
    v_add_f32 v12, v12, v16
    v_add_u32 v8, v8, v10
    v_sub_u32 v8, v8, v50
    v_add_u32 v9, v9, v11
    v_sub_u32 v17, v9, v51
    v_mul_f32 v19, v150, v92
    v_fmac_f32 v19, v151, v93
    v_fmac_f32 v19, v152, v94
    v_fmac_f32 v19, v153, v95
    v_fmac_f32 v19, v154, v96
    v_fmac_f32 v19, v155, v97
    v_fmac_f32 v19, v156, v98
    v_fmac_f32 v19, v157, v99
    v_fmac_f32 v19, v158, v100
    v_fmac_f32 v19, v159, v101
    v_fmac_f32 v19, v160, v102
    v_fmac_f32 v19, v161, v103
    v_fmac_f32 v19, v162, v104
    v_ldexp_f32 v19, v19, v17
    v_add_f32 v13, v13, v19
    v_add_u32 v9, v9, v11
    v_sub_u32 v9, v9, v50
    v_pk_mul_f16 v52, v20, v108
    v_pk_mul_f16 v53, v21, v109
    v_pk_mul_f16 v54, v22, v110
    v_pk_mul_f16 v55, v23, v111
    v_pk_mul_f16 v56, v33, v121
    v_pk_mul_f16 v57, v34, v122
    v_pk_mul_f16 v58, v35, v123
    v_pk_mul_f16 v59, v36, v124
    s_waitcnt lgkmcnt(2)
    v_mfma_f32_32x32x16_f16 v[134:149], v[60:63], v[52:55], 0
    v_pk_mul_f16 v46, v24, v112
    v_pk_mul_f16 v47, v25, v113
    v_pk_mul_f16 v48, v26, v114
    v_pk_mul_f16 v49, v27, v115
    v_mfma_f32_32x32x16_f16 v[150:165], v[60:63], v[56:59], 0
    ds_read_b128 v[72:75], v4 offset:2592
    v_pk_mul_f16 v52, v37, v125
    v_pk_mul_f16 v53, v38, v126
    v_pk_mul_f16 v54, v39, v127
    v_pk_mul_f16 v55, v40, v128
    s_waitcnt lgkmcnt(2)
    v_mfma_f32_32x32x16_f16 v[134:149], v[64:67], v[46:49], v[134:149]
    v_pk_mul_f16 v56, v28, v116
    v_pk_mul_f16 v57, v29, v117
    v_pk_mul_f16 v58, v30, v118
    v_pk_mul_f16 v59, v31, v119
    v_mfma_f32_32x32x16_f16 v[150:165], v[64:67], v[52:55], v[150:165]
    ds_read_b128 v[60:63], v4 offset:3456
    v_pk_mul_f16 v46, v41, v129
    v_pk_mul_f16 v47, v42, v130
    v_pk_mul_f16 v48, v43, v131
    v_pk_mul_f16 v49, v44, v132
    s_waitcnt lgkmcnt(2)
    v_mfma_f32_32x32x16_f16 v[134:149], v[68:71], v[56:59], v[134:149]
    v_pk_mul_f16 v52, v32, v120
    v_pk_mul_f16 v53, v20, v109
    v_pk_mul_f16 v54, v21, v110
    v_pk_mul_f16 v55, v22, v111
    v_mfma_f32_32x32x16_f16 v[150:165], v[68:71], v[46:49], v[150:165]
    ds_read_b128 v[64:67], v4 offset:4320
    v_pk_mul_f16 v56, v45, v133
    v_pk_mul_f16 v57, v33, v122
    v_pk_mul_f16 v58, v34, v123
    v_pk_mul_f16 v59, v35, v124
    s_waitcnt lgkmcnt(2)
    v_mfma_f32_32x32x16_f16 v[134:149], v[72:75], v[52:55], v[134:149]
    v_pk_mul_f16 v46, v23, v112
    v_pk_mul_f16 v47, v24, v113
    v_pk_mul_f16 v48, v25, v114
    v_pk_mul_f16 v49, v26, v115
    v_mfma_f32_32x32x16_f16 v[150:165], v[72:75], v[56:59], v[150:165]
    ds_read_b128 v[68:71], v4 offset:5184
    v_pk_mul_f16 v52, v36, v125
    v_pk_mul_f16 v53, v37, v126
    v_pk_mul_f16 v54, v38, v127
    v_pk_mul_f16 v55, v39, v128
    s_waitcnt lgkmcnt(2)
    v_mfma_f32_32x32x16_f16 v[134:149], v[60:63], v[46:49], v[134:149]
    v_pk_mul_f16 v56, v27, v116
    v_pk_mul_f16 v57, v28, v117
    v_pk_mul_f16 v58, v29, v118
    v_pk_mul_f16 v59, v30, v119
    v_mfma_f32_32x32x16_f16 v[150:165], v[60:63], v[52:55], v[150:165]
    ds_read_b128 v[72:75], v4 offset:6048
    v_pk_mul_f16 v46, v40, v129
    v_pk_mul_f16 v47, v41, v130
    v_pk_mul_f16 v48, v42, v131
    v_pk_mul_f16 v49, v43, v132
    s_waitcnt lgkmcnt(2)
    v_mfma_f32_32x32x16_f16 v[134:149], v[64:67], v[56:59], v[134:149]
    v_pk_mul_f16 v52, v31, v120
    v_pk_mul_f16 v53, v32, v108
    v_pk_mul_f16 v54, v20, v110
    v_pk_mul_f16 v55, v21, v111
    v_mfma_f32_32x32x16_f16 v[150:165], v[64:67], v[46:49], v[150:165]
    ds_read_b128 v[60:63], v4 offset:6912
    v_pk_mul_f16 v56, v44, v133
    v_pk_mul_f16 v57, v45, v121
    v_pk_mul_f16 v58, v33, v123
    v_pk_mul_f16 v59, v34, v124
    s_waitcnt lgkmcnt(2)
    v_mfma_f32_32x32x16_f16 v[134:149], v[68:71], v[52:55], v[134:149]
    v_pk_mul_f16 v46, v22, v112
    v_pk_mul_f16 v47, v23, v113
    v_pk_mul_f16 v48, v24, v114
    v_pk_mul_f16 v49, v25, v115
    v_mfma_f32_32x32x16_f16 v[150:165], v[68:71], v[56:59], v[150:165]
    ds_read_b128 v[64:67], v4 offset:7776
    v_pk_mul_f16 v52, v35, v125
    v_pk_mul_f16 v53, v36, v126
    v_pk_mul_f16 v54, v37, v127
    v_pk_mul_f16 v55, v38, v128
    s_waitcnt lgkmcnt(2)
    v_mfma_f32_32x32x16_f16 v[134:149], v[72:75], v[46:49], v[134:149]
    v_pk_mul_f16 v56, v26, v116
    v_pk_mul_f16 v57, v27, v117
    v_pk_mul_f16 v58, v28, v118
    v_pk_mul_f16 v59, v29, v119
    v_mfma_f32_32x32x16_f16 v[150:165], v[72:75], v[52:55], v[150:165]
    ds_read_b128 v[68:71], v4 offset:8640
    v_pk_mul_f16 v46, v39, v129
    v_pk_mul_f16 v47, v40, v130
    v_pk_mul_f16 v48, v41, v131
    v_pk_mul_f16 v49, v42, v132
    s_waitcnt lgkmcnt(2)
    v_mfma_f32_32x32x16_f16 v[134:149], v[60:63], v[56:59], v[134:149]
    v_pk_mul_f16 v52, v30, v120
    v_pk_mul_f16 v53, v31, v108
    v_pk_mul_f16 v54, v32, v109
    v_pk_mul_f16 v55, v20, v111
    v_mfma_f32_32x32x16_f16 v[150:165], v[60:63], v[46:49], v[150:165]
    ds_read_b128 v[72:75], v4 offset:9504
    v_pk_mul_f16 v56, v43, v133
    v_pk_mul_f16 v57, v44, v121
    v_pk_mul_f16 v58, v45, v122
    v_pk_mul_f16 v59, v33, v124
    s_waitcnt lgkmcnt(2)
    v_mfma_f32_32x32x16_f16 v[134:149], v[64:67], v[52:55], v[134:149]
    v_pk_mul_f16 v46, v21, v112
    v_pk_mul_f16 v47, v22, v113
    v_pk_mul_f16 v48, v23, v114
    v_pk_mul_f16 v49, v24, v115
    v_mfma_f32_32x32x16_f16 v[150:165], v[64:67], v[56:59], v[150:165]
    ds_read_b128 v[60:63], v4 offset:10368
    v_pk_mul_f16 v52, v34, v125
    v_pk_mul_f16 v53, v35, v126
    v_pk_mul_f16 v54, v36, v127
    v_pk_mul_f16 v55, v37, v128
    s_waitcnt lgkmcnt(2)
    v_mfma_f32_32x32x16_f16 v[134:149], v[68:71], v[46:49], v[134:149]
    v_pk_mul_f16 v56, v25, v116
    v_pk_mul_f16 v57, v26, v117
    v_pk_mul_f16 v58, v27, v118
    v_pk_mul_f16 v59, v28, v119
    v_mfma_f32_32x32x16_f16 v[150:165], v[68:71], v[52:55], v[150:165]
    ds_read_b128 v[64:67], v4 offset:11232
    v_pk_mul_f16 v46, v38, v129
    v_pk_mul_f16 v47, v39, v130
    v_pk_mul_f16 v48, v40, v131
    v_pk_mul_f16 v49, v41, v132
    s_waitcnt lgkmcnt(2)
    v_mfma_f32_32x32x16_f16 v[134:149], v[72:75], v[56:59], v[134:149]
    v_pk_mul_f16 v52, v29, v120
    v_pk_mul_f16 v53, v30, v108
    v_pk_mul_f16 v54, v31, v109
    v_pk_mul_f16 v55, v32, v110
    v_mfma_f32_32x32x16_f16 v[150:165], v[72:75], v[46:49], v[150:165]
    ds_read_b128 v[68:71], v4 offset:12096
    v_pk_mul_f16 v56, v42, v133
    v_pk_mul_f16 v57, v43, v121
    v_pk_mul_f16 v58, v44, v122
    v_pk_mul_f16 v59, v45, v123
    s_waitcnt lgkmcnt(2)
    v_mfma_f32_32x32x16_f16 v[134:149], v[60:63], v[52:55], v[134:149]
    v_pk_mul_f16 v46, v20, v112
    v_pk_mul_f16 v47, v21, v113
    v_pk_mul_f16 v48, v22, v114
    v_pk_mul_f16 v49, v23, v115
    v_mfma_f32_32x32x16_f16 v[150:165], v[60:63], v[56:59], v[150:165]
    ds_read_b128 v[72:75], v4 offset:12960
    v_pk_mul_f16 v52, v33, v125
    v_pk_mul_f16 v53, v34, v126
    v_pk_mul_f16 v54, v35, v127
    v_pk_mul_f16 v55, v36, v128
    s_waitcnt lgkmcnt(2)
    v_mfma_f32_32x32x16_f16 v[134:149], v[64:67], v[46:49], v[134:149]
    v_pk_mul_f16 v56, v24, v116
    v_pk_mul_f16 v57, v25, v117
    v_pk_mul_f16 v58, v26, v118
    v_pk_mul_f16 v59, v27, v119
    v_mfma_f32_32x32x16_f16 v[150:165], v[64:67], v[52:55], v[150:165]
    ds_read_b128 v[60:63], v4 offset:13824
    v_pk_mul_f16 v46, v37, v129
    v_pk_mul_f16 v47, v38, v130
    v_pk_mul_f16 v48, v39, v131
    v_pk_mul_f16 v49, v40, v132
    s_waitcnt lgkmcnt(2)
    v_mfma_f32_32x32x16_f16 v[134:149], v[68:71], v[56:59], v[134:149]
    v_pk_mul_f16 v52, v28, v120
    v_pk_mul_f16 v53, v29, v108
    v_pk_mul_f16 v54, v30, v109
    v_pk_mul_f16 v55, v31, v110
    v_mfma_f32_32x32x16_f16 v[150:165], v[68:71], v[46:49], v[150:165]
    ds_read_b128 v[64:67], v4 offset:14688
    v_pk_mul_f16 v56, v41, v133
    v_pk_mul_f16 v57, v42, v121
    v_pk_mul_f16 v58, v43, v122
    v_pk_mul_f16 v59, v44, v123
    s_waitcnt lgkmcnt(2)
    v_mfma_f32_32x32x16_f16 v[134:149], v[72:75], v[52:55], v[134:149]
    v_pk_mul_f16 v46, v32, v111
    v_pk_mul_f16 v47, v20, v113
    v_pk_mul_f16 v48, v21, v114
    v_pk_mul_f16 v49, v22, v115
    v_mfma_f32_32x32x16_f16 v[150:165], v[72:75], v[56:59], v[150:165]
    ds_read_b128 v[68:71], v4 offset:15552
    v_pk_mul_f16 v52, v45, v124
    v_pk_mul_f16 v53, v33, v126
    v_pk_mul_f16 v54, v34, v127
    v_pk_mul_f16 v55, v35, v128
    s_waitcnt lgkmcnt(2)
    v_mfma_f32_32x32x16_f16 v[134:149], v[60:63], v[46:49], v[134:149]
    v_pk_mul_f16 v56, v23, v116
    v_pk_mul_f16 v57, v24, v117
    v_pk_mul_f16 v58, v25, v118
    v_pk_mul_f16 v59, v26, v119
    v_mfma_f32_32x32x16_f16 v[150:165], v[60:63], v[52:55], v[150:165]
    ds_read_b128 v[72:75], v4 offset:16416
    v_pk_mul_f16 v46, v36, v129
    v_pk_mul_f16 v47, v37, v130
    v_pk_mul_f16 v48, v38, v131
    v_pk_mul_f16 v49, v39, v132
    s_waitcnt lgkmcnt(2)
    v_mfma_f32_32x32x16_f16 v[134:149], v[64:67], v[56:59], v[134:149]
    v_pk_mul_f16 v52, v27, v120
    v_pk_mul_f16 v53, v28, v108
    v_pk_mul_f16 v54, v29, v109
    v_pk_mul_f16 v55, v30, v110
    v_mfma_f32_32x32x16_f16 v[150:165], v[64:67], v[46:49], v[150:165]
    ds_read_b128 v[60:63], v4 offset:17280
    v_pk_mul_f16 v56, v40, v133
    v_pk_mul_f16 v57, v41, v121
    v_pk_mul_f16 v58, v42, v122
    v_pk_mul_f16 v59, v43, v123
    s_waitcnt lgkmcnt(2)
    v_mfma_f32_32x32x16_f16 v[134:149], v[68:71], v[52:55], v[134:149]
    v_pk_mul_f16 v46, v31, v111
    v_pk_mul_f16 v47, v32, v112
    v_pk_mul_f16 v48, v20, v114
    v_pk_mul_f16 v49, v21, v115
    v_mfma_f32_32x32x16_f16 v[150:165], v[68:71], v[56:59], v[150:165]
    ds_read_b128 v[64:67], v4 offset:18144
    v_pk_mul_f16 v52, v44, v124
    v_pk_mul_f16 v53, v45, v125
    v_pk_mul_f16 v54, v33, v127
    v_pk_mul_f16 v55, v34, v128
    s_waitcnt lgkmcnt(2)
    v_mfma_f32_32x32x16_f16 v[134:149], v[72:75], v[46:49], v[134:149]
    v_pk_mul_f16 v56, v22, v116
    v_pk_mul_f16 v57, v23, v117
    v_pk_mul_f16 v58, v24, v118
    v_pk_mul_f16 v59, v25, v119
    v_mfma_f32_32x32x16_f16 v[150:165], v[72:75], v[52:55], v[150:165]
    ds_read_b128 v[68:71], v4 offset:19008
    v_pk_mul_f16 v46, v35, v129
    v_pk_mul_f16 v47, v36, v130
    v_pk_mul_f16 v48, v37, v131
    v_pk_mul_f16 v49, v38, v132
    s_waitcnt lgkmcnt(2)
    v_mfma_f32_32x32x16_f16 v[134:149], v[60:63], v[56:59], v[134:149]
    v_pk_mul_f16 v52, v26, v120
    v_pk_mul_f16 v53, v27, v108
    v_pk_mul_f16 v54, v28, v109
    v_pk_mul_f16 v55, v29, v110
    v_mfma_f32_32x32x16_f16 v[150:165], v[60:63], v[46:49], v[150:165]
    v_pk_mul_f16 v56, v39, v133
    v_pk_mul_f16 v57, v40, v121
    v_pk_mul_f16 v58, v41, v122
    v_pk_mul_f16 v59, v42, v123
    s_waitcnt lgkmcnt(1)
    v_mfma_f32_32x32x16_f16 v[134:149], v[64:67], v[52:55], v[134:149]
    v_pk_mul_f16 v46, v30, v111
    v_pk_mul_f16 v47, v31, v112
    v_pk_mul_f16 v48, v32, v113
    v_mov_b32 v49, 0
    v_mfma_f32_32x32x16_f16 v[150:165], v[64:67], v[56:59], v[150:165]
    v_pk_mul_f16 v52, v43, v124
    v_pk_mul_f16 v53, v44, v125
    v_pk_mul_f16 v54, v45, v126
    v_mov_b32 v55, 0
    s_waitcnt lgkmcnt(0)
    v_mfma_f32_32x32x16_f16 v[134:149], v[68:71], v[46:49], v[134:149]
    v_mfma_f32_32x32x16_f16 v[150:165], v[68:71], v[52:55], v[150:165]
    s_lshl_b32 s28, s35, 3
    s_add_u32 s28, s28, 162816
    v_and_b32 v3, 3, v1
    v_lshl_add_u32 v3, v3, 6, s28
    s_mov_b32 s60, 1048576
L_w17:
    ds_read_b32 v7, v6 offset:24
    s_waitcnt lgkmcnt(0)
    v_readfirstlane_b32 s61, v7
    s_nop 0
    s_cmp_ge_u32 s61, 16
    s_cbranch_scc1 L_d18
    s_sub_u32 s60, s60, 1
    s_cbranch_scc1 L_d18
    s_sleep 2
    s_branch L_w17
L_d18:
    ds_read_b64 v[46:47], v3
    s_mov_b32 s16, s80
    s_mov_b32 s17, s81
    s_mov_b32 s18, 0x2000
    s_mov_b32 s19, 0x20000
    s_lshl_b32 s28, s36, 1
    v_mov_b32 v3, s28
    v_mul_f32 v16, v134, v76
    v_fmac_f32 v16, v135, v77
    v_fmac_f32 v16, v136, v78
    v_fmac_f32 v16, v137, v79
    v_fmac_f32 v16, v138, v80
    v_fmac_f32 v16, v139, v81
    v_fmac_f32 v16, v140, v82
    v_fmac_f32 v16, v141, v83
    v_fmac_f32 v16, v142, v84
    v_fmac_f32 v16, v143, v85
    v_fmac_f32 v16, v144, v86
    v_fmac_f32 v16, v145, v87
    v_fmac_f32 v16, v146, v88
    v_ldexp_f32 v16, v16, v8
    v_add_f32 v12, v12, v16
    v_mul_f32 v19, v150, v92
    v_fmac_f32 v19, v151, v93
    v_fmac_f32 v19, v152, v94
    v_fmac_f32 v19, v153, v95
    v_fmac_f32 v19, v154, v96
    v_fmac_f32 v19, v155, v97
    v_fmac_f32 v19, v156, v98
    v_fmac_f32 v19, v157, v99
    v_fmac_f32 v19, v158, v100
    v_fmac_f32 v19, v159, v101
    v_fmac_f32 v19, v160, v102
    v_fmac_f32 v19, v161, v103
    v_fmac_f32 v19, v162, v104
    v_ldexp_f32 v19, v19, v9
    v_add_f32 v13, v13, v19
    s_waitcnt lgkmcnt(0)
    s_mov_b64 exec, 15
    v_add_f32 v12, v12, v46
    v_add_f32 v13, v13, v47
    s_mov_b64 exec, -1
    v_add_f32_dpp v12, v12, v12 row_shr:1 row_mask:0xf bank_mask:0xf bound_ctrl:0
    v_add_f32_dpp v13, v13, v13 row_shr:1 row_mask:0xf bank_mask:0xf bound_ctrl:0
    s_nop 0
    v_add_f32_dpp v12, v12, v12 row_shr:2 row_mask:0xf bank_mask:0xf bound_ctrl:0
    v_add_f32_dpp v13, v13, v13 row_shr:2 row_mask:0xf bank_mask:0xf bound_ctrl:0
    s_nop 0
    v_add_f32_dpp v12, v12, v12 row_shr:4 row_mask:0xf bank_mask:0xf bound_ctrl:0
    v_add_f32_dpp v13, v13, v13 row_shr:4 row_mask:0xf bank_mask:0xf bound_ctrl:0
    s_nop 0
    v_add_f32_dpp v12, v12, v12 row_shr:8 row_mask:0xf bank_mask:0xf bound_ctrl:0
    v_add_f32_dpp v13, v13, v13 row_shr:8 row_mask:0xf bank_mask:0xf bound_ctrl:0
    s_nop 0
    v_add_f32_dpp v12, v12, v12 row_bcast:15 row_mask:0xa bank_mask:0xf
    v_add_f32_dpp v13, v13, v13 row_bcast:15 row_mask:0xa bank_mask:0xf
    s_nop 0
    v_add_f32_dpp v12, v12, v12 row_bcast:31 row_mask:0xc bank_mask:0xf
    v_add_f32_dpp v13, v13, v13 row_bcast:31 row_mask:0xc bank_mask:0xf
    v_cvt_pk_bf16_f32 v2, v12, v13
    v_cmp_eq_u32 vcc, 63, v1
    s_nop 0
    s_and_saveexec_b64 s[6:7], vcc
    buffer_store_dword v2, v3, s[16:19], 0 offen
L_end:
    s_endpgm
L_dnn:
    s_cmp_lt_u32 s2, 6
    s_cbranch_scc1 L_xg_late
    s_lshl_b32 s7, s3, 2
    v_add_u32 v4, s7, v28
    s_waitcnt vmcnt(0)
    s_mov_b64 exec, 1
    ds_add_u32 v4, v29 offset:48
    s_mov_b64 exec, -1
    v_lshl_add_u32 v154, v154, 6, v23
    s_add_u32 m0, s63, 139680
    s_nop 0
    buffer_load_dwordx4 v154, s[8:11], 0 offen nt lds
    v_lshl_add_u32 v155, v155, 6, v23
    s_add_u32 m0, s63, 140704
    s_nop 0
    buffer_load_dwordx4 v155, s[8:11], 0 offen nt lds
    v_lshl_add_u32 v156, v156, 6, v23
    s_add_u32 m0, s63, 141728
    s_nop 0
    buffer_load_dwordx4 v156, s[8:11], 0 offen nt lds
    v_lshl_add_u32 v157, v157, 6, v23
    s_add_u32 m0, s63, 142752
    s_nop 0
    buffer_load_dwordx4 v157, s[8:11], 0 offen nt lds
    s_waitcnt vmcnt(0)
    s_mov_b64 exec, 1
    ds_add_u32 v4, v29 offset:48
    s_mov_b64 exec, -1
L_xg_late:
    s_mov_b32 s8, s68
    s_mov_b32 s9, s69
    s_mov_b32 s10, 0x337e0
    s_mov_b32 s11, 0x20000
    s_mov_b32 s12, s84
    s_mov_b32 s13, s85
    s_mov_b32 s14, 0x22590
    s_mov_b32 s15, 0x20000
    v_mov_b32 v9, 0x7ffffff0
    v_mov_b32 v8, 0
    s_setprio 3
    s_add_u32 s24, s84, 0x40000
    s_addc_u32 s25, s85, 0
    s_mov_b32 s26, 0x38000
    s_mov_b32 s27, 0x20000
    v_mov_b32 v24, -1
    v_mov_b32 v25, -1
    v_mov_b32 v26, -1
    v_mov_b32 v27, -1
    s_mul_i32 s20, s62, 7168
    v_lshlrev_b32 v10, 4, v0
    buffer_store_dwordx4 v[24:27], v10, s[24:27], s20 offen sc0 sc1
    v_add_u32 v10, 4096, v10
    v_cmp_gt_u32 vcc, 192, v0
    s_nop 1
    v_cndmask_b32 v10, v9, v10, vcc
    buffer_store_dwordx4 v[24:27], v10, s[24:27], s20 offen sc0 sc1
    s_cmp_ge_u32 s62, 6
    s_cbranch_scc1 L_prep_c
    s_cmp_ge_u32 s62, 4
    s_cbranch_scc1 L_prep_a
    v_mul_u32_u24 v11, 1214, v1
    v_lshrrev_b32 v11, 16, v11
    v_mul_u32_u24 v14, 54, v11
    v_sub_u32 v13, v1, v14
    v_mul_u32_u24 v12, 38, v13
    v_lshrrev_b32 v12, 10, v12
    v_mul_u32_u24 v14, 27, v12
    v_sub_u32 v13, v13, v14
    v_cmp_ne_u32 s[18:19], 13, v13
    v_add_u32 v14, 2, v13
    v_lshrrev_b32 v14, 4, v14
    v_mul_u32_u24 v15, 14, v14
    v_sub_u32 v13, v13, v15
    v_min_u32 v13, 12, v13
    v_lshrrev_b32 v15, 1, v13
    v_xor_b32 v15, v15, v13
    v_bfe_u32 v15, v15, 2, 1
    v_xor_b32 v14, v14, v15
    v_mad_u32_u24 v13, v14, 13, v13
    v_cmp_gt_u32 vcc, 54, v1
    s_nop 0
    s_and_b64 s[18:19], s[18:19], vcc
    v_mul_u32_u24 v13, 1352, v13
    v_mul_u32_u24 v14, 676, v12
    v_add_u32 v10, v13, v14
    v_cndmask_b32 v10, v9, v10, s[18:19]
    s_mul_i32 s16, s62, 11
    s_add_u32 s16, s16, s3
    s_lshl_b32 s17, s16, 4
    s_add_u32 s17, s17, 35152
    s_lshr_b32 s20, s62, 1
    s_and_b32 s20, s20, s62
    s_add_u32 s20, s20, s3
    s_cmp_lt_u32 s20, 3
    s_cselect_b32 s21, 0, 0x40000000
    s_add_u32 s22, s17, s21
    buffer_load_dwordx4 v[68:71], v10, s[8:11], s17 offen offset:0
    buffer_load_dwordx4 v[72:75], v10, s[8:11], s17 offen offset:64
    buffer_load_dwordx4 v[76:79], v10, s[8:11], s22 offen offset:128
    v_lshlrev_b32 v20, 4, v1
    v_cmp_gt_u32 vcc, 54, v1
    s_nop 1
    v_cndmask_b32 v10, v9, v20, vcc
    s_cmp_eq_u32 s16, 34
    s_cselect_b32 s23, 0, -1
    s_mul_i32 s19, s16, 864
    s_add_u32 s19, s19, 16
    s_waitcnt vmcnt(5)
    v_and_b32 v15, 0x7fff7fff, v32
    v_and_b32 v14, 0x7fff7fff, v33
    v_pk_max_u16 v15, v15, v14
    v_and_b32 v14, 0x7fff7fff, v34
    v_pk_max_u16 v15, v15, v14
    v_and_b32 v14, 0x7fff7fff, v35
    v_pk_max_u16 v15, v15, v14
    v_and_b32 v14, 0x7fff7fff, v36
    v_pk_max_u16 v15, v15, v14
    v_and_b32 v14, 0x7fff7fff, v37
    v_pk_max_u16 v15, v15, v14
    v_and_b32 v14, 0x7fff7fff, v38
    v_pk_max_u16 v15, v15, v14
    v_and_b32 v14, 0x7fff7fff, v39
    v_pk_max_u16 v15, v15, v14
    v_and_b32 v14, 0x7fff7fff, v40
    v_pk_max_u16 v15, v15, v14
    v_and_b32 v14, 0x7fff7fff, v41
    v_pk_max_u16 v15, v15, v14
    v_and_b32 v14, 0x7fff7fff, v42
    v_pk_max_u16 v15, v15, v14
    v_and_b32 v14, 0x7fff7fff, v43
    v_pk_max_u16 v15, v15, v14
    v_and_b32 v14, 0x7fff7fff, v44
    v_pk_max_u16 v15, v15, v14
    v_and_b32 v14, 0x7fff7fff, v45
    v_pk_max_u16 v15, v15, v14
    v_and_b32 v14, 0x7fff7fff, v46
    v_pk_max_u16 v15, v15, v14
    v_and_b32 v14, 0x7fff7fff, v47
    v_pk_max_u16 v15, v15, v14
    v_and_b32 v14, 0x7fff7fff, v48
    v_pk_max_u16 v15, v15, v14
    v_and_b32 v14, 0x7fff7fff, v49
    v_pk_max_u16 v15, v15, v14
    v_and_b32 v14, 0x7fff7fff, v50
    v_pk_max_u16 v15, v15, v14
    v_and_b32 v14, 0x7fff7fff, v51
    v_pk_max_u16 v15, v15, v14
    v_and_b32 v14, 0x7fff7fff, v52
    v_pk_max_u16 v15, v15, v14
    v_and_b32 v14, 0x7fff7fff, v53
    v_pk_max_u16 v15, v15, v14
    v_and_b32 v14, 0x7fff7fff, v54
    v_pk_max_u16 v15, v15, v14
    v_and_b32 v14, 0x7fff7fff, v55
    v_pk_max_u16 v15, v15, v14
    v_and_b32 v14, 0x7fff7fff, v56
    v_pk_max_u16 v15, v15, v14
    v_and_b32 v14, 0x7fff7fff, v57
    v_pk_max_u16 v15, v15, v14
    v_and_b32 v14, 0x7fff7fff, v58
    v_pk_max_u16 v15, v15, v14
    v_and_b32 v14, 0x7fff7fff, v59
    v_pk_max_u16 v15, v15, v14
    v_and_b32 v14, 0x7fff7fff, v60
    v_pk_max_u16 v15, v15, v14
    v_and_b32 v14, 0x7fff7fff, v61
    v_pk_max_u16 v15, v15, v14
    v_and_b32 v14, 0x7fff7fff, v62
    v_pk_max_u16 v15, v15, v14
    v_and_b32 v14, 0x7fff7fff, v63
    v_pk_max_u16 v15, v15, v14
    v_and_b32 v14, 0x7fff7fff, v64
    v_pk_max_u16 v15, v15, v14
    v_and_b32 v14, 0x7fff7fff, v65
    v_pk_max_u16 v15, v15, v14
    v_and_b32 v14, 0x7fff7fff, v66
    v_pk_max_u16 v15, v15, v14
    v_and_b32 v14, 0x7fff7fff, v67
    v_pk_max_u16 v15, v15, v14
    v_lshrrev_b32 v14, 16, v15
    v_and_b32 v15, 0xffff, v15
    v_max_u32 v15, v15, v14
    s_nop 1
    v_max_u32_dpp v15, v15, v15 row_shr:1 row_mask:0xf bank_mask:0xf
    s_nop 1
    v_max_u32_dpp v15, v15, v15 row_shr:2 row_mask:0xf bank_mask:0xf
    s_nop 1
    v_max_u32_dpp v15, v15, v15 row_shr:4 row_mask:0xf bank_mask:0xf
    s_nop 1
    v_max_u32_dpp v15, v15, v15 row_shr:8 row_mask:0xf bank_mask:0xf
    s_nop 1
    v_max_u32_dpp v15, v15, v15 row_bcast:15 row_mask:0xa bank_mask:0xf
    s_nop 1
    v_max_u32_dpp v15, v15, v15 row_bcast:31 row_mask:0xc bank_mask:0xf
    s_nop 0
    v_readlane_b32 s6, v15, 63
    s_lshl_b32 s7, s3, 2
    v_add_u32 v14, s7, v8
    v_mov_b32 v15, s6
    ds_write_b32 v14, v15 offset:0
    s_waitcnt lgkmcnt(0)
    s_mov_b64 exec, 1
    ds_add_u32 v28, v29 offset:20
    s_mov_b64 exec, -1
    s_mov_b32 s60, 1048576
L_w19:
    ds_read_b32 v2, v28 offset:20
    s_waitcnt lgkmcnt(0)
    v_readfirstlane_b32 s61, v2
    s_nop 0
    s_cmp_ge_u32 s61, 4
    s_cbranch_scc1 L_d20
    s_sub_u32 s60, s60, 1
    s_cbranch_scc1 L_d20
    s_branch L_w19
L_d20:
    ds_read_b128 v[16:19], v8
    s_waitcnt vmcnt(0) lgkmcnt(0)
    v_max3_u32 v16, v16, v17, v18
    v_max_u32 v16, v16, v19
    s_nop 0
    v_readfirstlane_b32 s17, v16
    s_nop 0
    s_lshr_b32 s17, s17, 7
    s_sub_i32 s17, 124, s17
    s_min_i32 s17, s17, 126
    s_max_i32 s17, s17, -120
    s_add_i32 s20, s17, 127
    s_lshl_b32 s20, s20, 23
    v_and_b32 v77, s23, v77
    v_and_b32 v78, s23, v78
    v_and_b32 v79, s23, v79
    v_lshlrev_b32 v16, 16, v68
    v_lshlrev_b32 v17, 16, v69
    v_lshlrev_b32 v18, 16, v70
    v_lshlrev_b32 v19, 16, v71
    v_and_b32 v68, 0xffff0000, v68
    v_and_b32 v69, 0xffff0000, v69
    v_and_b32 v70, 0xffff0000, v70
    v_and_b32 v71, 0xffff0000, v71
    v_mul_f32 v16, s20, v16
    v_mul_f32 v17, s20, v17
    v_mul_f32 v18, s20, v18
    v_mul_f32 v19, s20, v19
    v_mul_f32 v68, s20, v68
    v_mul_f32 v69, s20, v69
    v_mul_f32 v70, s20, v70
    v_mul_f32 v71, s20, v71
    v_cvt_pk_f16_f32 v68, v16, v68
    v_cvt_pk_f16_f32 v69, v17, v69
    v_cvt_pk_f16_f32 v70, v18, v70
    v_cvt_pk_f16_f32 v71, v19, v71
    s_add_u32 s22, s19, 0
    buffer_store_dwordx4 v[68:71], v10, s[12:15], s22 offen sc1
    v_lshlrev_b32 v16, 16, v72
    v_lshlrev_b32 v17, 16, v73
    v_lshlrev_b32 v18, 16, v74
    v_lshlrev_b32 v19, 16, v75
    v_and_b32 v72, 0xffff0000, v72
    v_and_b32 v73, 0xffff0000, v73
    v_and_b32 v74, 0xffff0000, v74
    v_and_b32 v75, 0xffff0000, v75
    v_mul_f32 v16, s20, v16
    v_mul_f32 v17, s20, v17
    v_mul_f32 v18, s20, v18
    v_mul_f32 v19, s20, v19
    v_mul_f32 v72, s20, v72
    v_mul_f32 v73, s20, v73
    v_mul_f32 v74, s20, v74
    v_mul_f32 v75, s20, v75
    v_cvt_pk_f16_f32 v72, v16, v72
    v_cvt_pk_f16_f32 v73, v17, v73
    v_cvt_pk_f16_f32 v74, v18, v74
    v_cvt_pk_f16_f32 v75, v19, v75
    s_add_u32 s22, s19, 3456
    buffer_store_dwordx4 v[72:75], v10, s[12:15], s22 offen sc1
    v_lshlrev_b32 v16, 16, v76
    v_lshlrev_b32 v17, 16, v77
    v_lshlrev_b32 v18, 16, v78
    v_lshlrev_b32 v19, 16, v79
    v_and_b32 v76, 0xffff0000, v76
    v_and_b32 v77, 0xffff0000, v77
    v_and_b32 v78, 0xffff0000, v78
    v_and_b32 v79, 0xffff0000, v79
    v_mul_f32 v16, s20, v16
    v_mul_f32 v17, s20, v17
    v_mul_f32 v18, s20, v18
    v_mul_f32 v19, s20, v19
    v_mul_f32 v76, s20, v76
    v_mul_f32 v77, s20, v77
    v_mul_f32 v78, s20, v78
    v_mul_f32 v79, s20, v79
    v_cvt_pk_f16_f32 v76, v16, v76
    v_cvt_pk_f16_f32 v77, v17, v77
    v_cvt_pk_f16_f32 v78, v18, v78
    v_cvt_pk_f16_f32 v79, v19, v79
    s_add_u32 s22, s19, 6912
    s_add_u32 s22, s22, s21
    buffer_store_dwordx4 v[76:79], v10, s[12:15], s22 offen sc1
    v_mov_b32 v16, s17
    v_mov_b32 v17, 0
    v_mov_b32 v18, 0
    v_mov_b32 v19, 0
    s_mov_b64 exec, 1
    buffer_store_dwordx4 v[16:19], v8, s[12:15], 0 offen sc1
    s_mov_b64 exec, -1
    s_waitcnt vmcnt(0)
    v_mov_b32 v4, 2
    s_mov_b64 exec, 1
    ds_add_u32 v28, v4 offset:20
    s_mov_b64 exec, -1
    s_branch L_prep_af
L_prep_a:
    v_lshlrev_b32 v20, 4, v1
    v_mul_u32_u24 v11, 1214, v1
    v_lshrrev_b32 v11, 16, v11
    v_mul_u32_u24 v14, 54, v11
    v_sub_u32 v13, v1, v14
    v_mul_u32_u24 v12, 38, v13
    v_lshrrev_b32 v12, 10, v12
    v_mul_u32_u24 v14, 27, v12
    v_sub_u32 v13, v13, v14
    v_cmp_ne_u32 s[18:19], 13, v13
    v_add_u32 v14, 2, v13
    v_lshrrev_b32 v14, 4, v14
    v_mul_u32_u24 v15, 14, v14
    v_sub_u32 v13, v13, v15
    v_min_u32 v13, 12, v13
    v_lshrrev_b32 v15, 1, v13
    v_xor_b32 v15, v15, v13
    v_bfe_u32 v15, v15, 2, 1
    v_xor_b32 v14, v14, v15
    v_mad_u32_u24 v13, v14, 13, v13
    v_cmp_gt_u32 vcc, 54, v1
    s_nop 0
    s_and_b64 s[18:19], s[18:19], vcc
    v_mul_u32_u24 v13, 1352, v13
    v_mul_u32_u24 v14, 676, v12
    v_add_u32 v10, v13, v14
    v_cndmask_b32 v10, v8, v10, s[18:19]
    s_lshl_b32 s17, s3, 4
    s_add_u32 s17, s17, 1024
    v_add_u32 v10, s17, v10
    s_waitcnt vmcnt(0)
    s_mov_b64 exec, 1
    ds_add_u32 v28, v29 offset:20
    s_mov_b64 exec, -1
    s_mov_b32 s60, 1048576
L_w21:
    ds_read_b32 v2, v28 offset:20
    s_waitcnt lgkmcnt(0)
    v_readfirstlane_b32 s61, v2
    s_nop 0
    s_cmp_ge_u32 s61, 4
    s_cbranch_scc1 L_d22
    s_sub_u32 s60, s60, 1
    s_cbranch_scc1 L_d22
    s_branch L_w21
L_d22:
    ds_read2_b32 v[32:33], v10 offset0:0 offset1:1
    ds_read2_b32 v[34:35], v10 offset0:2 offset1:3
    ds_read2_b32 v[36:37], v10 offset0:16 offset1:17
    ds_read2_b32 v[38:39], v10 offset0:18 offset1:19
    ds_read2_b32 v[40:41], v10 offset0:32 offset1:33
    ds_read2_b32 v[42:43], v10 offset0:34 offset1:35
    ds_read2_b32 v[44:45], v10 offset0:48 offset1:49
    ds_read2_b32 v[46:47], v10 offset0:50 offset1:51
    ds_read2_b32 v[48:49], v10 offset0:64 offset1:65
    ds_read2_b32 v[50:51], v10 offset0:66 offset1:67
    ds_read2_b32 v[52:53], v10 offset0:80 offset1:81
    ds_read2_b32 v[54:55], v10 offset0:82 offset1:83
    ds_read2_b32 v[56:57], v10 offset0:96 offset1:97
    ds_read2_b32 v[58:59], v10 offset0:98 offset1:99
    ds_read2_b32 v[60:61], v10 offset0:112 offset1:113
    ds_read2_b32 v[62:63], v10 offset0:114 offset1:115
    ds_read2_b32 v[64:65], v10 offset0:128 offset1:129
    ds_read2_b32 v[66:67], v10 offset0:130 offset1:131
    ds_read2_b32 v[68:69], v10 offset0:144 offset1:145
    ds_read2_b32 v[70:71], v10 offset0:146 offset1:147
    ds_read2_b32 v[72:73], v10 offset0:160 offset1:161
    ds_read2_b32 v[74:75], v10 offset0:162 offset1:163
    s_cmp_lt_u32 s3, 2
    s_cselect_b32 s17, -1, 0
    s_cmp_lt_u32 s3, 3
    s_cselect_b32 s20, -1, 0
    s_waitcnt lgkmcnt(0)
    v_and_b32 v72, s20, v72
    v_and_b32 v73, s17, v73
    v_and_b32 v74, s17, v74
    v_and_b32 v75, s17, v75
    v_and_b32 v15, 0x7fff7fff, v32
    v_and_b32 v14, 0x7fff7fff, v33
    v_pk_max_u16 v15, v15, v14
    v_and_b32 v14, 0x7fff7fff, v34
    v_pk_max_u16 v15, v15, v14
    v_and_b32 v14, 0x7fff7fff, v35
    v_pk_max_u16 v15, v15, v14
    v_and_b32 v14, 0x7fff7fff, v36
    v_pk_max_u16 v15, v15, v14
    v_and_b32 v14, 0x7fff7fff, v37
    v_pk_max_u16 v15, v15, v14
    v_and_b32 v14, 0x7fff7fff, v38
    v_pk_max_u16 v15, v15, v14
    v_and_b32 v14, 0x7fff7fff, v39
    v_pk_max_u16 v15, v15, v14
    v_and_b32 v14, 0x7fff7fff, v40
    v_pk_max_u16 v15, v15, v14
    v_and_b32 v14, 0x7fff7fff, v41
    v_pk_max_u16 v15, v15, v14
    v_and_b32 v14, 0x7fff7fff, v42
    v_pk_max_u16 v15, v15, v14
    v_and_b32 v14, 0x7fff7fff, v43
    v_pk_max_u16 v15, v15, v14
    v_and_b32 v14, 0x7fff7fff, v44
    v_pk_max_u16 v15, v15, v14
    v_and_b32 v14, 0x7fff7fff, v45
    v_pk_max_u16 v15, v15, v14
    v_and_b32 v14, 0x7fff7fff, v46
    v_pk_max_u16 v15, v15, v14
    v_and_b32 v14, 0x7fff7fff, v47
    v_pk_max_u16 v15, v15, v14
    v_and_b32 v14, 0x7fff7fff, v48
    v_pk_max_u16 v15, v15, v14
    v_and_b32 v14, 0x7fff7fff, v49
    v_pk_max_u16 v15, v15, v14
    v_and_b32 v14, 0x7fff7fff, v50
    v_pk_max_u16 v15, v15, v14
    v_and_b32 v14, 0x7fff7fff, v51
    v_pk_max_u16 v15, v15, v14
    v_and_b32 v14, 0x7fff7fff, v52
    v_pk_max_u16 v15, v15, v14
    v_and_b32 v14, 0x7fff7fff, v53
    v_pk_max_u16 v15, v15, v14
    v_and_b32 v14, 0x7fff7fff, v54
    v_pk_max_u16 v15, v15, v14
    v_and_b32 v14, 0x7fff7fff, v55
    v_pk_max_u16 v15, v15, v14
    v_and_b32 v14, 0x7fff7fff, v56
    v_pk_max_u16 v15, v15, v14
    v_and_b32 v14, 0x7fff7fff, v57
    v_pk_max_u16 v15, v15, v14
    v_and_b32 v14, 0x7fff7fff, v58
    v_pk_max_u16 v15, v15, v14
    v_and_b32 v14, 0x7fff7fff, v59
    v_pk_max_u16 v15, v15, v14
    v_and_b32 v14, 0x7fff7fff, v60
    v_pk_max_u16 v15, v15, v14
    v_and_b32 v14, 0x7fff7fff, v61
    v_pk_max_u16 v15, v15, v14
    v_and_b32 v14, 0x7fff7fff, v62
    v_pk_max_u16 v15, v15, v14
    v_and_b32 v14, 0x7fff7fff, v63
    v_pk_max_u16 v15, v15, v14
    v_and_b32 v14, 0x7fff7fff, v64
    v_pk_max_u16 v15, v15, v14
    v_and_b32 v14, 0x7fff7fff, v65
    v_pk_max_u16 v15, v15, v14
    v_and_b32 v14, 0x7fff7fff, v66
    v_pk_max_u16 v15, v15, v14
    v_and_b32 v14, 0x7fff7fff, v67
    v_pk_max_u16 v15, v15, v14
    v_and_b32 v14, 0x7fff7fff, v68
    v_pk_max_u16 v15, v15, v14
    v_and_b32 v14, 0x7fff7fff, v69
    v_pk_max_u16 v15, v15, v14
    v_and_b32 v14, 0x7fff7fff, v70
    v_pk_max_u16 v15, v15, v14
    v_and_b32 v14, 0x7fff7fff, v71
    v_pk_max_u16 v15, v15, v14
    v_and_b32 v14, 0x7fff7fff, v72
    v_pk_max_u16 v15, v15, v14
    v_and_b32 v14, 0x7fff7fff, v73
    v_pk_max_u16 v15, v15, v14
    v_and_b32 v14, 0x7fff7fff, v74
    v_pk_max_u16 v15, v15, v14
    v_and_b32 v14, 0x7fff7fff, v75
    v_pk_max_u16 v15, v15, v14
    v_lshrrev_b32 v14, 16, v15
    v_and_b32 v15, 0xffff, v15
    v_max_u32 v15, v15, v14
    s_nop 1
    v_max_u32_dpp v15, v15, v15 row_shr:1 row_mask:0xf bank_mask:0xf
    s_nop 1
    v_max_u32_dpp v15, v15, v15 row_shr:2 row_mask:0xf bank_mask:0xf
    s_nop 1
    v_max_u32_dpp v15, v15, v15 row_shr:4 row_mask:0xf bank_mask:0xf
    s_nop 1
    v_max_u32_dpp v15, v15, v15 row_shr:8 row_mask:0xf bank_mask:0xf
    s_nop 1
    v_max_u32_dpp v15, v15, v15 row_bcast:15 row_mask:0xa bank_mask:0xf
    s_nop 1
    v_max_u32_dpp v15, v15, v15 row_bcast:31 row_mask:0xc bank_mask:0xf
    s_nop 0
    v_readlane_b32 s6, v15, 63
    s_lshl_b32 s7, s3, 2
    v_add_u32 v14, s7, v8
    v_mov_b32 v15, s6
    ds_write_b32 v14, v15 offset:0
    s_waitcnt lgkmcnt(0)
    s_mov_b64 exec, 1
    ds_add_u32 v28, v29 offset:20
    s_mov_b64 exec, -1
    s_mov_b32 s60, 1048576
L_w23:
    ds_read_b32 v2, v28 offset:20
    s_waitcnt lgkmcnt(0)
    v_readfirstlane_b32 s61, v2
    s_nop 0
    s_cmp_ge_u32 s61, 8
    s_cbranch_scc1 L_d24
    s_sub_u32 s60, s60, 1
    s_cbranch_scc1 L_d24
    s_branch L_w23
L_d24:
    ds_read_b128 v[16:19], v8
    s_waitcnt lgkmcnt(0)
    v_max3_u32 v16, v16, v17, v18
    v_max_u32 v16, v16, v19
    s_nop 0
    v_readfirstlane_b32 s17, v16
    s_nop 0
    s_lshr_b32 s17, s17, 7
    s_sub_i32 s17, 124, s17
    s_min_i32 s17, s17, 126
    s_max_i32 s17, s17, -120
    s_add_i32 s20, s17, 127
    s_lshl_b32 s20, s20, 23
    v_mov_b32 v21, s20
    v_cndmask_b32 v21, 0, v21, s[18:19]
    v_cmp_gt_u32 vcc, 54, v1
    s_nop 1
    v_cndmask_b32 v10, v9, v20, vcc
    s_mov_b32 s19, 40976
    s_cmp_eq_u32 s62, 5
    s_cselect_b32 s19, 81920, s19
    s_mul_i32 s18, s3, 864
    s_add_u32 s19, s19, s18
    v_lshlrev_b32 v16, 16, v32
    v_lshlrev_b32 v17, 16, v33
    v_lshlrev_b32 v18, 16, v34
    v_lshlrev_b32 v19, 16, v35
    v_and_b32 v32, 0xffff0000, v32
    v_and_b32 v33, 0xffff0000, v33
    v_and_b32 v34, 0xffff0000, v34
    v_and_b32 v35, 0xffff0000, v35
    v_mul_f32 v16, v21, v16
    v_mul_f32 v17, v21, v17
    v_mul_f32 v18, v21, v18
    v_mul_f32 v19, v21, v19
    v_mul_f32 v32, v21, v32
    v_mul_f32 v33, v21, v33
    v_mul_f32 v34, v21, v34
    v_mul_f32 v35, v21, v35
    v_cvt_pk_f16_f32 v32, v16, v32
    v_cvt_pk_f16_f32 v33, v17, v33
    v_cvt_pk_f16_f32 v34, v18, v34
    v_cvt_pk_f16_f32 v35, v19, v35
    s_add_u32 s20, s19, 0
    buffer_store_dwordx4 v[32:35], v10, s[12:15], s20 offen sc1
    v_lshlrev_b32 v16, 16, v36
    v_lshlrev_b32 v17, 16, v37
    v_lshlrev_b32 v18, 16, v38
    v_lshlrev_b32 v19, 16, v39
    v_and_b32 v36, 0xffff0000, v36
    v_and_b32 v37, 0xffff0000, v37
    v_and_b32 v38, 0xffff0000, v38
    v_and_b32 v39, 0xffff0000, v39
    v_mul_f32 v16, v21, v16
    v_mul_f32 v17, v21, v17
    v_mul_f32 v18, v21, v18
    v_mul_f32 v19, v21, v19
    v_mul_f32 v36, v21, v36
    v_mul_f32 v37, v21, v37
    v_mul_f32 v38, v21, v38
    v_mul_f32 v39, v21, v39
    v_cvt_pk_f16_f32 v36, v16, v36
    v_cvt_pk_f16_f32 v37, v17, v37
    v_cvt_pk_f16_f32 v38, v18, v38
    v_cvt_pk_f16_f32 v39, v19, v39
    s_add_u32 s20, s19, 3456
    buffer_store_dwordx4 v[36:39], v10, s[12:15], s20 offen sc1
    v_lshlrev_b32 v16, 16, v40
    v_lshlrev_b32 v17, 16, v41
    v_lshlrev_b32 v18, 16, v42
    v_lshlrev_b32 v19, 16, v43
    v_and_b32 v40, 0xffff0000, v40
    v_and_b32 v41, 0xffff0000, v41
    v_and_b32 v42, 0xffff0000, v42
    v_and_b32 v43, 0xffff0000, v43
    v_mul_f32 v16, v21, v16
    v_mul_f32 v17, v21, v17
    v_mul_f32 v18, v21, v18
    v_mul_f32 v19, v21, v19
    v_mul_f32 v40, v21, v40
    v_mul_f32 v41, v21, v41
    v_mul_f32 v42, v21, v42
    v_mul_f32 v43, v21, v43
    v_cvt_pk_f16_f32 v40, v16, v40
    v_cvt_pk_f16_f32 v41, v17, v41
    v_cvt_pk_f16_f32 v42, v18, v42
    v_cvt_pk_f16_f32 v43, v19, v43
    s_add_u32 s20, s19, 6912
    buffer_store_dwordx4 v[40:43], v10, s[12:15], s20 offen sc1
    v_lshlrev_b32 v16, 16, v44
    v_lshlrev_b32 v17, 16, v45
    v_lshlrev_b32 v18, 16, v46
    v_lshlrev_b32 v19, 16, v47
    v_and_b32 v44, 0xffff0000, v44
    v_and_b32 v45, 0xffff0000, v45
    v_and_b32 v46, 0xffff0000, v46
    v_and_b32 v47, 0xffff0000, v47
    v_mul_f32 v16, v21, v16
    v_mul_f32 v17, v21, v17
    v_mul_f32 v18, v21, v18
    v_mul_f32 v19, v21, v19
    v_mul_f32 v44, v21, v44
    v_mul_f32 v45, v21, v45
    v_mul_f32 v46, v21, v46
    v_mul_f32 v47, v21, v47
    v_cvt_pk_f16_f32 v44, v16, v44
    v_cvt_pk_f16_f32 v45, v17, v45
    v_cvt_pk_f16_f32 v46, v18, v46
    v_cvt_pk_f16_f32 v47, v19, v47
    s_add_u32 s20, s19, 10368
    buffer_store_dwordx4 v[44:47], v10, s[12:15], s20 offen sc1
    v_lshlrev_b32 v16, 16, v48
    v_lshlrev_b32 v17, 16, v49
    v_lshlrev_b32 v18, 16, v50
    v_lshlrev_b32 v19, 16, v51
    v_and_b32 v48, 0xffff0000, v48
    v_and_b32 v49, 0xffff0000, v49
    v_and_b32 v50, 0xffff0000, v50
    v_and_b32 v51, 0xffff0000, v51
    v_mul_f32 v16, v21, v16
    v_mul_f32 v17, v21, v17
    v_mul_f32 v18, v21, v18
    v_mul_f32 v19, v21, v19
    v_mul_f32 v48, v21, v48
    v_mul_f32 v49, v21, v49
    v_mul_f32 v50, v21, v50
    v_mul_f32 v51, v21, v51
    v_cvt_pk_f16_f32 v48, v16, v48
    v_cvt_pk_f16_f32 v49, v17, v49
    v_cvt_pk_f16_f32 v50, v18, v50
    v_cvt_pk_f16_f32 v51, v19, v51
    s_add_u32 s20, s19, 13824
    buffer_store_dwordx4 v[48:51], v10, s[12:15], s20 offen sc1
    v_lshlrev_b32 v16, 16, v52
    v_lshlrev_b32 v17, 16, v53
    v_lshlrev_b32 v18, 16, v54
    v_lshlrev_b32 v19, 16, v55
    v_and_b32 v52, 0xffff0000, v52
    v_and_b32 v53, 0xffff0000, v53
    v_and_b32 v54, 0xffff0000, v54
    v_and_b32 v55, 0xffff0000, v55
    v_mul_f32 v16, v21, v16
    v_mul_f32 v17, v21, v17
    v_mul_f32 v18, v21, v18
    v_mul_f32 v19, v21, v19
    v_mul_f32 v52, v21, v52
    v_mul_f32 v53, v21, v53
    v_mul_f32 v54, v21, v54
    v_mul_f32 v55, v21, v55
    v_cvt_pk_f16_f32 v52, v16, v52
    v_cvt_pk_f16_f32 v53, v17, v53
    v_cvt_pk_f16_f32 v54, v18, v54
    v_cvt_pk_f16_f32 v55, v19, v55
    s_add_u32 s20, s19, 17280
    buffer_store_dwordx4 v[52:55], v10, s[12:15], s20 offen sc1
    v_lshlrev_b32 v16, 16, v56
    v_lshlrev_b32 v17, 16, v57
    v_lshlrev_b32 v18, 16, v58
    v_lshlrev_b32 v19, 16, v59
    v_and_b32 v56, 0xffff0000, v56
    v_and_b32 v57, 0xffff0000, v57
    v_and_b32 v58, 0xffff0000, v58
    v_and_b32 v59, 0xffff0000, v59
    v_mul_f32 v16, v21, v16
    v_mul_f32 v17, v21, v17
    v_mul_f32 v18, v21, v18
    v_mul_f32 v19, v21, v19
    v_mul_f32 v56, v21, v56
    v_mul_f32 v57, v21, v57
    v_mul_f32 v58, v21, v58
    v_mul_f32 v59, v21, v59
    v_cvt_pk_f16_f32 v56, v16, v56
    v_cvt_pk_f16_f32 v57, v17, v57
    v_cvt_pk_f16_f32 v58, v18, v58
    v_cvt_pk_f16_f32 v59, v19, v59
    s_add_u32 s20, s19, 20736
    buffer_store_dwordx4 v[56:59], v10, s[12:15], s20 offen sc1
    v_lshlrev_b32 v16, 16, v60
    v_lshlrev_b32 v17, 16, v61
    v_lshlrev_b32 v18, 16, v62
    v_lshlrev_b32 v19, 16, v63
    v_and_b32 v60, 0xffff0000, v60
    v_and_b32 v61, 0xffff0000, v61
    v_and_b32 v62, 0xffff0000, v62
    v_and_b32 v63, 0xffff0000, v63
    v_mul_f32 v16, v21, v16
    v_mul_f32 v17, v21, v17
    v_mul_f32 v18, v21, v18
    v_mul_f32 v19, v21, v19
    v_mul_f32 v60, v21, v60
    v_mul_f32 v61, v21, v61
    v_mul_f32 v62, v21, v62
    v_mul_f32 v63, v21, v63
    v_cvt_pk_f16_f32 v60, v16, v60
    v_cvt_pk_f16_f32 v61, v17, v61
    v_cvt_pk_f16_f32 v62, v18, v62
    v_cvt_pk_f16_f32 v63, v19, v63
    s_add_u32 s20, s19, 24192
    buffer_store_dwordx4 v[60:63], v10, s[12:15], s20 offen sc1
    v_lshlrev_b32 v16, 16, v64
    v_lshlrev_b32 v17, 16, v65
    v_lshlrev_b32 v18, 16, v66
    v_lshlrev_b32 v19, 16, v67
    v_and_b32 v64, 0xffff0000, v64
    v_and_b32 v65, 0xffff0000, v65
    v_and_b32 v66, 0xffff0000, v66
    v_and_b32 v67, 0xffff0000, v67
    v_mul_f32 v16, v21, v16
    v_mul_f32 v17, v21, v17
    v_mul_f32 v18, v21, v18
    v_mul_f32 v19, v21, v19
    v_mul_f32 v64, v21, v64
    v_mul_f32 v65, v21, v65
    v_mul_f32 v66, v21, v66
    v_mul_f32 v67, v21, v67
    v_cvt_pk_f16_f32 v64, v16, v64
    v_cvt_pk_f16_f32 v65, v17, v65
    v_cvt_pk_f16_f32 v66, v18, v66
    v_cvt_pk_f16_f32 v67, v19, v67
    s_add_u32 s20, s19, 27648
    buffer_store_dwordx4 v[64:67], v10, s[12:15], s20 offen sc1
    v_lshlrev_b32 v16, 16, v68
    v_lshlrev_b32 v17, 16, v69
    v_lshlrev_b32 v18, 16, v70
    v_lshlrev_b32 v19, 16, v71
    v_and_b32 v68, 0xffff0000, v68
    v_and_b32 v69, 0xffff0000, v69
    v_and_b32 v70, 0xffff0000, v70
    v_and_b32 v71, 0xffff0000, v71
    v_mul_f32 v16, v21, v16
    v_mul_f32 v17, v21, v17
    v_mul_f32 v18, v21, v18
    v_mul_f32 v19, v21, v19
    v_mul_f32 v68, v21, v68
    v_mul_f32 v69, v21, v69
    v_mul_f32 v70, v21, v70
    v_mul_f32 v71, v21, v71
    v_cvt_pk_f16_f32 v68, v16, v68
    v_cvt_pk_f16_f32 v69, v17, v69
    v_cvt_pk_f16_f32 v70, v18, v70
    v_cvt_pk_f16_f32 v71, v19, v71
    s_add_u32 s20, s19, 31104
    buffer_store_dwordx4 v[68:71], v10, s[12:15], s20 offen sc1
    v_lshlrev_b32 v16, 16, v72
    v_lshlrev_b32 v17, 16, v73
    v_lshlrev_b32 v18, 16, v74
    v_lshlrev_b32 v19, 16, v75
    v_and_b32 v72, 0xffff0000, v72
    v_and_b32 v73, 0xffff0000, v73
    v_and_b32 v74, 0xffff0000, v74
    v_and_b32 v75, 0xffff0000, v75
    v_mul_f32 v16, v21, v16
    v_mul_f32 v17, v21, v17
    v_mul_f32 v18, v21, v18
    v_mul_f32 v19, v21, v19
    v_mul_f32 v72, v21, v72
    v_mul_f32 v73, v21, v73
    v_mul_f32 v74, v21, v74
    v_mul_f32 v75, v21, v75
    v_cvt_pk_f16_f32 v72, v16, v72
    v_cvt_pk_f16_f32 v73, v17, v73
    v_cvt_pk_f16_f32 v74, v18, v74
    v_cvt_pk_f16_f32 v75, v19, v75
    s_add_u32 s20, s19, 34560
    s_cmp_lt_u32 s3, 3
    s_cselect_b32 s20, s20, 0x40000000
    buffer_store_dwordx4 v[72:75], v10, s[12:15], s20 offen sc1
    s_mov_b32 s20, 40960
    s_cmp_eq_u32 s62, 5
    s_cselect_b32 s20, 140680, s20
    v_mov_b32 v16, s17
    v_mov_b32 v17, 0
    v_mov_b32 v18, 0
    v_mov_b32 v19, 0
    v_mov_b32 v12, s20
    s_mov_b64 exec, 1
    buffer_store_dwordx4 v[16:19], v12, s[12:15], 0 offen sc1
    s_mov_b64 exec, -1
    s_waitcnt vmcnt(0)
    s_mov_b64 exec, 1
    ds_add_u32 v28, v29 offset:20
    s_mov_b64 exec, -1
L_prep_af:
    s_cmp_lg_u32 s3, 0
    s_cbranch_scc1 L_prep_done
    s_mov_b32 s60, 1048576
L_w25:
    ds_read_b32 v2, v28 offset:20
    s_waitcnt lgkmcnt(0)
    v_readfirstlane_b32 s61, v2
    s_nop 0
    s_cmp_ge_u32 s61, 12
    s_cbranch_scc1 L_d26
    s_sub_u32 s60, s60, 1
    s_cbranch_scc1 L_d26
    s_branch L_w25
L_d26:
    s_branch L_prep_sig
L_prep_c:
    s_load_dwordx16 s[20:35], s[70:71], 208
    s_load_dwordx8 s[36:43], s[70:71], 272
    s_load_dwordx2 s[44:45], s[70:71], 304
    s_sub_u32 s16, s62, 6
    v_lshlrev_b32 v10, 3, v0
    v_cmp_gt_u32 vcc, 169, v0
    s_nop 1
    v_cndmask_b32 v10, v9, v10, vcc
    s_mov_b32 s17, 175760
    buffer_load_dwordx2 v[32:33], v10, s[8:11], s17 offen
    s_mov_b32 s17, 177112
    buffer_load_dwordx2 v[34:35], v10, s[8:11], s17 offen
    s_mov_b32 s17, 178464
    buffer_load_dwordx2 v[36:37], v10, s[8:11], s17 offen
    s_mov_b32 s17, 179816
    buffer_load_dwordx2 v[38:39], v10, s[8:11], s17 offen
    s_mov_b32 s17, 181168
    buffer_load_dwordx2 v[40:41], v10, s[8:11], s17 offen
    s_mov_b32 s17, 182520
    buffer_load_dwordx2 v[42:43], v10, s[8:11], s17 offen
    s_mov_b32 s17, 183872
    buffer_load_dwordx2 v[44:45], v10, s[8:11], s17 offen
    s_mov_b32 s17, 185224
    buffer_load_dwordx2 v[46:47], v10, s[8:11], s17 offen
    s_mov_b32 s17, 186576
    buffer_load_dwordx2 v[48:49], v10, s[8:11], s17 offen
    s_mov_b32 s17, 187928
    buffer_load_dwordx2 v[50:51], v10, s[8:11], s17 offen
    s_mov_b32 s17, 189280
    buffer_load_dwordx2 v[52:53], v10, s[8:11], s17 offen
    s_mov_b32 s17, 190632
    buffer_load_dwordx2 v[54:55], v10, s[8:11], s17 offen
    s_mov_b32 s17, 191984
    buffer_load_dwordx2 v[56:57], v10, s[8:11], s17 offen
    s_mov_b32 s17, 193336
    buffer_load_dwordx2 v[58:59], v10, s[8:11], s17 offen
    s_mov_b32 s17, 194688
    buffer_load_dwordx2 v[60:61], v10, s[8:11], s17 offen
    s_mov_b32 s17, 196040
    buffer_load_dwordx2 v[62:63], v10, s[8:11], s17 offen
    s_mov_b32 s17, 197392
    buffer_load_dwordx2 v[64:65], v10, s[8:11], s17 offen
    s_mov_b32 s17, 198744
    buffer_load_dwordx2 v[66:67], v10, s[8:11], s17 offen
    s_mov_b32 s17, 200096
    buffer_load_dwordx2 v[68:69], v10, s[8:11], s17 offen
    s_mov_b32 s17, 201448
    buffer_load_dwordx2 v[70:71], v10, s[8:11], s17 offen
    s_mov_b32 s17, 202800
    buffer_load_dwordx2 v[72:73], v10, s[8:11], s17 offen
    s_mov_b32 s17, 204152
    buffer_load_dwordx2 v[74:75], v10, s[8:11], s17 offen
    s_mov_b32 s17, 205504
    buffer_load_dwordx2 v[76:77], v10, s[8:11], s17 offen
    s_mov_b32 s17, 206856
    buffer_load_dwordx2 v[78:79], v10, s[8:11], s17 offen
    s_mov_b32 s17, 208208
    buffer_load_dwordx2 v[80:81], v10, s[8:11], s17 offen
    s_mov_b32 s17, 209560
    buffer_load_dwordx2 v[82:83], v10, s[8:11], s17 offen
    v_lshlrev_b32 v11, 4, v0
    s_mov_b32 s17, 140608
    buffer_load_dwordx4 v[84:87], v11, s[8:11], s17 offen
    s_mov_b32 s17, 144704
    buffer_load_dwordx4 v[88:91], v11, s[8:11], s17 offen
    s_mov_b32 s17, 148800
    buffer_load_dwordx4 v[92:95], v11, s[8:11], s17 offen
    s_mov_b32 s17, 152896
    buffer_load_dwordx4 v[96:99], v11, s[8:11], s17 offen
    s_mov_b32 s17, 156992
    buffer_load_dwordx4 v[100:103], v11, s[8:11], s17 offen
    s_mov_b32 s17, 161088
    buffer_load_dwordx4 v[104:107], v11, s[8:11], s17 offen
    s_mov_b32 s17, 165184
    buffer_load_dwordx4 v[108:111], v11, s[8:11], s17 offen
    s_mov_b32 s17, 169280
    buffer_load_dwordx4 v[112:115], v11, s[8:11], s17 offen
    s_mov_b32 s17, 173376
    v_cmp_gt_u32 vcc, 2384, v11
    s_nop 1
    v_cndmask_b32 v11, v9, v11, vcc
    buffer_load_dwordx4 v[116:119], v11, s[8:11], s17 offen
    v_and_b32 v12, 31, v1
    v_lshrrev_b32 v13, 5, v1
    v_mul_u32_u24 v15, 1352, v13
    v_lshl_add_u32 v15, v12, 1, v15
    v_cmp_gt_u32 vcc, 26, v12
    s_nop 1
    v_cndmask_b32 v15, v9, v15, vcc
    s_mul_i32 s18, s16, 52
    s_add_u32 s18, s18, 140608
    v_mov_b32 v120, 0
    v_mov_b32 v121, 0
    v_mov_b32 v122, 0
    v_mov_b32 v123, 0
    v_mov_b32 v124, 0
    v_mov_b32 v125, 0
    v_mov_b32 v126, 0
    v_mov_b32 v127, 0
    v_mov_b32 v128, 0
    v_mov_b32 v129, 0
    v_mov_b32 v130, 0
    v_mov_b32 v131, 0
    v_mov_b32 v132, 0
    s_add_u32 s17, s18, 0
    buffer_load_short_d16_hi v120, v15, s[8:11], s17 offen
    s_add_u32 s17, s18, 2704
    buffer_load_short_d16_hi v121, v15, s[8:11], s17 offen
    s_add_u32 s17, s18, 5408
    buffer_load_short_d16_hi v122, v15, s[8:11], s17 offen
    s_add_u32 s17, s18, 8112
    buffer_load_short_d16_hi v123, v15, s[8:11], s17 offen
    s_add_u32 s17, s18, 10816
    buffer_load_short_d16_hi v124, v15, s[8:11], s17 offen
    s_add_u32 s17, s18, 13520
    buffer_load_short_d16_hi v125, v15, s[8:11], s17 offen
    s_add_u32 s17, s18, 16224
    buffer_load_short_d16_hi v126, v15, s[8:11], s17 offen
    s_add_u32 s17, s18, 18928
    buffer_load_short_d16_hi v127, v15, s[8:11], s17 offen
    s_add_u32 s17, s18, 21632
    buffer_load_short_d16_hi v128, v15, s[8:11], s17 offen
    s_add_u32 s17, s18, 24336
    buffer_load_short_d16_hi v129, v15, s[8:11], s17 offen
    s_add_u32 s17, s18, 27040
    buffer_load_short_d16_hi v130, v15, s[8:11], s17 offen
    s_add_u32 s17, s18, 29744
    buffer_load_short_d16_hi v131, v15, s[8:11], s17 offen
    s_add_u32 s17, s18, 32448
    buffer_load_short_d16_hi v132, v15, s[8:11], s17 offen
    v_lshlrev_b32 v21, 7, v13
    v_lshl_add_u32 v21, v12, 2, v21
    v_lshl_add_u32 v14, v0, 1, 0
    v_mul_u32_u24 v16, 5042, v14
    v_lshrrev_b32 v16, 16, v16
    v_mul_u32_u24 v17, 13, v16
    v_sub_u32 v17, v14, v17
    v_lshlrev_b32 v19, 7, v16
    v_lshl_add_u32 v19, v17, 3, v19
    v_lshl_add_u32 v14, v0, 1, 1
    v_mul_u32_u24 v16, 5042, v14
    v_lshrrev_b32 v16, 16, v16
    v_mul_u32_u24 v17, 13, v16
    v_sub_u32 v17, v14, v17
    v_lshlrev_b32 v20, 7, v16
    v_lshl_add_u32 v20, v17, 3, v20
    v_mov_b32 v30, 0
    s_waitcnt lgkmcnt(0)
    s_lshl_b32 s17, s20, 16
    v_writelane_b32 v30, s17, 0
    s_and_b32 s17, s20, 0xffff0000
    v_writelane_b32 v30, s17, 1
    s_lshl_b32 s17, s21, 16
    v_writelane_b32 v30, s17, 2
    s_and_b32 s17, s21, 0xffff0000
    v_writelane_b32 v30, s17, 3
    s_lshl_b32 s17, s22, 16
    v_writelane_b32 v30, s17, 4
    s_and_b32 s17, s22, 0xffff0000
    v_writelane_b32 v30, s17, 5
    s_lshl_b32 s17, s23, 16
    v_writelane_b32 v30, s17, 6
    s_and_b32 s17, s23, 0xffff0000
    v_writelane_b32 v30, s17, 7
    s_lshl_b32 s17, s24, 16
    v_writelane_b32 v30, s17, 8
    s_and_b32 s17, s24, 0xffff0000
    v_writelane_b32 v30, s17, 9
    s_lshl_b32 s17, s25, 16
    v_writelane_b32 v30, s17, 10
    s_and_b32 s17, s25, 0xffff0000
    v_writelane_b32 v30, s17, 11
    s_lshl_b32 s17, s26, 16
    v_writelane_b32 v30, s17, 12
    s_and_b32 s17, s26, 0xffff0000
    v_writelane_b32 v30, s17, 13
    s_lshl_b32 s17, s27, 16
    v_writelane_b32 v30, s17, 14
    s_and_b32 s17, s27, 0xffff0000
    v_writelane_b32 v30, s17, 15
    s_lshl_b32 s17, s28, 16
    v_writelane_b32 v30, s17, 16
    s_and_b32 s17, s28, 0xffff0000
    v_writelane_b32 v30, s17, 17
    s_lshl_b32 s17, s29, 16
    v_writelane_b32 v30, s17, 18
    s_and_b32 s17, s29, 0xffff0000
    v_writelane_b32 v30, s17, 19
    s_lshl_b32 s17, s30, 16
    v_writelane_b32 v30, s17, 20
    s_and_b32 s17, s30, 0xffff0000
    v_writelane_b32 v30, s17, 21
    s_lshl_b32 s17, s31, 16
    v_writelane_b32 v30, s17, 22
    s_and_b32 s17, s31, 0xffff0000
    v_writelane_b32 v30, s17, 23
    s_lshl_b32 s17, s32, 16
    v_writelane_b32 v30, s17, 24
    s_and_b32 s17, s32, 0xffff0000
    v_writelane_b32 v30, s17, 25
    v_lshlrev_b32 v31, 7, v1
    v_cmp_gt_u32 vcc, 26, v0
    s_nop 0
    s_and_saveexec_b64 s[6:7], vcc
    ds_write_b32 v31, v30 offset:1128
    s_mov_b64 exec, s[6:7]
    v_and_b32 v26, 0x7fffffff, v30
    s_nop 1
    v_max_u32_dpp v26, v26, v26 row_shr:1 row_mask:0xf bank_mask:0xf
    s_nop 1
    v_max_u32_dpp v26, v26, v26 row_shr:2 row_mask:0xf bank_mask:0xf
    s_nop 1
    v_max_u32_dpp v26, v26, v26 row_shr:4 row_mask:0xf bank_mask:0xf
    s_nop 1
    v_max_u32_dpp v26, v26, v26 row_shr:8 row_mask:0xf bank_mask:0xf
    s_nop 1
    v_max_u32_dpp v26, v26, v26 row_bcast:15 row_mask:0xa bank_mask:0xf
    s_nop 1
    v_max_u32_dpp v26, v26, v26 row_bcast:31 row_mask:0xc bank_mask:0xf
    s_nop 0
    v_readlane_b32 s46, v26, 63
    s_waitcnt vmcnt(22)
    s_lshl_b32 s17, s33, 16
    v_lshlrev_b32 v14, 16, v32
    v_and_b32 v15, 0xffff0000, v32
    v_lshlrev_b32 v16, 16, v33
    v_and_b32 v17, 0xffff0000, v33
    v_mul_f32 v22, s17, v14
    v_mul_f32 v23, s17, v15
    v_mul_f32 v24, s17, v16
    v_mul_f32 v25, s17, v17
    s_and_b32 s17, s33, 0xffff0000
    v_lshlrev_b32 v14, 16, v34
    v_and_b32 v15, 0xffff0000, v34
    v_lshlrev_b32 v16, 16, v35
    v_and_b32 v17, 0xffff0000, v35
    v_fmac_f32 v22, s17, v14
    v_fmac_f32 v23, s17, v15
    v_fmac_f32 v24, s17, v16
    v_fmac_f32 v25, s17, v17
    s_lshl_b32 s17, s34, 16
    v_lshlrev_b32 v14, 16, v36
    v_and_b32 v15, 0xffff0000, v36
    v_lshlrev_b32 v16, 16, v37
    v_and_b32 v17, 0xffff0000, v37
    v_fmac_f32 v22, s17, v14
    v_fmac_f32 v23, s17, v15
    v_fmac_f32 v24, s17, v16
    v_fmac_f32 v25, s17, v17
    s_and_b32 s17, s34, 0xffff0000
    v_lshlrev_b32 v14, 16, v38
    v_and_b32 v15, 0xffff0000, v38
    v_lshlrev_b32 v16, 16, v39
    v_and_b32 v17, 0xffff0000, v39
    v_fmac_f32 v22, s17, v14
    v_fmac_f32 v23, s17, v15
    v_fmac_f32 v24, s17, v16
    v_fmac_f32 v25, s17, v17
    s_lshl_b32 s17, s35, 16
    v_lshlrev_b32 v14, 16, v40
    v_and_b32 v15, 0xffff0000, v40
    v_lshlrev_b32 v16, 16, v41
    v_and_b32 v17, 0xffff0000, v41
    v_fmac_f32 v22, s17, v14
    v_fmac_f32 v23, s17, v15
    v_fmac_f32 v24, s17, v16
    v_fmac_f32 v25, s17, v17
    s_and_b32 s17, s35, 0xffff0000
    v_lshlrev_b32 v14, 16, v42
    v_and_b32 v15, 0xffff0000, v42
    v_lshlrev_b32 v16, 16, v43
    v_and_b32 v17, 0xffff0000, v43
    v_fmac_f32 v22, s17, v14
    v_fmac_f32 v23, s17, v15
    v_fmac_f32 v24, s17, v16
    v_fmac_f32 v25, s17, v17
    s_lshl_b32 s17, s36, 16
    v_lshlrev_b32 v14, 16, v44
    v_and_b32 v15, 0xffff0000, v44
    v_lshlrev_b32 v16, 16, v45
    v_and_b32 v17, 0xffff0000, v45
    v_fmac_f32 v22, s17, v14
    v_fmac_f32 v23, s17, v15
    v_fmac_f32 v24, s17, v16
    v_fmac_f32 v25, s17, v17
    s_and_b32 s17, s36, 0xffff0000
    v_lshlrev_b32 v14, 16, v46
    v_and_b32 v15, 0xffff0000, v46
    v_lshlrev_b32 v16, 16, v47
    v_and_b32 v17, 0xffff0000, v47
    v_fmac_f32 v22, s17, v14
    v_fmac_f32 v23, s17, v15
    v_fmac_f32 v24, s17, v16
    v_fmac_f32 v25, s17, v17
    s_lshl_b32 s17, s37, 16
    v_lshlrev_b32 v14, 16, v48
    v_and_b32 v15, 0xffff0000, v48
    v_lshlrev_b32 v16, 16, v49
    v_and_b32 v17, 0xffff0000, v49
    v_fmac_f32 v22, s17, v14
    v_fmac_f32 v23, s17, v15
    v_fmac_f32 v24, s17, v16
    v_fmac_f32 v25, s17, v17
    s_and_b32 s17, s37, 0xffff0000
    v_lshlrev_b32 v14, 16, v50
    v_and_b32 v15, 0xffff0000, v50
    v_lshlrev_b32 v16, 16, v51
    v_and_b32 v17, 0xffff0000, v51
    v_fmac_f32 v22, s17, v14
    v_fmac_f32 v23, s17, v15
    v_fmac_f32 v24, s17, v16
    v_fmac_f32 v25, s17, v17
    s_lshl_b32 s17, s38, 16
    v_lshlrev_b32 v14, 16, v52
    v_and_b32 v15, 0xffff0000, v52
    v_lshlrev_b32 v16, 16, v53
    v_and_b32 v17, 0xffff0000, v53
    v_fmac_f32 v22, s17, v14
    v_fmac_f32 v23, s17, v15
    v_fmac_f32 v24, s17, v16
    v_fmac_f32 v25, s17, v17
    s_and_b32 s17, s38, 0xffff0000
    v_lshlrev_b32 v14, 16, v54
    v_and_b32 v15, 0xffff0000, v54
    v_lshlrev_b32 v16, 16, v55
    v_and_b32 v17, 0xffff0000, v55
    v_fmac_f32 v22, s17, v14
    v_fmac_f32 v23, s17, v15
    v_fmac_f32 v24, s17, v16
    v_fmac_f32 v25, s17, v17
    s_lshl_b32 s17, s39, 16
    v_lshlrev_b32 v14, 16, v56
    v_and_b32 v15, 0xffff0000, v56
    v_lshlrev_b32 v16, 16, v57
    v_and_b32 v17, 0xffff0000, v57
    v_fmac_f32 v22, s17, v14
    v_fmac_f32 v23, s17, v15
    v_fmac_f32 v24, s17, v16
    v_fmac_f32 v25, s17, v17
    s_and_b32 s17, s39, 0xffff0000
    v_lshlrev_b32 v14, 16, v58
    v_and_b32 v15, 0xffff0000, v58
    v_lshlrev_b32 v16, 16, v59
    v_and_b32 v17, 0xffff0000, v59
    v_fmac_f32 v22, s17, v14
    v_fmac_f32 v23, s17, v15
    v_fmac_f32 v24, s17, v16
    v_fmac_f32 v25, s17, v17
    s_lshl_b32 s17, s40, 16
    v_lshlrev_b32 v14, 16, v60
    v_and_b32 v15, 0xffff0000, v60
    v_lshlrev_b32 v16, 16, v61
    v_and_b32 v17, 0xffff0000, v61
    v_fmac_f32 v22, s17, v14
    v_fmac_f32 v23, s17, v15
    v_fmac_f32 v24, s17, v16
    v_fmac_f32 v25, s17, v17
    s_and_b32 s17, s40, 0xffff0000
    v_lshlrev_b32 v14, 16, v62
    v_and_b32 v15, 0xffff0000, v62
    v_lshlrev_b32 v16, 16, v63
    v_and_b32 v17, 0xffff0000, v63
    v_fmac_f32 v22, s17, v14
    v_fmac_f32 v23, s17, v15
    v_fmac_f32 v24, s17, v16
    v_fmac_f32 v25, s17, v17
    s_lshl_b32 s17, s41, 16
    v_lshlrev_b32 v14, 16, v64
    v_and_b32 v15, 0xffff0000, v64
    v_lshlrev_b32 v16, 16, v65
    v_and_b32 v17, 0xffff0000, v65
    v_fmac_f32 v22, s17, v14
    v_fmac_f32 v23, s17, v15
    v_fmac_f32 v24, s17, v16
    v_fmac_f32 v25, s17, v17
    s_and_b32 s17, s41, 0xffff0000
    v_lshlrev_b32 v14, 16, v66
    v_and_b32 v15, 0xffff0000, v66
    v_lshlrev_b32 v16, 16, v67
    v_and_b32 v17, 0xffff0000, v67
    v_fmac_f32 v22, s17, v14
    v_fmac_f32 v23, s17, v15
    v_fmac_f32 v24, s17, v16
    v_fmac_f32 v25, s17, v17
    s_lshl_b32 s17, s42, 16
    v_lshlrev_b32 v14, 16, v68
    v_and_b32 v15, 0xffff0000, v68
    v_lshlrev_b32 v16, 16, v69
    v_and_b32 v17, 0xffff0000, v69
    v_fmac_f32 v22, s17, v14
    v_fmac_f32 v23, s17, v15
    v_fmac_f32 v24, s17, v16
    v_fmac_f32 v25, s17, v17
    s_and_b32 s17, s42, 0xffff0000
    v_lshlrev_b32 v14, 16, v70
    v_and_b32 v15, 0xffff0000, v70
    v_lshlrev_b32 v16, 16, v71
    v_and_b32 v17, 0xffff0000, v71
    v_fmac_f32 v22, s17, v14
    v_fmac_f32 v23, s17, v15
    v_fmac_f32 v24, s17, v16
    v_fmac_f32 v25, s17, v17
    s_lshl_b32 s17, s43, 16
    v_lshlrev_b32 v14, 16, v72
    v_and_b32 v15, 0xffff0000, v72
    v_lshlrev_b32 v16, 16, v73
    v_and_b32 v17, 0xffff0000, v73
    v_fmac_f32 v22, s17, v14
    v_fmac_f32 v23, s17, v15
    v_fmac_f32 v24, s17, v16
    v_fmac_f32 v25, s17, v17
    s_and_b32 s17, s43, 0xffff0000
    v_lshlrev_b32 v14, 16, v74
    v_and_b32 v15, 0xffff0000, v74
    v_lshlrev_b32 v16, 16, v75
    v_and_b32 v17, 0xffff0000, v75
    v_fmac_f32 v22, s17, v14
    v_fmac_f32 v23, s17, v15
    v_fmac_f32 v24, s17, v16
    v_fmac_f32 v25, s17, v17
    s_lshl_b32 s17, s44, 16
    v_lshlrev_b32 v14, 16, v76
    v_and_b32 v15, 0xffff0000, v76
    v_lshlrev_b32 v16, 16, v77
    v_and_b32 v17, 0xffff0000, v77
    v_fmac_f32 v22, s17, v14
    v_fmac_f32 v23, s17, v15
    v_fmac_f32 v24, s17, v16
    v_fmac_f32 v25, s17, v17
    s_and_b32 s17, s44, 0xffff0000
    v_lshlrev_b32 v14, 16, v78
    v_and_b32 v15, 0xffff0000, v78
    v_lshlrev_b32 v16, 16, v79
    v_and_b32 v17, 0xffff0000, v79
    v_fmac_f32 v22, s17, v14
    v_fmac_f32 v23, s17, v15
    v_fmac_f32 v24, s17, v16
    v_fmac_f32 v25, s17, v17
    s_lshl_b32 s17, s45, 16
    v_lshlrev_b32 v14, 16, v80
    v_and_b32 v15, 0xffff0000, v80
    v_lshlrev_b32 v16, 16, v81
    v_and_b32 v17, 0xffff0000, v81
    v_fmac_f32 v22, s17, v14
    v_fmac_f32 v23, s17, v15
    v_fmac_f32 v24, s17, v16
    v_fmac_f32 v25, s17, v17
    s_and_b32 s17, s45, 0xffff0000
    v_lshlrev_b32 v14, 16, v82
    v_and_b32 v15, 0xffff0000, v82
    v_lshlrev_b32 v16, 16, v83
    v_and_b32 v17, 0xffff0000, v83
    v_fmac_f32 v22, s17, v14
    v_fmac_f32 v23, s17, v15
    v_fmac_f32 v24, s17, v16
    v_fmac_f32 v25, s17, v17
    v_cmp_gt_u32 vcc, 169, v0
    s_nop 0
    s_and_saveexec_b64 s[6:7], vcc
    ds_write_b64 v19, v[22:23] offset:1024
    ds_write_b64 v20, v[24:25] offset:1024
    s_mov_b64 exec, s[6:7]
    v_max3_f32 v22, |v22|, |v23|, |v24|
    v_max_f32 v22, v22, |v25|
    s_nop 1
    v_max_u32_dpp v22, v22, v22 row_shr:1 row_mask:0xf bank_mask:0xf
    s_nop 1
    v_max_u32_dpp v22, v22, v22 row_shr:2 row_mask:0xf bank_mask:0xf
    s_nop 1
    v_max_u32_dpp v22, v22, v22 row_shr:4 row_mask:0xf bank_mask:0xf
    s_nop 1
    v_max_u32_dpp v22, v22, v22 row_shr:8 row_mask:0xf bank_mask:0xf
    s_nop 1
    v_max_u32_dpp v22, v22, v22 row_bcast:15 row_mask:0xa bank_mask:0xf
    s_nop 1
    v_max_u32_dpp v22, v22, v22 row_bcast:31 row_mask:0xc bank_mask:0xf
    s_nop 0
    v_readlane_b32 s6, v22, 63
    s_lshl_b32 s7, s3, 2
    v_add_u32 v18, s7, v8
    v_mov_b32 v22, s6
    ds_write_b32 v18, v22 offset:0
    s_waitcnt vmcnt(13)
    v_and_b32 v22, 0x7fff7fff, v84
    v_and_b32 v18, 0x7fff7fff, v85
    v_pk_max_u16 v22, v22, v18
    v_and_b32 v18, 0x7fff7fff, v86
    v_pk_max_u16 v22, v22, v18
    v_and_b32 v18, 0x7fff7fff, v87
    v_pk_max_u16 v22, v22, v18
    v_and_b32 v18, 0x7fff7fff, v88
    v_pk_max_u16 v22, v22, v18
    v_and_b32 v18, 0x7fff7fff, v89
    v_pk_max_u16 v22, v22, v18
    v_and_b32 v18, 0x7fff7fff, v90
    v_pk_max_u16 v22, v22, v18
    v_and_b32 v18, 0x7fff7fff, v91
    v_pk_max_u16 v22, v22, v18
    v_and_b32 v18, 0x7fff7fff, v92
    v_pk_max_u16 v22, v22, v18
    v_and_b32 v18, 0x7fff7fff, v93
    v_pk_max_u16 v22, v22, v18
    v_and_b32 v18, 0x7fff7fff, v94
    v_pk_max_u16 v22, v22, v18
    v_and_b32 v18, 0x7fff7fff, v95
    v_pk_max_u16 v22, v22, v18
    v_and_b32 v18, 0x7fff7fff, v96
    v_pk_max_u16 v22, v22, v18
    v_and_b32 v18, 0x7fff7fff, v97
    v_pk_max_u16 v22, v22, v18
    v_and_b32 v18, 0x7fff7fff, v98
    v_pk_max_u16 v22, v22, v18
    v_and_b32 v18, 0x7fff7fff, v99
    v_pk_max_u16 v22, v22, v18
    v_and_b32 v18, 0x7fff7fff, v100
    v_pk_max_u16 v22, v22, v18
    v_and_b32 v18, 0x7fff7fff, v101
    v_pk_max_u16 v22, v22, v18
    v_and_b32 v18, 0x7fff7fff, v102
    v_pk_max_u16 v22, v22, v18
    v_and_b32 v18, 0x7fff7fff, v103
    v_pk_max_u16 v22, v22, v18
    v_and_b32 v18, 0x7fff7fff, v104
    v_pk_max_u16 v22, v22, v18
    v_and_b32 v18, 0x7fff7fff, v105
    v_pk_max_u16 v22, v22, v18
    v_and_b32 v18, 0x7fff7fff, v106
    v_pk_max_u16 v22, v22, v18
    v_and_b32 v18, 0x7fff7fff, v107
    v_pk_max_u16 v22, v22, v18
    v_and_b32 v18, 0x7fff7fff, v108
    v_pk_max_u16 v22, v22, v18
    v_and_b32 v18, 0x7fff7fff, v109
    v_pk_max_u16 v22, v22, v18
    v_and_b32 v18, 0x7fff7fff, v110
    v_pk_max_u16 v22, v22, v18
    v_and_b32 v18, 0x7fff7fff, v111
    v_pk_max_u16 v22, v22, v18
    v_and_b32 v18, 0x7fff7fff, v112
    v_pk_max_u16 v22, v22, v18
    v_and_b32 v18, 0x7fff7fff, v113
    v_pk_max_u16 v22, v22, v18
    v_and_b32 v18, 0x7fff7fff, v114
    v_pk_max_u16 v22, v22, v18
    v_and_b32 v18, 0x7fff7fff, v115
    v_pk_max_u16 v22, v22, v18
    v_and_b32 v18, 0x7fff7fff, v116
    v_pk_max_u16 v22, v22, v18
    v_and_b32 v18, 0x7fff7fff, v117
    v_pk_max_u16 v22, v22, v18
    v_and_b32 v18, 0x7fff7fff, v118
    v_pk_max_u16 v22, v22, v18
    v_and_b32 v18, 0x7fff7fff, v119
    v_pk_max_u16 v22, v22, v18
    v_lshrrev_b32 v18, 16, v22
    v_and_b32 v22, 0xffff, v22
    v_max_u32 v22, v22, v18
    s_nop 1
    v_max_u32_dpp v22, v22, v22 row_shr:1 row_mask:0xf bank_mask:0xf
    s_nop 1
    v_max_u32_dpp v22, v22, v22 row_shr:2 row_mask:0xf bank_mask:0xf
    s_nop 1
    v_max_u32_dpp v22, v22, v22 row_shr:4 row_mask:0xf bank_mask:0xf
    s_nop 1
    v_max_u32_dpp v22, v22, v22 row_shr:8 row_mask:0xf bank_mask:0xf
    s_nop 1
    v_max_u32_dpp v22, v22, v22 row_bcast:15 row_mask:0xa bank_mask:0xf
    s_nop 1
    v_max_u32_dpp v22, v22, v22 row_bcast:31 row_mask:0xc bank_mask:0xf
    s_nop 0
    v_readlane_b32 s6, v22, 63
    s_lshl_b32 s7, s3, 2
    v_add_u32 v18, s7, v8
    v_mov_b32 v22, s6
    ds_write_b32 v18, v22 offset:16
    s_waitcnt vmcnt(0) lgkmcnt(0)
    s_mov_b64 exec, 1
    ds_add_u32 v28, v29 offset:20
    s_mov_b64 exec, -1
    s_cmp_lg_u32 s3, 0
    s_cbranch_scc1 L_prep_done
    s_mov_b32 s60, 1048576
L_w27:
    ds_read_b32 v2, v28 offset:20
    s_waitcnt lgkmcnt(0)
    v_readfirstlane_b32 s61, v2
    s_nop 0
    s_cmp_ge_u32 s61, 4
    s_cbranch_scc1 L_d28
    s_sub_u32 s60, s60, 1
    s_cbranch_scc1 L_d28
    s_sleep 1
    s_branch L_w27
L_d28:
    ds_read_b32 v136, v21 offset:1024
    ds_read_b32 v137, v21 offset:1280
    ds_read_b32 v138, v21 offset:1536
    ds_read_b32 v139, v21 offset:1792
    ds_read_b32 v140, v21 offset:2048
    ds_read_b32 v141, v21 offset:2304
    ds_read_b32 v142, v21 offset:2560
    ds_read_b32 v143, v21 offset:2816
    ds_read_b32 v144, v21 offset:3072
    ds_read_b32 v145, v21 offset:3328
    ds_read_b32 v146, v21 offset:3584
    ds_read_b32 v147, v21 offset:3840
    ds_read_b32 v148, v21 offset:4096
    ds_read_b128 v[16:19], v8
    ds_read_b128 v[24:27], v8 offset:16
    s_waitcnt lgkmcnt(0)
    v_max3_u32 v16, v16, v17, v18
    v_max_u32 v16, v16, v19
    s_nop 0
    v_readfirstlane_b32 s17, v16
    v_max3_u32 v24, v24, v25, v26
    v_max_u32 v24, v24, v27
    s_nop 0
    v_readfirstlane_b32 s18, v24
    s_lshr_b32 s17, s17, 23
    s_lshr_b32 s18, s18, 7
    s_lshr_b32 s46, s46, 23
    s_add_u32 s17, s17, s18
    s_sub_i32 s17, 261, s17
    s_add_u32 s46, s46, s18
    s_sub_i32 s46, 262, s46
    v_mfma_f32_32x32x2_f32 v[32:47], v120, v136, 0
    v_mfma_f32_32x32x2_f32 v[32:47], v136, v120, v[32:47]
    v_mfma_f32_32x32x2_f32 v[32:47], v121, v137, v[32:47]
    v_mfma_f32_32x32x2_f32 v[32:47], v137, v121, v[32:47]
    v_mfma_f32_32x32x2_f32 v[32:47], v122, v138, v[32:47]
    v_mfma_f32_32x32x2_f32 v[32:47], v138, v122, v[32:47]
    v_mfma_f32_32x32x2_f32 v[32:47], v123, v139, v[32:47]
    v_mfma_f32_32x32x2_f32 v[32:47], v139, v123, v[32:47]
    v_mfma_f32_32x32x2_f32 v[32:47], v124, v140, v[32:47]
    v_mfma_f32_32x32x2_f32 v[32:47], v140, v124, v[32:47]
    v_mfma_f32_32x32x2_f32 v[32:47], v125, v141, v[32:47]
    v_mfma_f32_32x32x2_f32 v[32:47], v141, v125, v[32:47]
    v_mfma_f32_32x32x2_f32 v[32:47], v126, v142, v[32:47]
    v_mfma_f32_32x32x2_f32 v[32:47], v142, v126, v[32:47]
    v_mfma_f32_32x32x2_f32 v[32:47], v127, v143, v[32:47]
    v_mfma_f32_32x32x2_f32 v[32:47], v143, v127, v[32:47]
    v_mfma_f32_32x32x2_f32 v[32:47], v128, v144, v[32:47]
    v_mfma_f32_32x32x2_f32 v[32:47], v144, v128, v[32:47]
    v_mfma_f32_32x32x2_f32 v[32:47], v129, v145, v[32:47]
    v_mfma_f32_32x32x2_f32 v[32:47], v145, v129, v[32:47]
    v_mfma_f32_32x32x2_f32 v[32:47], v130, v146, v[32:47]
    v_mfma_f32_32x32x2_f32 v[32:47], v146, v130, v[32:47]
    v_mfma_f32_32x32x2_f32 v[32:47], v131, v147, v[32:47]
    v_mfma_f32_32x32x2_f32 v[32:47], v147, v131, v[32:47]
    v_mfma_f32_32x32x2_f32 v[32:47], v132, v148, v[32:47]
    v_mfma_f32_32x32x2_f32 v[32:47], v148, v132, v[32:47]
    v_lshrrev_b32 v11, 1, v1
    v_and_b32 v12, 1, v1
    v_cmp_lt_u32 s[18:19], 22, v11
    v_mov_b32 v14, s46
    v_lshl_add_u32 v15, v11, 2, 0
    v_min_u32 v15, 90, v15
    v_mul_u32_u24 v76, 79, v15
    v_lshrrev_b32 v76, 10, v76
    v_mul_u32_u24 v19, 13, v76
    v_sub_u32 v16, v15, v19
    v_add_u32 v17, v16, v76
    v_subrev_u32 v19, 13, v17
    v_min_u32 v17, v17, v19
    v_lshlrev_b32 v16, 1, v16
    v_lshl_add_u32 v17, v17, 1, v12
    v_xor_b32 v18, 1, v17
    v_min_u32 v76, 1, v76
    v_xor_b32 v76, 1, v76
    v_lshlrev_b32 v19, 7, v16
    v_lshl_add_u32 v60, v17, 2, v19
    v_add_u32 v16, 1, v16
    v_lshlrev_b32 v19, 7, v16
    v_lshl_add_u32 v61, v18, 2, v19
    v_sub_u32 v76, s17, v76
    v_cndmask_b32 v76, v76, v14, s[18:19]
    v_lshl_add_u32 v15, v11, 2, 1
    v_min_u32 v15, 90, v15
    v_mul_u32_u24 v77, 79, v15
    v_lshrrev_b32 v77, 10, v77
    v_mul_u32_u24 v19, 13, v77
    v_sub_u32 v16, v15, v19
    v_add_u32 v17, v16, v77
    v_subrev_u32 v19, 13, v17
    v_min_u32 v17, v17, v19
    v_lshlrev_b32 v16, 1, v16
    v_lshl_add_u32 v17, v17, 1, v12
    v_xor_b32 v18, 1, v17
    v_min_u32 v77, 1, v77
    v_xor_b32 v77, 1, v77
    v_lshlrev_b32 v19, 7, v16
    v_lshl_add_u32 v62, v17, 2, v19
    v_add_u32 v16, 1, v16
    v_lshlrev_b32 v19, 7, v16
    v_lshl_add_u32 v63, v18, 2, v19
    v_sub_u32 v77, s17, v77
    v_cndmask_b32 v77, v77, v14, s[18:19]
    v_lshl_add_u32 v15, v11, 2, 2
    v_min_u32 v15, 90, v15
    v_mul_u32_u24 v78, 79, v15
    v_lshrrev_b32 v78, 10, v78
    v_mul_u32_u24 v19, 13, v78
    v_sub_u32 v16, v15, v19
    v_add_u32 v17, v16, v78
    v_subrev_u32 v19, 13, v17
    v_min_u32 v17, v17, v19
    v_lshlrev_b32 v16, 1, v16
    v_lshl_add_u32 v17, v17, 1, v12
    v_xor_b32 v18, 1, v17
    v_min_u32 v78, 1, v78
    v_xor_b32 v78, 1, v78
    v_lshlrev_b32 v19, 7, v16
    v_lshl_add_u32 v64, v17, 2, v19
    v_add_u32 v16, 1, v16
    v_lshlrev_b32 v19, 7, v16
    v_lshl_add_u32 v65, v18, 2, v19
    v_sub_u32 v78, s17, v78
    v_cndmask_b32 v78, v78, v14, s[18:19]
    v_lshl_add_u32 v15, v11, 2, 3
    v_min_u32 v15, 90, v15
    v_mul_u32_u24 v79, 79, v15
    v_lshrrev_b32 v79, 10, v79
    v_mul_u32_u24 v19, 13, v79
    v_sub_u32 v16, v15, v19
    v_add_u32 v17, v16, v79
    v_subrev_u32 v19, 13, v17
    v_min_u32 v17, v17, v19
    v_lshlrev_b32 v16, 1, v16
    v_lshl_add_u32 v17, v17, 1, v12
    v_xor_b32 v18, 1, v17
    v_min_u32 v79, 1, v79
    v_xor_b32 v79, 1, v79
    v_lshlrev_b32 v19, 7, v16
    v_lshl_add_u32 v66, v17, 2, v19
    v_add_u32 v16, 1, v16
    v_lshlrev_b32 v19, 7, v16
    v_lshl_add_u32 v67, v18, 2, v19
    v_sub_u32 v79, s17, v79
    v_cndmask_b32 v79, v79, v14, s[18:19]
    v_subrev_u32 v15, 23, v11
    v_lshlrev_b32 v15, 3, v15
    v_mad_u32_u24 v15, v12, 14, v15
    v_lshlrev_b32 v15, 7, v15
    v_add_u32 v16, 104, v15
    v_and_b32 v16, 0xfff, v16
    v_cndmask_b32 v60, v60, v16, s[18:19]
    v_add_u32 v16, 232, v15
    v_and_b32 v16, 0xfff, v16
    v_cndmask_b32 v61, v61, v16, s[18:19]
    v_add_u32 v16, 360, v15
    v_and_b32 v16, 0xfff, v16
    v_cndmask_b32 v62, v62, v16, s[18:19]
    v_add_u32 v16, 488, v15
    v_and_b32 v16, 0xfff, v16
    v_cndmask_b32 v63, v63, v16, s[18:19]
    v_add_u32 v16, 616, v15
    v_and_b32 v16, 0xfff, v16
    v_cndmask_b32 v64, v64, v16, s[18:19]
    v_add_u32 v16, 744, v15
    v_and_b32 v16, 0xfff, v16
    v_cndmask_b32 v65, v65, v16, s[18:19]
    v_add_u32 v16, 872, v15
    v_and_b32 v16, 0xfff, v16
    v_cndmask_b32 v66, v66, v16, s[18:19]
    v_add_u32 v16, 1000, v15
    v_and_b32 v16, 0xfff, v16
    v_cndmask_b32 v67, v67, v16, s[18:19]
    s_cmp_ge_u32 s16, 13
    s_cselect_b32 s20, 1, 0
    s_mul_i32 s21, s20, 13
    s_sub_u32 s21, s16, s21
    s_lshr_b32 s22, s21, 1
    s_xor_b32 s22, s22, s21
    s_bfe_u32 s22, s22, 0x10002
    s_xor_b32 s20, s20, s22
    s_mul_i32 s20, s20, 14
    s_add_u32 s21, s21, s20
    s_lshl_b32 s21, s21, 4
    s_add_u32 s21, s21, 119072
    v_and_b32 v20, 31, v1
    v_lshlrev_b32 v20, 2, v20
    v_lshl_add_u32 v20, v13, 9, v20
    ds_write_b32 v20, v32 offset:8192
    ds_write_b32 v20, v33 offset:8320
    ds_write_b32 v20, v34 offset:8448
    ds_write_b32 v20, v35 offset:8576
    ds_write_b32 v20, v36 offset:9216
    ds_write_b32 v20, v37 offset:9344
    ds_write_b32 v20, v38 offset:9472
    ds_write_b32 v20, v39 offset:9600
    ds_write_b32 v20, v40 offset:10240
    ds_write_b32 v20, v41 offset:10368
    ds_write_b32 v20, v42 offset:10496
    ds_write_b32 v20, v43 offset:10624
    ds_write_b32 v20, v44 offset:11264
    ds_write_b32 v20, v45 offset:11392
    ds_write_b32 v20, v46 offset:11520
    ds_write_b32 v20, v47 offset:11648
    s_waitcnt lgkmcnt(0)
    ds_read_b32 v48, v60 offset:8192
    ds_read_b32 v49, v61 offset:8192
    ds_read_b32 v50, v62 offset:8192
    ds_read_b32 v51, v63 offset:8192
    ds_read_b32 v52, v64 offset:8192
    ds_read_b32 v53, v65 offset:8192
    ds_read_b32 v54, v66 offset:8192
    ds_read_b32 v55, v67 offset:8192
    s_waitcnt lgkmcnt(0)
    v_ldexp_f32 v48, v48, v76
    v_ldexp_f32 v49, v49, v76
    v_ldexp_f32 v50, v50, v77
    v_ldexp_f32 v51, v51, v77
    v_ldexp_f32 v52, v52, v78
    v_ldexp_f32 v53, v53, v78
    v_ldexp_f32 v54, v54, v79
    v_ldexp_f32 v55, v55, v79
    v_cvt_pk_f16_f32 v32, v48, v49
    v_cvt_pk_f16_f32 v33, v50, v51
    v_cvt_pk_f16_f32 v34, v52, v53
    v_cvt_pk_f16_f32 v35, v54, v55
    v_cmp_ne_u32 vcc, 22, v11
    s_nop 1
    v_cndmask_b32 v35, 0, v35, vcc
    v_cmp_ne_u32 vcc, 24, v11
    s_nop 1
    v_cndmask_b32 v35, 0, v35, vcc
    v_cmp_ne_u32 vcc, 49, v1
    s_nop 1
    v_cndmask_b32 v34, 0, v34, vcc
    v_mul_u32_u24 v10, 432, v1
    v_cmp_gt_u32 vcc, 50, v1
    s_nop 1
    v_cndmask_b32 v10, v9, v10, vcc
    buffer_store_dwordx4 v[32:35], v10, s[12:15], s21 offen sc1
    s_cmp_lg_u32 s16, 0
    s_cbranch_scc1 L_prep_sig0
    v_mov_b32 v36, 0
    v_mov_b32 v37, 0
    v_mov_b32 v38, 0
    v_mov_b32 v39, 0
    s_mov_b32 s21, 119280
    buffer_store_dwordx4 v[36:39], v10, s[12:15], s21 offen sc1
    v_mov_b32 v40, s17
    v_mov_b32 v41, s46
    v_mov_b32 v12, 140672
    s_mov_b64 exec, 1
    buffer_store_dwordx2 v[40:41], v12, s[12:15], 0 offen sc1
    s_mov_b64 exec, -1
L_prep_sig0:
    s_waitcnt vmcnt(0)
L_prep_sig:
    s_mov_b32 s16, s82
    s_mov_b32 s17, s83
    s_mov_b32 s18, 0x100
    s_mov_b32 s19, 0x20000
    v_mov_b32 v12, s62
    s_mov_b64 exec, 1
    buffer_store_byte v29, v12, s[16:19], 0 offen sc0 sc1
    s_mov_b64 exec, -1
L_prep_done:
    s_setprio 0
    s_cmp_ge_u32 s2, 6
    s_cbranch_scc1 L_xg_done
    s_mov_b32 s8, s66
    s_mov_b32 s9, s67
    s_mov_b32 s10, 0x61a800
    s_mov_b32 s11, 0x20000
    v_and_b32 v23, 3, v1
    v_lshlrev_b32 v23, 4, v23
    s_lshl_b32 s63, s3, 12
    s_mov_b32 s60, 1048576
L_w29:
    ds_read_b32 v2, v28 offset:40
    s_waitcnt lgkmcnt(0)
    v_readfirstlane_b32 s61, v2
    s_nop 0
    s_cmp_ge_u32 s61, 8
    s_cbranch_scc1 L_d30
    s_sub_u32 s60, s60, 1
    s_cbranch_scc1 L_d30
    s_sleep 1
    s_branch L_w29
L_d30:
    s_waitcnt vmcnt(0)
    v_lshl_add_u32 v150, v150, 6, v23
    s_add_u32 m0, s63, 123296
    s_nop 0
    buffer_load_dwordx4 v150, s[8:11], 0 offen nt lds
    v_lshl_add_u32 v151, v151, 6, v23
    s_add_u32 m0, s63, 124320
    s_nop 0
    buffer_load_dwordx4 v151, s[8:11], 0 offen nt lds
    v_lshl_add_u32 v152, v152, 6, v23
    s_add_u32 m0, s63, 125344
    s_nop 0
    buffer_load_dwordx4 v152, s[8:11], 0 offen nt lds
    v_lshl_add_u32 v153, v153, 6, v23
    s_add_u32 m0, s63, 126368
    s_nop 0
    buffer_load_dwordx4 v153, s[8:11], 0 offen nt lds
    s_lshl_b32 s7, s3, 2
    v_add_u32 v4, s7, v28
    s_waitcnt vmcnt(0)
    s_mov_b64 exec, 1
    ds_add_u32 v4, v29 offset:48
    s_mov_b64 exec, -1
    v_lshl_add_u32 v154, v154, 6, v23
    s_add_u32 m0, s63, 139680
    s_nop 0
    buffer_load_dwordx4 v154, s[8:11], 0 offen nt lds
    v_lshl_add_u32 v155, v155, 6, v23
    s_add_u32 m0, s63, 140704
    s_nop 0
    buffer_load_dwordx4 v155, s[8:11], 0 offen nt lds
    v_lshl_add_u32 v156, v156, 6, v23
    s_add_u32 m0, s63, 141728
    s_nop 0
    buffer_load_dwordx4 v156, s[8:11], 0 offen nt lds
    v_lshl_add_u32 v157, v157, 6, v23
    s_add_u32 m0, s63, 142752
    s_nop 0
    buffer_load_dwordx4 v157, s[8:11], 0 offen nt lds
    s_waitcnt vmcnt(0)
    s_mov_b64 exec, 1
    ds_add_u32 v4, v29 offset:48
    s_mov_b64 exec, -1
L_xg_done:
    s_mov_b32 s34, s3
    s_mov_b64 exec, 1
    ds_add_u32 v28, v29 offset:28
    s_mov_b64 exec, -1
    s_cmp_eq_u32 s3, 0
    s_cbranch_scc1 L_collect
    s_mov_b32 s36, s82
    s_mov_b32 s37, s83
    s_mov_b32 s38, 0x100
    s_mov_b32 s39, 0x20000
    v_lshlrev_b32 v20, 4, v1
    s_sub_u32 s44, s3, 1
    s_lshl_b32 s44, s44, 10
    v_mov_b32 v4, 4
    s_mov_b32 s40, s84
    s_mov_b32 s41, s85
    s_mov_b32 s42, 0x9130
    s_mov_b32 s43, 0x20000
    s_mov_b32 s60, 1048576
L_w31:
    ds_read_b32 v2, v28 offset:4
    s_waitcnt lgkmcnt(0)
    v_readfirstlane_b32 s61, v2
    s_nop 0
    s_cmp_ge_u32 s61, 8
    s_cbranch_scc1 L_d32
    s_sub_u32 s60, s60, 1
    s_cbranch_scc1 L_d32
    s_sleep 4
    s_branch L_w31
L_d32:
    s_cmp_lg_u32 s3, 1
    s_cbranch_scc1 L_f33
    s_mov_b32 s60, 1048576
L_p34:
    buffer_load_ubyte v2, v1, s[36:39], 0 offen sc0 sc1
    s_waitcnt vmcnt(0)
    v_cmp_eq_u32 vcc, 1, v2
    s_nop 0
    s_and_b32 s61, vcc_lo, 0xf
    s_cmp_eq_u32 s61, 0xf
    s_cbranch_scc1 L_d35
    s_sub_u32 s60, s60, 1
    s_cbranch_scc1 L_d35
    s_sleep 16
    s_branch L_p34
L_d35:
    v_mov_b32 v5, 256
    s_mov_b64 exec, 1
    ds_add_u32 v28, v5 offset:28
    s_mov_b64 exec, -1
L_f33:
    s_mov_b32 s60, 1048576
L_w36:
    ds_read_b32 v2, v28 offset:28
    s_waitcnt lgkmcnt(0)
    v_readfirstlane_b32 s61, v2
    s_nop 0
    s_cmp_ge_u32 s61, 256
    s_cbranch_scc1 L_d37
    s_sub_u32 s60, s60, 1
    s_cbranch_scc1 L_d37
    s_sleep 2
    s_branch L_w36
L_d37:
    s_add_u32 s45, s44, 0
    s_add_u32 m0, s45, 85408
    s_nop 0
    buffer_load_dwordx4 v20, s[40:43], s45 offen sc1 lds
    s_add_u32 s45, s44, 3072
    s_add_u32 m0, s45, 85408
    s_nop 0
    buffer_load_dwordx4 v20, s[40:43], s45 offen sc1 lds
    s_add_u32 s45, s44, 6144
    s_add_u32 m0, s45, 85408
    s_nop 0
    buffer_load_dwordx4 v20, s[40:43], s45 offen sc1 lds
    s_add_u32 s45, s44, 9216
    s_add_u32 m0, s45, 85408
    s_nop 0
    buffer_load_dwordx4 v20, s[40:43], s45 offen sc1 lds
    s_add_u32 s45, s44, 12288
    s_add_u32 m0, s45, 85408
    s_nop 0
    buffer_load_dwordx4 v20, s[40:43], s45 offen sc1 lds
    s_add_u32 s45, s44, 15360
    s_add_u32 m0, s45, 85408
    s_nop 0
    buffer_load_dwordx4 v20, s[40:43], s45 offen sc1 lds
    s_add_u32 s45, s44, 18432
    s_add_u32 m0, s45, 85408
    s_nop 0
    buffer_load_dwordx4 v20, s[40:43], s45 offen sc1 lds
    s_add_u32 s45, s44, 21504
    s_add_u32 m0, s45, 85408
    s_nop 0
    buffer_load_dwordx4 v20, s[40:43], s45 offen sc1 lds
    s_add_u32 s45, s44, 24576
    s_add_u32 m0, s45, 85408
    s_nop 0
    buffer_load_dwordx4 v20, s[40:43], s45 offen sc1 lds
    s_add_u32 s45, s44, 27648
    s_add_u32 m0, s45, 85408
    s_nop 0
    buffer_load_dwordx4 v20, s[40:43], s45 offen sc1 lds
    s_add_u32 s45, s44, 30720
    s_add_u32 m0, s45, 85408
    s_nop 0
    buffer_load_dwordx4 v20, s[40:43], s45 offen sc1 lds
    s_add_u32 s45, s44, 33792
    s_add_u32 m0, s45, 85408
    s_nop 0
    buffer_load_dwordx4 v20, s[40:43], s45 offen sc1 lds
    s_add_u32 s45, s44, 36864
    s_min_u32 s45, s45, 36864
    s_add_u32 m0, s45, 85408
    s_nop 0
    buffer_load_dwordx4 v20, s[40:43], s45 offen sc1 lds
    s_waitcnt vmcnt(0)
    s_mov_b64 exec, 1
    ds_add_u32 v28, v4 offset:8
    s_mov_b64 exec, -1
    s_add_u32 s40, s84, 0xa000
    s_addc_u32 s41, s85, 0
    s_mov_b32 s42, 0x9130
    s_mov_b32 s43, 0x20000
    s_mov_b32 s60, 1048576
L_w38:
    ds_read_b32 v2, v28 offset:36
    s_waitcnt lgkmcnt(0)
    v_readfirstlane_b32 s61, v2
    s_nop 0
    s_cmp_ge_u32 s61, 8
    s_cbranch_scc1 L_d39
    s_sub_u32 s60, s60, 1
    s_cbranch_scc1 L_d39
    s_sleep 4
    s_branch L_w38
L_d39:
    s_cmp_lg_u32 s3, 1
    s_cbranch_scc1 L_f40
    s_mov_b32 s60, 1048576
L_p41:
    buffer_load_ubyte v2, v1, s[36:39], 0 offen sc0 sc1
    s_waitcnt vmcnt(0)
    v_cmp_eq_u32 vcc, 1, v2
    s_nop 0
    s_and_b32 s61, vcc_lo, 0x10
    s_cmp_eq_u32 s61, 0x10
    s_cbranch_scc1 L_d42
    s_sub_u32 s60, s60, 1
    s_cbranch_scc1 L_d42
    s_sleep 16
    s_branch L_p41
L_d42:
    v_mov_b32 v5, 256
    s_mov_b64 exec, 1
    ds_add_u32 v28, v5 offset:28
    s_mov_b64 exec, -1
L_f40:
    s_mov_b32 s60, 1048576
L_w43:
    ds_read_b32 v2, v28 offset:28
    s_waitcnt lgkmcnt(0)
    v_readfirstlane_b32 s61, v2
    s_nop 0
    s_cmp_ge_u32 s61, 512
    s_cbranch_scc1 L_d44
    s_sub_u32 s60, s60, 1
    s_cbranch_scc1 L_d44
    s_sleep 2
    s_branch L_w43
L_d44:
    s_add_u32 s45, s44, 0
    s_add_u32 m0, s45, 123296
    s_nop 0
    buffer_load_dwordx4 v20, s[40:43], s45 offen sc1 lds
    s_add_u32 s45, s44, 3072
    s_add_u32 m0, s45, 123296
    s_nop 0
    buffer_load_dwordx4 v20, s[40:43], s45 offen sc1 lds
    s_add_u32 s45, s44, 6144
    s_add_u32 m0, s45, 123296
    s_nop 0
    buffer_load_dwordx4 v20, s[40:43], s45 offen sc1 lds
    s_add_u32 s45, s44, 9216
    s_add_u32 m0, s45, 123296
    s_nop 0
    buffer_load_dwordx4 v20, s[40:43], s45 offen sc1 lds
    s_add_u32 s45, s44, 12288
    s_add_u32 m0, s45, 123296
    s_nop 0
    buffer_load_dwordx4 v20, s[40:43], s45 offen sc1 lds
    s_add_u32 s45, s44, 15360
    s_add_u32 m0, s45, 123296
    s_nop 0
    buffer_load_dwordx4 v20, s[40:43], s45 offen sc1 lds
    s_add_u32 s45, s44, 18432
    s_add_u32 m0, s45, 123296
    s_nop 0
    buffer_load_dwordx4 v20, s[40:43], s45 offen sc1 lds
    s_add_u32 s45, s44, 21504
    s_add_u32 m0, s45, 123296
    s_nop 0
    buffer_load_dwordx4 v20, s[40:43], s45 offen sc1 lds
    s_add_u32 s45, s44, 24576
    s_add_u32 m0, s45, 123296
    s_nop 0
    buffer_load_dwordx4 v20, s[40:43], s45 offen sc1 lds
    s_add_u32 s45, s44, 27648
    s_add_u32 m0, s45, 123296
    s_nop 0
    buffer_load_dwordx4 v20, s[40:43], s45 offen sc1 lds
    s_add_u32 s45, s44, 30720
    s_add_u32 m0, s45, 123296
    s_nop 0
    buffer_load_dwordx4 v20, s[40:43], s45 offen sc1 lds
    s_add_u32 s45, s44, 33792
    s_add_u32 m0, s45, 123296
    s_nop 0
    buffer_load_dwordx4 v20, s[40:43], s45 offen sc1 lds
    s_add_u32 s45, s44, 36864
    s_min_u32 s45, s45, 36864
    s_add_u32 m0, s45, 123296
    s_nop 0
    buffer_load_dwordx4 v20, s[40:43], s45 offen sc1 lds
    s_waitcnt vmcnt(0)
    s_mov_b64 exec, 1
    ds_add_u32 v28, v4 offset:12
    s_mov_b64 exec, -1
    s_add_u32 s40, s84, 0x14000
    s_addc_u32 s41, s85, 0
    s_mov_b32 s42, 0xe590
    s_mov_b32 s43, 0x20000
    s_mov_b32 s60, 1048576
L_w45:
    ds_read_b32 v2, v28 offset:32
    s_waitcnt lgkmcnt(0)
    v_readfirstlane_b32 s61, v2
    s_nop 0
    s_cmp_ge_u32 s61, 1
    s_cbranch_scc1 L_d46
    s_sub_u32 s60, s60, 1
    s_cbranch_scc1 L_d46
    s_sleep 4
    s_branch L_w45
L_d46:
    s_cmp_lg_u32 s3, 1
    s_cbranch_scc1 L_f47
    s_mov_b32 s60, 1048576
L_p48:
    buffer_load_ubyte v2, v1, s[36:39], 0 offen sc0 sc1
    s_waitcnt vmcnt(0)
    v_cmp_eq_u32 vcc, 1, v2
    s_nop 0
    s_and_b32 s61, vcc_lo, 0xffffffe0
    s_cmp_eq_u32 s61, 0xffffffe0
    s_cbranch_scc1 L_d49
    s_sub_u32 s60, s60, 1
    s_cbranch_scc1 L_d49
    s_sleep 16
    s_branch L_p48
L_d49:
    v_mov_b32 v5, 256
    s_mov_b64 exec, 1
    ds_add_u32 v28, v5 offset:28
    s_mov_b64 exec, -1
L_f47:
    s_mov_b32 s60, 1048576
L_w50:
    ds_read_b32 v2, v28 offset:28
    s_waitcnt lgkmcnt(0)
    v_readfirstlane_b32 s61, v2
    s_nop 0
    s_cmp_ge_u32 s61, 772
    s_cbranch_scc1 L_d51
    s_sub_u32 s60, s60, 1
    s_cbranch_scc1 L_d51
    s_sleep 2
    s_branch L_w50
L_d51:
    s_add_u32 s45, s44, 0
    s_add_u32 m0, s45, 0
    s_nop 0
    buffer_load_dwordx4 v20, s[40:43], s45 offen sc1 lds
    s_add_u32 s45, s44, 3072
    s_add_u32 m0, s45, 0
    s_nop 0
    buffer_load_dwordx4 v20, s[40:43], s45 offen sc1 lds
    s_add_u32 s45, s44, 6144
    s_add_u32 m0, s45, 0
    s_nop 0
    buffer_load_dwordx4 v20, s[40:43], s45 offen sc1 lds
    s_add_u32 s45, s44, 9216
    s_add_u32 m0, s45, 0
    s_nop 0
    buffer_load_dwordx4 v20, s[40:43], s45 offen sc1 lds
    s_add_u32 s45, s44, 12288
    s_add_u32 m0, s45, 0
    s_nop 0
    buffer_load_dwordx4 v20, s[40:43], s45 offen sc1 lds
    s_add_u32 s45, s44, 15360
    s_add_u32 m0, s45, 0
    s_nop 0
    buffer_load_dwordx4 v20, s[40:43], s45 offen sc1 lds
    s_add_u32 s45, s44, 18432
    s_add_u32 m0, s45, 0
    s_nop 0
    buffer_load_dwordx4 v20, s[40:43], s45 offen sc1 lds
    s_add_u32 s45, s44, 21504
    s_add_u32 m0, s45, 0
    s_nop 0
    buffer_load_dwordx4 v20, s[40:43], s45 offen sc1 lds
    s_add_u32 s45, s44, 24576
    s_add_u32 m0, s45, 0
    s_nop 0
    buffer_load_dwordx4 v20, s[40:43], s45 offen sc1 lds
    s_add_u32 s45, s44, 27648
    s_add_u32 m0, s45, 0
    s_nop 0
    buffer_load_dwordx4 v20, s[40:43], s45 offen sc1 lds
    s_add_u32 s45, s44, 30720
    s_add_u32 m0, s45, 0
    s_nop 0
    buffer_load_dwordx4 v20, s[40:43], s45 offen sc1 lds
    s_add_u32 s45, s44, 33792
    s_add_u32 m0, s45, 0
    s_nop 0
    buffer_load_dwordx4 v20, s[40:43], s45 offen sc1 lds
    s_add_u32 s45, s44, 36864
    s_add_u32 m0, s45, 0
    s_nop 0
    buffer_load_dwordx4 v20, s[40:43], s45 offen sc1 lds
    s_add_u32 s45, s44, 39936
    s_add_u32 m0, s45, 0
    s_nop 0
    buffer_load_dwordx4 v20, s[40:43], s45 offen sc1 lds
    s_add_u32 s45, s44, 43008
    s_add_u32 m0, s45, 0
    s_nop 0
    buffer_load_dwordx4 v20, s[40:43], s45 offen sc1 lds
    s_add_u32 s45, s44, 46080
    s_add_u32 m0, s45, 0
    s_nop 0
    buffer_load_dwordx4 v20, s[40:43], s45 offen sc1 lds
    s_add_u32 s45, s44, 49152
    s_add_u32 m0, s45, 0
    s_nop 0
    buffer_load_dwordx4 v20, s[40:43], s45 offen sc1 lds
    s_add_u32 s45, s44, 52224
    s_add_u32 m0, s45, 0
    s_nop 0
    buffer_load_dwordx4 v20, s[40:43], s45 offen sc1 lds
    s_add_u32 s45, s44, 55296
    s_add_u32 m0, s45, 0
    s_nop 0
    buffer_load_dwordx4 v20, s[40:43], s45 offen sc1 lds
    s_add_u32 s45, s44, 58368
    s_min_u32 s45, s45, 58368
    s_add_u32 m0, s45, 0
    s_nop 0
    buffer_load_dwordx4 v20, s[40:43], s45 offen sc1 lds
    s_waitcnt vmcnt(0)
    s_mov_b64 exec, 1
    ds_add_u32 v28, v4 offset:16
    s_mov_b64 exec, -1
    s_endpgm
L_dnn_go:
    s_mov_b32 s34, s3
    s_mov_b32 s12, s72
    s_mov_b32 s13, s73
    s_mov_b32 s14, 0x152000
    s_mov_b32 s15, 0x20000
    s_mov_b32 s20, s74
    s_mov_b32 s21, s75
    s_mov_b32 s22, 0x680
    s_mov_b32 s23, 0x20000
    s_mov_b32 s24, s76
    s_mov_b32 s25, s77
    s_mov_b32 s26, 0x680
    s_mov_b32 s27, 0x20000
    s_lshl_b32 s28, s4, 7
    s_lshl_b32 s29, s34, 5
    s_add_u32 s28, s28, s29
    v_lshrrev_b32 v3, 2, v1
    v_add_u32 v3, s28, v3
    v_mul_u32_u24 v3, 104, v3
    v_and_b32 v8, 3, v1
    v_lshl_add_u32 v3, v8, 5, v3
    v_mov_b32 v21, v3
    s_sub_u32 s35, s5, 1
    v_and_b32 v4, 127, v0
    v_lshlrev_b32 v22, 1, v4
    s_lshl_b32 s29, s35, 8
    v_mov_b32 v18, 0
    v_mov_b32 v19, 0
    v_lshrrev_b32 v6, 4, v1
    v_bfe_u32 v7, v1, 2, 2
    v_xor_b32 v7, v7, v6
    v_lshlrev_b32 v7, 6, v7
    v_lshl_add_u32 v7, v8, 4, v7
    s_and_b32 s30, s34, 1
    s_lshl_b32 s30, s30, 5
    v_xor_b32 v7, s30, v7
    v_sub_u32 v9, 4, v6
    v_and_b32 v9, 3, v9
    v_xor_b32 v9, v9, v8
    v_lshlrev_b32 v9, 4, v9
    s_lshl_b32 s30, s34, 3
    v_add_u32 v6, s30, v6
    v_mul_u32_u24 v6, 1664, v6
    v_add3_u32 v6, v6, v7, s29
    v_add_u32 v7, s29, v7
    v_cmp_gt_u32 vcc, 1664, v7
    v_mov_b32 v7, 0x7ffffff0
    s_nop 0
    v_cndmask_b32 v6, v7, v6, vcc
    s_lshl_b32 s31, s34, 11
    s_and_b32 s32, s34, 1
    s_lshr_b32 s33, s34, 1
    v_and_b32 v2, 15, v1
    v_lshrrev_b32 v3, 4, v1
    v_bfe_u32 v7, v1, 2, 2
    v_sub_u32 v24, 4, v7
    v_and_b32 v24, 3, v24
    v_xor_b32 v24, v24, v3
    v_lshlrev_b32 v24, 4, v24
    v_lshl_add_u32 v24, v2, 6, v24
    s_lshl_b32 s30, s32, 12
    v_add_u32 v5, s30, v24
    s_lshl_b32 s30, s33, 1
    v_xor_b32 v24, s30, v7
    v_lshlrev_b32 v24, 6, v24
    v_lshl_add_u32 v24, v7, 8, v24
    v_lshl_add_u32 v24, v3, 11, v24
    v_and_b32 v2, 1, v3
    v_lshl_add_u32 v24, v2, 5, v24
    v_lshl_add_u32 v24, v8, 3, v24
    v_mov_b32 v8, v5
    v_xor_b32 v25, 32, v24
    v_xor_b32 v26, 64, v24
    v_xor_b32 v27, 96, v24
    s_lshl_b32 s30, s33, 8
    s_add_u32 s30, s30, 161696
    v_lshl_add_u32 v7, v3, 4, s30
    s_lshl_b32 s7, s3, 2
    v_add_u32 v4, s7, v28
    s_waitcnt vmcnt(0)
    s_mov_b64 exec, 1
    ds_add_u32 v4, v29 offset:48
    s_mov_b64 exec, -1
    buffer_load_dwordx4 v[10:13], v21, s[16:19], 0 offen offset:0
    buffer_load_dwordx4 v[14:17], v21, s[16:19], 0 offen offset:16
    buffer_load_dwordx4 v[158:161], v21, s[16:19], 0 offen offset:1664
    buffer_load_dwordx4 v[162:165], v21, s[16:19], 0 offen offset:1680
    v_lshl_add_u32 v154, v154, 6, v23
    s_add_u32 m0, s63, 139680
    s_nop 0
    buffer_load_dwordx4 v154, s[8:11], 0 offen nt lds
    v_lshl_add_u32 v155, v155, 6, v23
    s_add_u32 m0, s63, 140704
    s_nop 0
    buffer_load_dwordx4 v155, s[8:11], 0 offen nt lds
    v_lshl_add_u32 v156, v156, 6, v23
    s_add_u32 m0, s63, 141728
    s_nop 0
    buffer_load_dwordx4 v156, s[8:11], 0 offen nt lds
    v_lshl_add_u32 v157, v157, 6, v23
    s_add_u32 m0, s63, 142752
    s_nop 0
    buffer_load_dwordx4 v157, s[8:11], 0 offen nt lds
    s_waitcnt vmcnt(4)
    v_lshlrev_b32 v10, 6, v10
    v_lshlrev_b32 v11, 6, v11
    v_lshlrev_b32 v12, 6, v12
    v_lshlrev_b32 v13, 6, v13
    v_lshlrev_b32 v14, 6, v14
    v_lshlrev_b32 v15, 6, v15
    v_lshlrev_b32 v16, 6, v16
    v_lshlrev_b32 v17, 6, v17
    v_lshlrev_b32 v158, 6, v158
    v_lshlrev_b32 v159, 6, v159
    v_lshlrev_b32 v160, 6, v160
    v_lshlrev_b32 v161, 6, v161
    v_lshlrev_b32 v162, 6, v162
    v_lshlrev_b32 v163, 6, v163
    v_lshlrev_b32 v164, 6, v164
    v_lshlrev_b32 v165, 6, v165
    buffer_load_short_d16_hi v18, v22, s[20:23], s29 offen
    buffer_load_short_d16_hi v19, v22, s[24:27], s29 offen
    s_add_u32 m0, s31, 8192
    s_mov_b32 s30, 0
    buffer_load_dwordx4 v6, s[12:15], s30 offen lds
    s_add_u32 m0, s31, 9216
    s_mov_b32 s30, 6656
    buffer_load_dwordx4 v6, s[12:15], s30 offen lds
    v_add_u32_dpp v5, v10, v9 quad_perm:[0,0,0,0] row_mask:0xf bank_mask:0xf
    s_add_u32 m0, s31, 0
    s_nop 0
    buffer_load_dwordx4 v5, s[8:11], 0 offen lds
    v_add_u32_dpp v5, v158, v9 quad_perm:[0,0,0,0] row_mask:0xf bank_mask:0xf
    s_add_u32 m0, s31, 1024
    s_nop 0
    buffer_load_dwordx4 v5, s[8:11], 0 offen lds
    s_waitcnt vmcnt(6)
    s_mov_b64 exec, 1
    ds_add_u32 v4, v29 offset:48
    s_mov_b64 exec, -1
    s_setprio 3
    s_mov_b32 s36, s82
    s_mov_b32 s37, s83
    s_mov_b32 s38, 0x100
    s_mov_b32 s39, 0x20000
    s_mov_b32 s40, s84
    s_mov_b32 s41, s85
    s_mov_b32 s42, 0x9130
    s_mov_b32 s43, 0x20000
    s_add_u32 s48, s84, 0xa000
    s_addc_u32 s49, s85, 0
    s_mov_b32 s50, 0x9130
    s_mov_b32 s51, 0x20000
    s_add_u32 s52, s84, 0x14000
    s_addc_u32 s53, s85, 0
    s_mov_b32 s54, 0xe590
    s_mov_b32 s55, 0x20000
    v_lshlrev_b32 v20, 4, v1
    s_lshl_b32 s44, s3, 10
    s_cmp_lg_u32 s3, 0
    s_cbranch_scc1 L_f52
    buffer_load_ubyte v21, v1, s[36:39], 0 offen sc0 sc1
L_f52:
    s_add_u32 m0, s31, 24576
    s_mov_b32 s30, 53248
    buffer_load_dwordx4 v6, s[12:15], s30 offen lds
    s_add_u32 m0, s31, 25600
    s_mov_b32 s30, 59904
    buffer_load_dwordx4 v6, s[12:15], s30 offen lds
    v_add_u32_dpp v5, v11, v9 quad_perm:[0,0,0,0] row_mask:0xf bank_mask:0xf
    s_add_u32 m0, s31, 16384
    s_nop 0
    buffer_load_dwordx4 v5, s[8:11], 0 offen lds
    v_add_u32_dpp v5, v159, v9 quad_perm:[0,0,0,0] row_mask:0xf bank_mask:0xf
    s_add_u32 m0, s31, 17408
    s_nop 0
    buffer_load_dwordx4 v5, s[8:11], 0 offen lds
    s_add_u32 m0, s31, 40960
    s_mov_b32 s30, 106496
    buffer_load_dwordx4 v6, s[12:15], s30 offen lds
    s_add_u32 m0, s31, 41984
    s_mov_b32 s30, 113152
    buffer_load_dwordx4 v6, s[12:15], s30 offen lds
    v_add_u32_dpp v5, v12, v9 quad_perm:[0,0,0,0] row_mask:0xf bank_mask:0xf
    s_add_u32 m0, s31, 32768
    s_nop 0
    buffer_load_dwordx4 v5, s[8:11], 0 offen lds
    v_add_u32_dpp v5, v160, v9 quad_perm:[0,0,0,0] row_mask:0xf bank_mask:0xf
    s_add_u32 m0, s31, 33792
    s_nop 0
    buffer_load_dwordx4 v5, s[8:11], 0 offen lds
    v_and_b32 v4, 255, v0
    v_cmp_gt_u32 vcc, 128, v4
    v_lshlrev_b32 v4, 2, v4
    v_add_u32 v4, 161696, v4
    s_waitcnt vmcnt(12)
    v_cndmask_b32 v18, v19, v18, vcc
    ds_write_b32 v4, v18
    v_mov_b32 v4, 3
    s_waitcnt vmcnt(8) lgkmcnt(0)
    s_mov_b64 exec, 1
    ds_add_u32 v28, v29 offset:20
    s_mov_b64 exec, -1
    ds_read_b32 v2, v28 offset:20
    s_waitcnt lgkmcnt(0)
    v_readfirstlane_b32 s61, v2
    s_nop 0
    s_cmp_ge_u32 s61, 4
    s_cbranch_scc1 L_c53
    s_mov_b32 s60, 1048576
L_w54:
    ds_read_b32 v2, v28 offset:20
    s_waitcnt lgkmcnt(0)
    v_readfirstlane_b32 s61, v2
    s_nop 0
    s_cmp_ge_u32 s61, 4
    s_cbranch_scc1 L_d55
    s_sub_u32 s60, s60, 1
    s_cbranch_scc1 L_d55
    s_branch L_w54
L_d55:
L_c53:
    ds_read_b128 v[30:33], v7 offset:0
    ds_read_b128 v[34:37], v7 offset:0
    ds_read_b128 v[38:41], v7 offset:0
    ds_read_b128 v[42:45], v7 offset:0
    ds_read_b128 v[46:49], v7 offset:64
    ds_read_b128 v[50:53], v7 offset:64
    ds_read_b128 v[54:57], v7 offset:64
    ds_read_b128 v[58:61], v7 offset:64
    ds_read_b128 v[62:65], v7 offset:128
    ds_read_b128 v[66:69], v7 offset:128
    ds_read_b128 v[70:73], v7 offset:128
    ds_read_b128 v[74:77], v7 offset:128
    ds_read_b128 v[78:81], v7 offset:192
    ds_read_b128 v[82:85], v7 offset:192
    ds_read_b128 v[86:89], v7 offset:192
    ds_read_b128 v[90:93], v7 offset:192
    ds_read_b128 v[94:97], v8 offset:0
    ds_read_b64_tr_b16 v[110:111], v24 offset:8192
    ds_read_b64_tr_b16 v[112:113], v24 offset:9216
    ds_read_b128 v[98:101], v8 offset:1024
    ds_read_b64_tr_b16 v[114:115], v25 offset:8192
    ds_read_b64_tr_b16 v[116:117], v25 offset:9216
    ds_read_b128 v[102:105], v8 offset:2048
    ds_read_b64_tr_b16 v[118:119], v26 offset:8192
    ds_read_b64_tr_b16 v[120:121], v26 offset:9216
    ds_read_b128 v[106:109], v8 offset:3072
    ds_read_b64_tr_b16 v[122:123], v27 offset:8192
    ds_read_b64_tr_b16 v[124:125], v27 offset:9216
    v_add_u32_dpp v5, v13, v9 quad_perm:[0,0,0,0] row_mask:0xf bank_mask:0xf
    s_add_u32 m0, s31, 49152
    s_nop 0
    buffer_load_dwordx4 v5, s[8:11], 0 offen lds
    s_waitcnt vmcnt(5) lgkmcnt(0)
    s_cmp_lg_u32 s3, 0
    s_cbranch_scc1 L_f56
    s_waitcnt vmcnt(9)
    v_cmp_eq_u32 vcc, 1, v21
    s_nop 0
    s_and_b32 s61, vcc_lo, 0xf
    s_cmp_eq_u32 s61, 0xf
    s_cbranch_scc1 L_d57
    s_mov_b32 s60, 1048576
L_p58:
    buffer_load_ubyte v21, v1, s[36:39], 0 offen sc0 sc1
    s_waitcnt vmcnt(0)
    v_cmp_eq_u32 vcc, 1, v21
    s_nop 0
    s_and_b32 s61, vcc_lo, 0xf
    s_cmp_eq_u32 s61, 0xf
    s_cbranch_scc1 L_d59
    s_sub_u32 s60, s60, 1
    s_cbranch_scc1 L_d59
    s_sleep 4
    s_branch L_p58
L_d59:
L_d57:
    s_mov_b32 s60, 1048576
L_w60:
    ds_read_b32 v3, v28 offset:4
    s_waitcnt lgkmcnt(0)
    v_readfirstlane_b32 s61, v3
    s_nop 0
    s_cmp_ge_u32 s61, 8
    s_cbranch_scc1 L_d61
    s_sub_u32 s60, s60, 1
    s_cbranch_scc1 L_d61
    s_sleep 1
    s_branch L_w60
L_d61:
L_f56:
    s_mov_b64 exec, 1
    ds_add_u32 v28, v29 offset:20
    s_mov_b64 exec, -1
    v_add_u32_dpp v5, v161, v9 quad_perm:[0,0,0,0] row_mask:0xf bank_mask:0xf
    s_add_u32 m0, s31, 50176
    s_nop 0
    buffer_load_dwordx4 v5, s[8:11], 0 offen lds
    s_add_u32 m0, s31, 57344
    s_mov_b32 s30, 159744
    buffer_load_dwordx4 v6, s[12:15], s30 offen lds
    ds_read_b32 v2, v28 offset:20
    s_add_u32 m0, s31, 58368
    s_mov_b32 s30, 166400
    buffer_load_dwordx4 v6, s[12:15], s30 offen lds
    s_waitcnt lgkmcnt(0)
    v_readfirstlane_b32 s61, v2
    s_nop 0
    s_cmp_ge_u32 s61, 8
    s_cbranch_scc1 L_c62
    s_mov_b32 s60, 1048576
L_w63:
    ds_read_b32 v2, v28 offset:20
    s_waitcnt lgkmcnt(0)
    v_readfirstlane_b32 s61, v2
    s_nop 0
    s_cmp_ge_u32 s61, 8
    s_cbranch_scc1 L_d64
    s_sub_u32 s60, s60, 1
    s_cbranch_scc1 L_d64
    s_branch L_w63
L_d64:
L_c62:
    v_mfma_f32_16x16x32_bf16 v[30:33], v[110:113], v[94:97], v[30:33]
    ds_read_b128 v[126:129], v8 offset:16384
    v_mfma_f32_16x16x32_bf16 v[34:37], v[110:113], v[98:101], v[34:37]
    ds_read_b64_tr_b16 v[142:143], v24 offset:24576
    v_mfma_f32_16x16x32_bf16 v[38:41], v[110:113], v[102:105], v[38:41]
    ds_read_b64_tr_b16 v[144:145], v24 offset:25600
    v_mfma_f32_16x16x32_bf16 v[42:45], v[110:113], v[106:109], v[42:45]
    ds_read_b128 v[130:133], v8 offset:17408
    v_mfma_f32_16x16x32_bf16 v[46:49], v[114:117], v[94:97], v[46:49]
    ds_read_b64_tr_b16 v[146:147], v25 offset:24576
    v_mfma_f32_16x16x32_bf16 v[50:53], v[114:117], v[98:101], v[50:53]
    ds_read_b64_tr_b16 v[148:149], v25 offset:25600
    v_mfma_f32_16x16x32_bf16 v[54:57], v[114:117], v[102:105], v[54:57]
    ds_read_b128 v[134:137], v8 offset:18432
    v_mfma_f32_16x16x32_bf16 v[58:61], v[114:117], v[106:109], v[58:61]
    ds_read_b64_tr_b16 v[150:151], v26 offset:24576
    v_mfma_f32_16x16x32_bf16 v[62:65], v[118:121], v[94:97], v[62:65]
    ds_read_b64_tr_b16 v[152:153], v26 offset:25600
    v_mfma_f32_16x16x32_bf16 v[66:69], v[118:121], v[98:101], v[66:69]
    ds_read_b128 v[138:141], v8 offset:19456
    v_mfma_f32_16x16x32_bf16 v[70:73], v[118:121], v[102:105], v[70:73]
    ds_read_b64_tr_b16 v[154:155], v27 offset:24576
    v_mfma_f32_16x16x32_bf16 v[74:77], v[118:121], v[106:109], v[74:77]
    ds_read_b64_tr_b16 v[156:157], v27 offset:25600
    v_mfma_f32_16x16x32_bf16 v[78:81], v[122:125], v[94:97], v[78:81]
    s_add_u32 s45, s44, 0
    s_add_u32 m0, s45, 85408
    s_nop 0
    buffer_load_dwordx4 v20, s[40:43], s45 offen sc1 lds
    s_waitcnt vmcnt(5) lgkmcnt(0)
    s_mov_b64 exec, 1
    ds_add_u32 v28, v29 offset:20
    s_mov_b64 exec, -1
    v_mfma_f32_16x16x32_bf16 v[82:85], v[122:125], v[98:101], v[82:85]
    s_add_u32 s45, s44, 4096
    s_add_u32 m0, s45, 85408
    s_nop 0
    buffer_load_dwordx4 v20, s[40:43], s45 offen sc1 lds
    v_mfma_f32_16x16x32_bf16 v[86:89], v[122:125], v[102:105], v[86:89]
    s_add_u32 s45, s44, 8192
    s_add_u32 m0, s45, 85408
    s_nop 0
    buffer_load_dwordx4 v20, s[40:43], s45 offen sc1 lds
    s_add_u32 s45, s44, 12288
    s_add_u32 m0, s45, 85408
    s_nop 0
    buffer_load_dwordx4 v20, s[40:43], s45 offen sc1 lds
    s_add_u32 s45, s44, 16384
    s_add_u32 m0, s45, 85408
    s_nop 0
    buffer_load_dwordx4 v20, s[40:43], s45 offen sc1 lds
    s_add_u32 s45, s44, 20480
    s_add_u32 m0, s45, 85408
    s_nop 0
    buffer_load_dwordx4 v20, s[40:43], s45 offen sc1 lds
    s_add_u32 s45, s44, 24576
    s_add_u32 m0, s45, 85408
    s_nop 0
    buffer_load_dwordx4 v20, s[40:43], s45 offen sc1 lds
    s_add_u32 s45, s44, 28672
    s_add_u32 m0, s45, 85408
    s_nop 0
    buffer_load_dwordx4 v20, s[40:43], s45 offen sc1 lds
    s_add_u32 s45, s44, 32768
    s_add_u32 m0, s45, 85408
    s_nop 0
    buffer_load_dwordx4 v20, s[40:43], s45 offen sc1 lds
    s_add_u32 s45, s44, 36864
    s_min_u32 s45, s45, 36864
    s_add_u32 m0, s45, 85408
    s_nop 0
    buffer_load_dwordx4 v20, s[40:43], s45 offen sc1 lds
    v_add_u32_dpp v5, v14, v9 quad_perm:[0,0,0,0] row_mask:0xf bank_mask:0xf
    s_add_u32 m0, s31, 0
    s_nop 0
    buffer_load_dwordx4 v5, s[8:11], 0 offen lds
    v_add_u32_dpp v5, v162, v9 quad_perm:[0,0,0,0] row_mask:0xf bank_mask:0xf
    s_add_u32 m0, s31, 1024
    s_nop 0
    buffer_load_dwordx4 v5, s[8:11], 0 offen lds
    s_add_u32 m0, s31, 8192
    s_mov_b32 s30, 212992
    buffer_load_dwordx4 v6, s[12:15], s30 offen lds
    ds_read_b32 v2, v28 offset:20
    v_mfma_f32_16x16x32_bf16 v[90:93], v[122:125], v[106:109], v[90:93]
    s_add_u32 m0, s31, 9216
    s_mov_b32 s30, 219648
    buffer_load_dwordx4 v6, s[12:15], s30 offen lds
    s_waitcnt lgkmcnt(0)
    v_readfirstlane_b32 s61, v2
    s_nop 0
    s_cmp_ge_u32 s61, 12
    s_cbranch_scc1 L_c65
    s_mov_b32 s60, 1048576
L_w66:
    ds_read_b32 v2, v28 offset:20
    s_waitcnt lgkmcnt(0)
    v_readfirstlane_b32 s61, v2
    s_nop 0
    s_cmp_ge_u32 s61, 12
    s_cbranch_scc1 L_d67
    s_sub_u32 s60, s60, 1
    s_cbranch_scc1 L_d67
    s_branch L_w66
L_d67:
L_c65:
    v_add_u32 v0, 0x10000, v8
    v_add_u32 v18, 0x10000, v24
    v_add_u32 v19, 0x10000, v25
    v_add_u32 v22, 0x10000, v26
    v_add_u32 v23, 0x10000, v27
    v_mfma_f32_16x16x32_bf16 v[30:33], v[142:145], v[126:129], v[30:33]
    ds_read_b128 v[94:97], v8 offset:32768
    v_mfma_f32_16x16x32_bf16 v[34:37], v[142:145], v[130:133], v[34:37]
    ds_read_b64_tr_b16 v[110:111], v24 offset:40960
    v_mfma_f32_16x16x32_bf16 v[38:41], v[142:145], v[134:137], v[38:41]
    ds_read_b64_tr_b16 v[112:113], v24 offset:41984
    v_mfma_f32_16x16x32_bf16 v[42:45], v[142:145], v[138:141], v[42:45]
    ds_read_b128 v[98:101], v8 offset:33792
    v_mfma_f32_16x16x32_bf16 v[46:49], v[146:149], v[126:129], v[46:49]
    ds_read_b64_tr_b16 v[114:115], v25 offset:40960
    v_mfma_f32_16x16x32_bf16 v[50:53], v[146:149], v[130:133], v[50:53]
    ds_read_b64_tr_b16 v[116:117], v25 offset:41984
    v_mfma_f32_16x16x32_bf16 v[54:57], v[146:149], v[134:137], v[54:57]
    ds_read_b128 v[102:105], v8 offset:34816
    v_mfma_f32_16x16x32_bf16 v[58:61], v[146:149], v[138:141], v[58:61]
    ds_read_b64_tr_b16 v[118:119], v26 offset:40960
    v_mfma_f32_16x16x32_bf16 v[62:65], v[150:153], v[126:129], v[62:65]
    ds_read_b64_tr_b16 v[120:121], v26 offset:41984
    v_mfma_f32_16x16x32_bf16 v[66:69], v[150:153], v[130:133], v[66:69]
    ds_read_b128 v[106:109], v8 offset:35840
    v_mfma_f32_16x16x32_bf16 v[70:73], v[150:153], v[134:137], v[70:73]
    ds_read_b64_tr_b16 v[122:123], v27 offset:40960
    v_mfma_f32_16x16x32_bf16 v[74:77], v[150:153], v[138:141], v[74:77]
    ds_read_b64_tr_b16 v[124:125], v27 offset:41984
    v_mfma_f32_16x16x32_bf16 v[78:81], v[154:157], v[126:129], v[78:81]
    v_add_u32_dpp v5, v15, v9 quad_perm:[0,0,0,0] row_mask:0xf bank_mask:0xf
    s_add_u32 m0, s31, 16384
    s_nop 0
    buffer_load_dwordx4 v5, s[8:11], 0 offen lds
    s_waitcnt vmcnt(5) lgkmcnt(0)
    s_mov_b64 exec, 1
    ds_add_u32 v28, v29 offset:20
    s_mov_b64 exec, -1
    s_mov_b64 exec, 1
    ds_add_u32 v28, v4 offset:8
    s_mov_b64 exec, -1
    v_mfma_f32_16x16x32_bf16 v[82:85], v[154:157], v[130:133], v[82:85]
    v_add_u32_dpp v5, v163, v9 quad_perm:[0,0,0,0] row_mask:0xf bank_mask:0xf
    s_add_u32 m0, s31, 17408
    s_nop 0
    buffer_load_dwordx4 v5, s[8:11], 0 offen lds
    v_mfma_f32_16x16x32_bf16 v[86:89], v[154:157], v[134:137], v[86:89]
    s_add_u32 m0, s31, 24576
    s_mov_b32 s30, 266240
    buffer_load_dwordx4 v6, s[12:15], s30 offen lds
    ds_read_b32 v2, v28 offset:20
    v_mfma_f32_16x16x32_bf16 v[90:93], v[154:157], v[138:141], v[90:93]
    s_add_u32 m0, s31, 25600
    s_mov_b32 s30, 272896
    buffer_load_dwordx4 v6, s[12:15], s30 offen lds
    s_waitcnt lgkmcnt(0)
    v_readfirstlane_b32 s61, v2
    s_nop 0
    s_cmp_ge_u32 s61, 16
    s_cbranch_scc1 L_c68
    s_mov_b32 s60, 1048576
L_w69:
    ds_read_b32 v2, v28 offset:20
    s_waitcnt lgkmcnt(0)
    v_readfirstlane_b32 s61, v2
    s_nop 0
    s_cmp_ge_u32 s61, 16
    s_cbranch_scc1 L_d70
    s_sub_u32 s60, s60, 1
    s_cbranch_scc1 L_d70
    s_branch L_w69
L_d70:
L_c68:
    v_mfma_f32_16x16x32_bf16 v[30:33], v[110:113], v[94:97], v[30:33]
    ds_read_b128 v[126:129], v8 offset:49152
    v_mfma_f32_16x16x32_bf16 v[34:37], v[110:113], v[98:101], v[34:37]
    ds_read_b64_tr_b16 v[142:143], v24 offset:57344
    v_mfma_f32_16x16x32_bf16 v[38:41], v[110:113], v[102:105], v[38:41]
    ds_read_b64_tr_b16 v[144:145], v24 offset:58368
    v_mfma_f32_16x16x32_bf16 v[42:45], v[110:113], v[106:109], v[42:45]
    ds_read_b128 v[130:133], v8 offset:50176
    v_mfma_f32_16x16x32_bf16 v[46:49], v[114:117], v[94:97], v[46:49]
    ds_read_b64_tr_b16 v[146:147], v25 offset:57344
    v_mfma_f32_16x16x32_bf16 v[50:53], v[114:117], v[98:101], v[50:53]
    ds_read_b64_tr_b16 v[148:149], v25 offset:58368
    v_mfma_f32_16x16x32_bf16 v[54:57], v[114:117], v[102:105], v[54:57]
    ds_read_b128 v[134:137], v8 offset:51200
    v_mfma_f32_16x16x32_bf16 v[58:61], v[114:117], v[106:109], v[58:61]
    ds_read_b64_tr_b16 v[150:151], v26 offset:57344
    v_mfma_f32_16x16x32_bf16 v[62:65], v[118:121], v[94:97], v[62:65]
    ds_read_b64_tr_b16 v[152:153], v26 offset:58368
    v_mfma_f32_16x16x32_bf16 v[66:69], v[118:121], v[98:101], v[66:69]
    ds_read_b128 v[138:141], v8 offset:52224
    v_mfma_f32_16x16x32_bf16 v[70:73], v[118:121], v[102:105], v[70:73]
    ds_read_b64_tr_b16 v[154:155], v27 offset:57344
    v_mfma_f32_16x16x32_bf16 v[74:77], v[118:121], v[106:109], v[74:77]
    ds_read_b64_tr_b16 v[156:157], v27 offset:58368
    v_mfma_f32_16x16x32_bf16 v[78:81], v[122:125], v[94:97], v[78:81]
    v_add_u32_dpp v5, v16, v9 quad_perm:[0,0,0,0] row_mask:0xf bank_mask:0xf
    s_add_u32 m0, s31, 32768
    s_nop 0
    buffer_load_dwordx4 v5, s[8:11], 0 offen lds
    s_waitcnt vmcnt(5) lgkmcnt(0)
    s_mov_b64 exec, 1
    ds_add_u32 v28, v29 offset:20
    s_mov_b64 exec, -1
    v_mfma_f32_16x16x32_bf16 v[82:85], v[122:125], v[98:101], v[82:85]
    v_add_u32_dpp v5, v164, v9 quad_perm:[0,0,0,0] row_mask:0xf bank_mask:0xf
    s_add_u32 m0, s31, 33792
    s_nop 0
    buffer_load_dwordx4 v5, s[8:11], 0 offen lds
    v_mfma_f32_16x16x32_bf16 v[86:89], v[122:125], v[102:105], v[86:89]
    s_add_u32 m0, s31, 40960
    s_mov_b32 s30, 319488
    buffer_load_dwordx4 v6, s[12:15], s30 offen lds
    ds_read_b32 v2, v28 offset:20
    v_mfma_f32_16x16x32_bf16 v[90:93], v[122:125], v[106:109], v[90:93]
    s_add_u32 m0, s31, 41984
    s_mov_b32 s30, 326144
    buffer_load_dwordx4 v6, s[12:15], s30 offen lds
    s_waitcnt lgkmcnt(0)
    v_readfirstlane_b32 s61, v2
    s_nop 0
    s_cmp_ge_u32 s61, 20
    s_cbranch_scc1 L_c71
    s_mov_b32 s60, 1048576
L_w72:
    ds_read_b32 v2, v28 offset:20
    s_waitcnt lgkmcnt(0)
    v_readfirstlane_b32 s61, v2
    s_nop 0
    s_cmp_ge_u32 s61, 20
    s_cbranch_scc1 L_d73
    s_sub_u32 s60, s60, 1
    s_cbranch_scc1 L_d73
    s_branch L_w72
L_d73:
L_c71:
    v_mfma_f32_16x16x32_bf16 v[30:33], v[142:145], v[126:129], v[30:33]
    ds_read_b128 v[94:97], v8 offset:0
    v_mfma_f32_16x16x32_bf16 v[34:37], v[142:145], v[130:133], v[34:37]
    ds_read_b64_tr_b16 v[110:111], v24 offset:8192
    v_mfma_f32_16x16x32_bf16 v[38:41], v[142:145], v[134:137], v[38:41]
    ds_read_b64_tr_b16 v[112:113], v24 offset:9216
    v_mfma_f32_16x16x32_bf16 v[42:45], v[142:145], v[138:141], v[42:45]
    ds_read_b128 v[98:101], v8 offset:1024
    v_mfma_f32_16x16x32_bf16 v[46:49], v[146:149], v[126:129], v[46:49]
    ds_read_b64_tr_b16 v[114:115], v25 offset:8192
    v_mfma_f32_16x16x32_bf16 v[50:53], v[146:149], v[130:133], v[50:53]
    ds_read_b64_tr_b16 v[116:117], v25 offset:9216
    v_mfma_f32_16x16x32_bf16 v[54:57], v[146:149], v[134:137], v[54:57]
    ds_read_b128 v[102:105], v8 offset:2048
    v_mfma_f32_16x16x32_bf16 v[58:61], v[146:149], v[138:141], v[58:61]
    ds_read_b64_tr_b16 v[118:119], v26 offset:8192
    v_mfma_f32_16x16x32_bf16 v[62:65], v[150:153], v[126:129], v[62:65]
    ds_read_b64_tr_b16 v[120:121], v26 offset:9216
    v_mfma_f32_16x16x32_bf16 v[66:69], v[150:153], v[130:133], v[66:69]
    ds_read_b128 v[106:109], v8 offset:3072
    v_mfma_f32_16x16x32_bf16 v[70:73], v[150:153], v[134:137], v[70:73]
    ds_read_b64_tr_b16 v[122:123], v27 offset:8192
    v_mfma_f32_16x16x32_bf16 v[74:77], v[150:153], v[138:141], v[74:77]
    ds_read_b64_tr_b16 v[124:125], v27 offset:9216
    v_mfma_f32_16x16x32_bf16 v[78:81], v[154:157], v[126:129], v[78:81]
    v_add_u32_dpp v5, v17, v9 quad_perm:[0,0,0,0] row_mask:0xf bank_mask:0xf
    s_add_u32 m0, s31, 49152
    s_nop 0
    buffer_load_dwordx4 v5, s[8:11], 0 offen lds
    s_waitcnt vmcnt(5) lgkmcnt(0)
    s_mov_b64 exec, 1
    ds_add_u32 v28, v29 offset:20
    s_mov_b64 exec, -1
    v_mfma_f32_16x16x32_bf16 v[82:85], v[154:157], v[130:133], v[82:85]
    v_add_u32_dpp v5, v165, v9 quad_perm:[0,0,0,0] row_mask:0xf bank_mask:0xf
    s_add_u32 m0, s31, 50176
    s_nop 0
    buffer_load_dwordx4 v5, s[8:11], 0 offen lds
    v_mfma_f32_16x16x32_bf16 v[86:89], v[154:157], v[134:137], v[86:89]
    s_add_u32 m0, s31, 57344
    s_mov_b32 s30, 372736
    buffer_load_dwordx4 v6, s[12:15], s30 offen lds
    ds_read_b32 v2, v28 offset:20
    v_mfma_f32_16x16x32_bf16 v[90:93], v[154:157], v[138:141], v[90:93]
    s_add_u32 m0, s31, 58368
    s_mov_b32 s30, 379392
    buffer_load_dwordx4 v6, s[12:15], s30 offen lds
    s_waitcnt lgkmcnt(0)
    v_readfirstlane_b32 s61, v2
    s_nop 0
    s_cmp_ge_u32 s61, 24
    s_cbranch_scc1 L_c74
    s_mov_b32 s60, 1048576
L_w75:
    ds_read_b32 v2, v28 offset:20
    s_waitcnt lgkmcnt(0)
    v_readfirstlane_b32 s61, v2
    s_nop 0
    s_cmp_ge_u32 s61, 24
    s_cbranch_scc1 L_d76
    s_sub_u32 s60, s60, 1
    s_cbranch_scc1 L_d76
    s_branch L_w75
L_d76:
L_c74:
    v_mfma_f32_16x16x32_bf16 v[30:33], v[110:113], v[94:97], v[30:33]
    ds_read_b128 v[126:129], v8 offset:16384
    v_mfma_f32_16x16x32_bf16 v[34:37], v[110:113], v[98:101], v[34:37]
    ds_read_b64_tr_b16 v[142:143], v24 offset:24576
    v_mfma_f32_16x16x32_bf16 v[38:41], v[110:113], v[102:105], v[38:41]
    ds_read_b64_tr_b16 v[144:145], v24 offset:25600
    v_mfma_f32_16x16x32_bf16 v[42:45], v[110:113], v[106:109], v[42:45]
    ds_read_b128 v[130:133], v8 offset:17408
    v_mfma_f32_16x16x32_bf16 v[46:49], v[114:117], v[94:97], v[46:49]
    ds_read_b64_tr_b16 v[146:147], v25 offset:24576
    v_mfma_f32_16x16x32_bf16 v[50:53], v[114:117], v[98:101], v[50:53]
    ds_read_b64_tr_b16 v[148:149], v25 offset:25600
    v_mfma_f32_16x16x32_bf16 v[54:57], v[114:117], v[102:105], v[54:57]
    ds_read_b128 v[134:137], v8 offset:18432
    v_mfma_f32_16x16x32_bf16 v[58:61], v[114:117], v[106:109], v[58:61]
    ds_read_b64_tr_b16 v[150:151], v26 offset:24576
    v_mfma_f32_16x16x32_bf16 v[62:65], v[118:121], v[94:97], v[62:65]
    ds_read_b64_tr_b16 v[152:153], v26 offset:25600
    v_mfma_f32_16x16x32_bf16 v[66:69], v[118:121], v[98:101], v[66:69]
    ds_read_b128 v[138:141], v8 offset:19456
    v_mfma_f32_16x16x32_bf16 v[70:73], v[118:121], v[102:105], v[70:73]
    ds_read_b64_tr_b16 v[154:155], v27 offset:24576
    v_mfma_f32_16x16x32_bf16 v[74:77], v[118:121], v[106:109], v[74:77]
    ds_read_b64_tr_b16 v[156:157], v27 offset:25600
    v_mfma_f32_16x16x32_bf16 v[78:81], v[122:125], v[94:97], v[78:81]
    v_add_u32_dpp v5, v10, v9 quad_perm:[1,1,1,1] row_mask:0xf bank_mask:0xf
    s_add_u32 m0, s31, 0
    s_nop 0
    buffer_load_dwordx4 v5, s[8:11], 0 offen lds
    s_waitcnt vmcnt(5) lgkmcnt(0)
    s_cmp_lg_u32 s3, 0
    s_cbranch_scc1 L_f77
    s_mov_b32 s60, 1048576
L_w78:
    ds_read_b32 v3, v28 offset:68
    s_waitcnt lgkmcnt(0)
    v_readfirstlane_b32 s61, v3
    s_nop 0
    s_cmp_ge_u32 s61, 8
    s_cbranch_scc1 L_d79
    s_sub_u32 s60, s60, 1
    s_cbranch_scc1 L_d79
    s_sleep 1
    s_branch L_w78
L_d79:
L_f77:
    s_mov_b64 exec, 1
    ds_add_u32 v28, v29 offset:20
    s_mov_b64 exec, -1
    v_mfma_f32_16x16x32_bf16 v[82:85], v[122:125], v[98:101], v[82:85]
    v_add_u32_dpp v5, v158, v9 quad_perm:[1,1,1,1] row_mask:0xf bank_mask:0xf
    s_add_u32 m0, s31, 1024
    s_nop 0
    buffer_load_dwordx4 v5, s[8:11], 0 offen lds
    v_mfma_f32_16x16x32_bf16 v[86:89], v[122:125], v[102:105], v[86:89]
    s_add_u32 m0, s31, 8192
    s_mov_b32 s30, 425984
    buffer_load_dwordx4 v6, s[12:15], s30 offen lds
    ds_read_b32 v2, v28 offset:20
    v_mfma_f32_16x16x32_bf16 v[90:93], v[122:125], v[106:109], v[90:93]
    s_add_u32 m0, s31, 9216
    s_mov_b32 s30, 432640
    buffer_load_dwordx4 v6, s[12:15], s30 offen lds
    s_waitcnt lgkmcnt(0)
    v_readfirstlane_b32 s61, v2
    s_nop 0
    s_cmp_ge_u32 s61, 28
    s_cbranch_scc1 L_c80
    s_mov_b32 s60, 1048576
L_w81:
    ds_read_b32 v2, v28 offset:20
    s_waitcnt lgkmcnt(0)
    v_readfirstlane_b32 s61, v2
    s_nop 0
    s_cmp_ge_u32 s61, 28
    s_cbranch_scc1 L_d82
    s_sub_u32 s60, s60, 1
    s_cbranch_scc1 L_d82
    s_branch L_w81
L_d82:
L_c80:
    s_cmp_lg_u32 s3, 0
    s_cbranch_scc1 L_f83
    buffer_load_ubyte v21, v1, s[36:39], 0 offen sc0 sc1
L_f83:
    v_mfma_f32_16x16x32_bf16 v[30:33], v[142:145], v[126:129], v[30:33]
    ds_read_b128 v[94:97], v8 offset:32768
    v_mfma_f32_16x16x32_bf16 v[34:37], v[142:145], v[130:133], v[34:37]
    ds_read_b64_tr_b16 v[110:111], v24 offset:40960
    v_mfma_f32_16x16x32_bf16 v[38:41], v[142:145], v[134:137], v[38:41]
    ds_read_b64_tr_b16 v[112:113], v24 offset:41984
    v_mfma_f32_16x16x32_bf16 v[42:45], v[142:145], v[138:141], v[42:45]
    ds_read_b128 v[98:101], v8 offset:33792
    v_mfma_f32_16x16x32_bf16 v[46:49], v[146:149], v[126:129], v[46:49]
    ds_read_b64_tr_b16 v[114:115], v25 offset:40960
    v_mfma_f32_16x16x32_bf16 v[50:53], v[146:149], v[130:133], v[50:53]
    ds_read_b64_tr_b16 v[116:117], v25 offset:41984
    v_mfma_f32_16x16x32_bf16 v[54:57], v[146:149], v[134:137], v[54:57]
    ds_read_b128 v[102:105], v8 offset:34816
    v_mfma_f32_16x16x32_bf16 v[58:61], v[146:149], v[138:141], v[58:61]
    ds_read_b64_tr_b16 v[118:119], v26 offset:40960
    v_mfma_f32_16x16x32_bf16 v[62:65], v[150:153], v[126:129], v[62:65]
    ds_read_b64_tr_b16 v[120:121], v26 offset:41984
    v_mfma_f32_16x16x32_bf16 v[66:69], v[150:153], v[130:133], v[66:69]
    ds_read_b128 v[106:109], v8 offset:35840
    v_mfma_f32_16x16x32_bf16 v[70:73], v[150:153], v[134:137], v[70:73]
    ds_read_b64_tr_b16 v[122:123], v27 offset:40960
    v_mfma_f32_16x16x32_bf16 v[74:77], v[150:153], v[138:141], v[74:77]
    ds_read_b64_tr_b16 v[124:125], v27 offset:41984
    v_mfma_f32_16x16x32_bf16 v[78:81], v[154:157], v[126:129], v[78:81]
    v_add_u32_dpp v5, v11, v9 quad_perm:[1,1,1,1] row_mask:0xf bank_mask:0xf
    s_add_u32 m0, s31, 16384
    s_nop 0
    buffer_load_dwordx4 v5, s[8:11], 0 offen lds
    s_waitcnt vmcnt(5) lgkmcnt(0)
    s_mov_b64 exec, 1
    ds_add_u32 v28, v29 offset:20
    s_mov_b64 exec, -1
    v_mfma_f32_16x16x32_bf16 v[82:85], v[154:157], v[130:133], v[82:85]
    v_add_u32_dpp v5, v159, v9 quad_perm:[1,1,1,1] row_mask:0xf bank_mask:0xf
    s_add_u32 m0, s31, 17408
    s_nop 0
    buffer_load_dwordx4 v5, s[8:11], 0 offen lds
    v_mfma_f32_16x16x32_bf16 v[86:89], v[154:157], v[134:137], v[86:89]
    s_add_u32 m0, s31, 24576
    s_mov_b32 s30, 479232
    buffer_load_dwordx4 v6, s[12:15], s30 offen lds
    s_add_u32 m0, s31, 25600
    s_mov_b32 s30, 485888
    buffer_load_dwordx4 v6, s[12:15], s30 offen lds
    v_add_u32_dpp v5, v12, v9 quad_perm:[1,1,1,1] row_mask:0xf bank_mask:0xf
    s_add_u32 m0, s31, 65536
    s_nop 0
    buffer_load_dwordx4 v5, s[8:11], 0 offen lds
    v_add_u32_dpp v5, v160, v9 quad_perm:[1,1,1,1] row_mask:0xf bank_mask:0xf
    s_add_u32 m0, s31, 66560
    s_nop 0
    buffer_load_dwordx4 v5, s[8:11], 0 offen lds
    s_add_u32 m0, s31, 73728
    s_mov_b32 s30, 532480
    buffer_load_dwordx4 v6, s[12:15], s30 offen lds
    ds_read_b32 v2, v28 offset:20
    v_mfma_f32_16x16x32_bf16 v[90:93], v[154:157], v[138:141], v[90:93]
    s_add_u32 m0, s31, 74752
    s_mov_b32 s30, 539136
    buffer_load_dwordx4 v6, s[12:15], s30 offen lds
    s_waitcnt lgkmcnt(0)
    v_readfirstlane_b32 s61, v2
    s_nop 0
    s_cmp_ge_u32 s61, 32
    s_cbranch_scc1 L_c84
    s_mov_b32 s60, 1048576
L_w85:
    ds_read_b32 v2, v28 offset:20
    s_waitcnt lgkmcnt(0)
    v_readfirstlane_b32 s61, v2
    s_nop 0
    s_cmp_ge_u32 s61, 32
    s_cbranch_scc1 L_d86
    s_sub_u32 s60, s60, 1
    s_cbranch_scc1 L_d86
    s_branch L_w85
L_d86:
L_c84:
    v_mfma_f32_16x16x32_bf16 v[30:33], v[110:113], v[94:97], v[30:33]
    ds_read_b128 v[126:129], v8 offset:49152
    v_mfma_f32_16x16x32_bf16 v[34:37], v[110:113], v[98:101], v[34:37]
    ds_read_b64_tr_b16 v[142:143], v24 offset:57344
    v_mfma_f32_16x16x32_bf16 v[38:41], v[110:113], v[102:105], v[38:41]
    ds_read_b64_tr_b16 v[144:145], v24 offset:58368
    v_mfma_f32_16x16x32_bf16 v[42:45], v[110:113], v[106:109], v[42:45]
    ds_read_b128 v[130:133], v8 offset:50176
    v_mfma_f32_16x16x32_bf16 v[46:49], v[114:117], v[94:97], v[46:49]
    ds_read_b64_tr_b16 v[146:147], v25 offset:57344
    v_mfma_f32_16x16x32_bf16 v[50:53], v[114:117], v[98:101], v[50:53]
    ds_read_b64_tr_b16 v[148:149], v25 offset:58368
    v_mfma_f32_16x16x32_bf16 v[54:57], v[114:117], v[102:105], v[54:57]
    ds_read_b128 v[134:137], v8 offset:51200
    v_mfma_f32_16x16x32_bf16 v[58:61], v[114:117], v[106:109], v[58:61]
    ds_read_b64_tr_b16 v[150:151], v26 offset:57344
    v_mfma_f32_16x16x32_bf16 v[62:65], v[118:121], v[94:97], v[62:65]
    ds_read_b64_tr_b16 v[152:153], v26 offset:58368
    v_mfma_f32_16x16x32_bf16 v[66:69], v[118:121], v[98:101], v[66:69]
    ds_read_b128 v[138:141], v8 offset:52224
    v_mfma_f32_16x16x32_bf16 v[70:73], v[118:121], v[102:105], v[70:73]
    ds_read_b64_tr_b16 v[154:155], v27 offset:57344
    v_mfma_f32_16x16x32_bf16 v[74:77], v[118:121], v[106:109], v[74:77]
    ds_read_b64_tr_b16 v[156:157], v27 offset:58368
    v_mfma_f32_16x16x32_bf16 v[78:81], v[122:125], v[94:97], v[78:81]
    v_add_u32_dpp v5, v13, v9 quad_perm:[1,1,1,1] row_mask:0xf bank_mask:0xf
    s_add_u32 m0, s31, 32768
    s_nop 0
    buffer_load_dwordx4 v5, s[8:11], 0 offen lds
    s_waitcnt vmcnt(9) lgkmcnt(0)
    s_mov_b64 exec, 1
    ds_add_u32 v28, v29 offset:20
    s_mov_b64 exec, -1
    v_mfma_f32_16x16x32_bf16 v[82:85], v[122:125], v[98:101], v[82:85]
    v_add_u32_dpp v5, v161, v9 quad_perm:[1,1,1,1] row_mask:0xf bank_mask:0xf
    s_add_u32 m0, s31, 33792
    s_nop 0
    buffer_load_dwordx4 v5, s[8:11], 0 offen lds
    v_mfma_f32_16x16x32_bf16 v[86:89], v[122:125], v[102:105], v[86:89]
    s_add_u32 m0, s31, 40960
    s_mov_b32 s30, 585728
    buffer_load_dwordx4 v6, s[12:15], s30 offen lds
    ds_read_b32 v2, v28 offset:20
    v_mfma_f32_16x16x32_bf16 v[90:93], v[122:125], v[106:109], v[90:93]
    s_add_u32 m0, s31, 41984
    s_mov_b32 s30, 592384
    buffer_load_dwordx4 v6, s[12:15], s30 offen lds
    s_waitcnt lgkmcnt(0)
    v_readfirstlane_b32 s61, v2
    s_nop 0
    s_cmp_ge_u32 s61, 36
    s_cbranch_scc1 L_c87
    s_mov_b32 s60, 1048576
L_w88:
    ds_read_b32 v2, v28 offset:20
    s_waitcnt lgkmcnt(0)
    v_readfirstlane_b32 s61, v2
    s_nop 0
    s_cmp_ge_u32 s61, 36
    s_cbranch_scc1 L_d89
    s_sub_u32 s60, s60, 1
    s_cbranch_scc1 L_d89
    s_branch L_w88
L_d89:
L_c87:
    v_mfma_f32_16x16x32_bf16 v[30:33], v[142:145], v[126:129], v[30:33]
    ds_read_b128 v[94:97], v8 offset:0
    v_mfma_f32_16x16x32_bf16 v[34:37], v[142:145], v[130:133], v[34:37]
    ds_read_b64_tr_b16 v[110:111], v24 offset:8192
    v_mfma_f32_16x16x32_bf16 v[38:41], v[142:145], v[134:137], v[38:41]
    ds_read_b64_tr_b16 v[112:113], v24 offset:9216
    v_mfma_f32_16x16x32_bf16 v[42:45], v[142:145], v[138:141], v[42:45]
    ds_read_b128 v[98:101], v8 offset:1024
    v_mfma_f32_16x16x32_bf16 v[46:49], v[146:149], v[126:129], v[46:49]
    ds_read_b64_tr_b16 v[114:115], v25 offset:8192
    v_mfma_f32_16x16x32_bf16 v[50:53], v[146:149], v[130:133], v[50:53]
    ds_read_b64_tr_b16 v[116:117], v25 offset:9216
    v_mfma_f32_16x16x32_bf16 v[54:57], v[146:149], v[134:137], v[54:57]
    ds_read_b128 v[102:105], v8 offset:2048
    v_mfma_f32_16x16x32_bf16 v[58:61], v[146:149], v[138:141], v[58:61]
    ds_read_b64_tr_b16 v[118:119], v26 offset:8192
    v_mfma_f32_16x16x32_bf16 v[62:65], v[150:153], v[126:129], v[62:65]
    ds_read_b64_tr_b16 v[120:121], v26 offset:9216
    v_mfma_f32_16x16x32_bf16 v[66:69], v[150:153], v[130:133], v[66:69]
    ds_read_b128 v[106:109], v8 offset:3072
    v_mfma_f32_16x16x32_bf16 v[70:73], v[150:153], v[134:137], v[70:73]
    ds_read_b64_tr_b16 v[122:123], v27 offset:8192
    v_mfma_f32_16x16x32_bf16 v[74:77], v[150:153], v[138:141], v[74:77]
    ds_read_b64_tr_b16 v[124:125], v27 offset:9216
    v_mfma_f32_16x16x32_bf16 v[78:81], v[154:157], v[126:129], v[78:81]
    v_add_u32_dpp v5, v14, v9 quad_perm:[1,1,1,1] row_mask:0xf bank_mask:0xf
    s_add_u32 m0, s31, 49152
    s_nop 0
    buffer_load_dwordx4 v5, s[8:11], 0 offen lds
    s_waitcnt vmcnt(9) lgkmcnt(0)
    s_cmp_lg_u32 s3, 0
    s_cbranch_scc1 L_f90
    s_waitcnt vmcnt(13)
    v_cmp_eq_u32 vcc, 1, v21
    s_nop 0
    s_and_b32 s61, vcc_lo, 0x10
    s_cmp_eq_u32 s61, 0x10
    s_cbranch_scc1 L_d91
    s_mov_b32 s60, 1048576
L_p92:
    buffer_load_ubyte v21, v1, s[36:39], 0 offen sc0 sc1
    s_waitcnt vmcnt(0)
    v_cmp_eq_u32 vcc, 1, v21
    s_nop 0
    s_and_b32 s61, vcc_lo, 0x10
    s_cmp_eq_u32 s61, 0x10
    s_cbranch_scc1 L_d93
    s_sub_u32 s60, s60, 1
    s_cbranch_scc1 L_d93
    s_sleep 4
    s_branch L_p92
L_d93:
L_d91:
    s_mov_b32 s60, 1048576
L_w94:
    ds_read_b32 v3, v28 offset:36
    s_waitcnt lgkmcnt(0)
    v_readfirstlane_b32 s61, v3
    s_nop 0
    s_cmp_ge_u32 s61, 8
    s_cbranch_scc1 L_d95
    s_sub_u32 s60, s60, 1
    s_cbranch_scc1 L_d95
    s_sleep 1
    s_branch L_w94
L_d95:
L_f90:
    s_mov_b64 exec, 1
    ds_add_u32 v28, v29 offset:20
    s_mov_b64 exec, -1
    v_mfma_f32_16x16x32_bf16 v[82:85], v[154:157], v[130:133], v[82:85]
    v_add_u32_dpp v5, v162, v9 quad_perm:[1,1,1,1] row_mask:0xf bank_mask:0xf
    s_add_u32 m0, s31, 50176
    s_nop 0
    buffer_load_dwordx4 v5, s[8:11], 0 offen lds
    v_mfma_f32_16x16x32_bf16 v[86:89], v[154:157], v[134:137], v[86:89]
    s_add_u32 m0, s31, 57344
    s_mov_b32 s30, 638976
    buffer_load_dwordx4 v6, s[12:15], s30 offen lds
    ds_read_b32 v2, v28 offset:20
    v_mfma_f32_16x16x32_bf16 v[90:93], v[154:157], v[138:141], v[90:93]
    s_add_u32 m0, s31, 58368
    s_mov_b32 s30, 645632
    buffer_load_dwordx4 v6, s[12:15], s30 offen lds
    s_waitcnt lgkmcnt(0)
    v_readfirstlane_b32 s61, v2
    s_nop 0
    s_cmp_ge_u32 s61, 40
    s_cbranch_scc1 L_c96
    s_mov_b32 s60, 1048576
L_w97:
    ds_read_b32 v2, v28 offset:20
    s_waitcnt lgkmcnt(0)
    v_readfirstlane_b32 s61, v2
    s_nop 0
    s_cmp_ge_u32 s61, 40
    s_cbranch_scc1 L_d98
    s_sub_u32 s60, s60, 1
    s_cbranch_scc1 L_d98
    s_branch L_w97
L_d98:
L_c96:
    v_mfma_f32_16x16x32_bf16 v[30:33], v[110:113], v[94:97], v[30:33]
    ds_read_b128 v[126:129], v8 offset:16384
    v_mfma_f32_16x16x32_bf16 v[34:37], v[110:113], v[98:101], v[34:37]
    ds_read_b64_tr_b16 v[142:143], v24 offset:24576
    v_mfma_f32_16x16x32_bf16 v[38:41], v[110:113], v[102:105], v[38:41]
    ds_read_b64_tr_b16 v[144:145], v24 offset:25600
    v_mfma_f32_16x16x32_bf16 v[42:45], v[110:113], v[106:109], v[42:45]
    ds_read_b128 v[130:133], v8 offset:17408
    v_mfma_f32_16x16x32_bf16 v[46:49], v[114:117], v[94:97], v[46:49]
    ds_read_b64_tr_b16 v[146:147], v25 offset:24576
    v_mfma_f32_16x16x32_bf16 v[50:53], v[114:117], v[98:101], v[50:53]
    ds_read_b64_tr_b16 v[148:149], v25 offset:25600
    v_mfma_f32_16x16x32_bf16 v[54:57], v[114:117], v[102:105], v[54:57]
    ds_read_b128 v[134:137], v8 offset:18432
    v_mfma_f32_16x16x32_bf16 v[58:61], v[114:117], v[106:109], v[58:61]
    ds_read_b64_tr_b16 v[150:151], v26 offset:24576
    v_mfma_f32_16x16x32_bf16 v[62:65], v[118:121], v[94:97], v[62:65]
    ds_read_b64_tr_b16 v[152:153], v26 offset:25600
    v_mfma_f32_16x16x32_bf16 v[66:69], v[118:121], v[98:101], v[66:69]
    ds_read_b128 v[138:141], v8 offset:19456
    v_mfma_f32_16x16x32_bf16 v[70:73], v[118:121], v[102:105], v[70:73]
    ds_read_b64_tr_b16 v[154:155], v27 offset:24576
    v_mfma_f32_16x16x32_bf16 v[74:77], v[118:121], v[106:109], v[74:77]
    ds_read_b64_tr_b16 v[156:157], v27 offset:25600
    v_mfma_f32_16x16x32_bf16 v[78:81], v[122:125], v[94:97], v[78:81]
    v_add_u32_dpp v5, v15, v9 quad_perm:[1,1,1,1] row_mask:0xf bank_mask:0xf
    s_add_u32 m0, s31, 0
    s_nop 0
    buffer_load_dwordx4 v5, s[8:11], 0 offen lds
    s_waitcnt vmcnt(9) lgkmcnt(0)
    s_mov_b64 exec, 1
    ds_add_u32 v28, v29 offset:20
    s_mov_b64 exec, -1
    v_mfma_f32_16x16x32_bf16 v[82:85], v[122:125], v[98:101], v[82:85]
    v_add_u32_dpp v5, v163, v9 quad_perm:[1,1,1,1] row_mask:0xf bank_mask:0xf
    s_add_u32 m0, s31, 1024
    s_nop 0
    buffer_load_dwordx4 v5, s[8:11], 0 offen lds
    v_mfma_f32_16x16x32_bf16 v[86:89], v[122:125], v[102:105], v[86:89]
    s_add_u32 m0, s31, 8192
    s_mov_b32 s30, 692224
    buffer_load_dwordx4 v6, s[12:15], s30 offen lds
    s_add_u32 m0, s31, 9216
    s_mov_b32 s30, 698880
    buffer_load_dwordx4 v6, s[12:15], s30 offen lds
    s_add_u32 s45, s44, 0
    s_add_u32 m0, s45, 123296
    s_nop 0
    buffer_load_dwordx4 v20, s[48:51], s45 offen sc1 lds
    ds_read_b32 v2, v28 offset:20
    v_mfma_f32_16x16x32_bf16 v[90:93], v[122:125], v[106:109], v[90:93]
    s_add_u32 s45, s44, 4096
    s_add_u32 m0, s45, 123296
    s_nop 0
    buffer_load_dwordx4 v20, s[48:51], s45 offen sc1 lds
    s_waitcnt lgkmcnt(0)
    v_readfirstlane_b32 s61, v2
    s_nop 0
    s_cmp_ge_u32 s61, 44
    s_cbranch_scc1 L_c99
    s_mov_b32 s60, 1048576
L_w100:
    ds_read_b32 v2, v28 offset:20
    s_waitcnt lgkmcnt(0)
    v_readfirstlane_b32 s61, v2
    s_nop 0
    s_cmp_ge_u32 s61, 44
    s_cbranch_scc1 L_d101
    s_sub_u32 s60, s60, 1
    s_cbranch_scc1 L_d101
    s_branch L_w100
L_d101:
L_c99:
    v_mfma_f32_16x16x32_bf16 v[30:33], v[142:145], v[126:129], v[30:33]
    ds_read_b128 v[94:97], v0 offset:0
    v_mfma_f32_16x16x32_bf16 v[34:37], v[142:145], v[130:133], v[34:37]
    ds_read_b64_tr_b16 v[110:111], v18 offset:8192
    v_mfma_f32_16x16x32_bf16 v[38:41], v[142:145], v[134:137], v[38:41]
    ds_read_b64_tr_b16 v[112:113], v18 offset:9216
    v_mfma_f32_16x16x32_bf16 v[42:45], v[142:145], v[138:141], v[42:45]
    ds_read_b128 v[98:101], v0 offset:1024
    v_mfma_f32_16x16x32_bf16 v[46:49], v[146:149], v[126:129], v[46:49]
    ds_read_b64_tr_b16 v[114:115], v19 offset:8192
    v_mfma_f32_16x16x32_bf16 v[50:53], v[146:149], v[130:133], v[50:53]
    ds_read_b64_tr_b16 v[116:117], v19 offset:9216
    v_mfma_f32_16x16x32_bf16 v[54:57], v[146:149], v[134:137], v[54:57]
    ds_read_b128 v[102:105], v0 offset:2048
    v_mfma_f32_16x16x32_bf16 v[58:61], v[146:149], v[138:141], v[58:61]
    ds_read_b64_tr_b16 v[118:119], v22 offset:8192
    v_mfma_f32_16x16x32_bf16 v[62:65], v[150:153], v[126:129], v[62:65]
    ds_read_b64_tr_b16 v[120:121], v22 offset:9216
    v_mfma_f32_16x16x32_bf16 v[66:69], v[150:153], v[130:133], v[66:69]
    ds_read_b128 v[106:109], v0 offset:3072
    v_mfma_f32_16x16x32_bf16 v[70:73], v[150:153], v[134:137], v[70:73]
    ds_read_b64_tr_b16 v[122:123], v23 offset:8192
    v_mfma_f32_16x16x32_bf16 v[74:77], v[150:153], v[138:141], v[74:77]
    ds_read_b64_tr_b16 v[124:125], v23 offset:9216
    v_mfma_f32_16x16x32_bf16 v[78:81], v[154:157], v[126:129], v[78:81]
    v_add_u32_dpp v5, v16, v9 quad_perm:[1,1,1,1] row_mask:0xf bank_mask:0xf
    s_add_u32 m0, s31, 16384
    s_nop 0
    buffer_load_dwordx4 v5, s[8:11], 0 offen lds
    s_waitcnt vmcnt(11) lgkmcnt(0)
    s_mov_b64 exec, 1
    ds_add_u32 v28, v29 offset:20
    s_mov_b64 exec, -1
    v_mfma_f32_16x16x32_bf16 v[82:85], v[154:157], v[130:133], v[82:85]
    v_add_u32_dpp v5, v164, v9 quad_perm:[1,1,1,1] row_mask:0xf bank_mask:0xf
    s_add_u32 m0, s31, 17408
    s_nop 0
    buffer_load_dwordx4 v5, s[8:11], 0 offen lds
    v_mfma_f32_16x16x32_bf16 v[86:89], v[154:157], v[134:137], v[86:89]
    s_add_u32 m0, s31, 24576
    s_mov_b32 s30, 745472
    buffer_load_dwordx4 v6, s[12:15], s30 offen lds
    s_add_u32 m0, s31, 25600
    s_mov_b32 s30, 752128
    buffer_load_dwordx4 v6, s[12:15], s30 offen lds
    s_add_u32 s45, s44, 8192
    s_add_u32 m0, s45, 123296
    s_nop 0
    buffer_load_dwordx4 v20, s[48:51], s45 offen sc1 lds
    ds_read_b32 v2, v28 offset:20
    v_mfma_f32_16x16x32_bf16 v[90:93], v[154:157], v[138:141], v[90:93]
    s_add_u32 s45, s44, 12288
    s_add_u32 m0, s45, 123296
    s_nop 0
    buffer_load_dwordx4 v20, s[48:51], s45 offen sc1 lds
    s_waitcnt lgkmcnt(0)
    v_readfirstlane_b32 s61, v2
    s_nop 0
    s_cmp_ge_u32 s61, 48
    s_cbranch_scc1 L_c102
    s_mov_b32 s60, 1048576
L_w103:
    ds_read_b32 v2, v28 offset:20
    s_waitcnt lgkmcnt(0)
    v_readfirstlane_b32 s61, v2
    s_nop 0
    s_cmp_ge_u32 s61, 48
    s_cbranch_scc1 L_d104
    s_sub_u32 s60, s60, 1
    s_cbranch_scc1 L_d104
    s_branch L_w103
L_d104:
L_c102:
    v_mfma_f32_16x16x32_bf16 v[30:33], v[110:113], v[94:97], v[30:33]
    ds_read_b128 v[126:129], v8 offset:32768
    v_mfma_f32_16x16x32_bf16 v[34:37], v[110:113], v[98:101], v[34:37]
    ds_read_b64_tr_b16 v[142:143], v24 offset:40960
    v_mfma_f32_16x16x32_bf16 v[38:41], v[110:113], v[102:105], v[38:41]
    ds_read_b64_tr_b16 v[144:145], v24 offset:41984
    v_mfma_f32_16x16x32_bf16 v[42:45], v[110:113], v[106:109], v[42:45]
    ds_read_b128 v[130:133], v8 offset:33792
    v_mfma_f32_16x16x32_bf16 v[46:49], v[114:117], v[94:97], v[46:49]
    ds_read_b64_tr_b16 v[146:147], v25 offset:40960
    v_mfma_f32_16x16x32_bf16 v[50:53], v[114:117], v[98:101], v[50:53]
    ds_read_b64_tr_b16 v[148:149], v25 offset:41984
    v_mfma_f32_16x16x32_bf16 v[54:57], v[114:117], v[102:105], v[54:57]
    ds_read_b128 v[134:137], v8 offset:34816
    v_mfma_f32_16x16x32_bf16 v[58:61], v[114:117], v[106:109], v[58:61]
    ds_read_b64_tr_b16 v[150:151], v26 offset:40960
    v_mfma_f32_16x16x32_bf16 v[62:65], v[118:121], v[94:97], v[62:65]
    ds_read_b64_tr_b16 v[152:153], v26 offset:41984
    v_mfma_f32_16x16x32_bf16 v[66:69], v[118:121], v[98:101], v[66:69]
    ds_read_b128 v[138:141], v8 offset:35840
    v_mfma_f32_16x16x32_bf16 v[70:73], v[118:121], v[102:105], v[70:73]
    ds_read_b64_tr_b16 v[154:155], v27 offset:40960
    v_mfma_f32_16x16x32_bf16 v[74:77], v[118:121], v[106:109], v[74:77]
    ds_read_b64_tr_b16 v[156:157], v27 offset:41984
    v_mfma_f32_16x16x32_bf16 v[78:81], v[122:125], v[94:97], v[78:81]
    v_add_u32_dpp v5, v17, v9 quad_perm:[1,1,1,1] row_mask:0xf bank_mask:0xf
    s_add_u32 m0, s31, 65536
    s_nop 0
    buffer_load_dwordx4 v5, s[8:11], 0 offen lds
    s_waitcnt vmcnt(13) lgkmcnt(0)
    s_mov_b64 exec, 1
    ds_add_u32 v28, v29 offset:20
    s_mov_b64 exec, -1
    v_mfma_f32_16x16x32_bf16 v[82:85], v[122:125], v[98:101], v[82:85]
    v_add_u32_dpp v5, v165, v9 quad_perm:[1,1,1,1] row_mask:0xf bank_mask:0xf
    s_add_u32 m0, s31, 66560
    s_nop 0
    buffer_load_dwordx4 v5, s[8:11], 0 offen lds
    v_mfma_f32_16x16x32_bf16 v[86:89], v[122:125], v[102:105], v[86:89]
    s_add_u32 m0, s31, 73728
    s_mov_b32 s30, 798720
    buffer_load_dwordx4 v6, s[12:15], s30 offen lds
    s_add_u32 m0, s31, 74752
    s_mov_b32 s30, 805376
    buffer_load_dwordx4 v6, s[12:15], s30 offen lds
    s_add_u32 s45, s44, 16384
    s_add_u32 m0, s45, 123296
    s_nop 0
    buffer_load_dwordx4 v20, s[48:51], s45 offen sc1 lds
    ds_read_b32 v2, v28 offset:20
    v_mfma_f32_16x16x32_bf16 v[90:93], v[122:125], v[106:109], v[90:93]
    s_add_u32 s45, s44, 20480
    s_add_u32 m0, s45, 123296
    s_nop 0
    buffer_load_dwordx4 v20, s[48:51], s45 offen sc1 lds
    s_waitcnt lgkmcnt(0)
    v_readfirstlane_b32 s61, v2
    s_nop 0
    s_cmp_ge_u32 s61, 52
    s_cbranch_scc1 L_c105
    s_mov_b32 s60, 1048576
L_w106:
    ds_read_b32 v2, v28 offset:20
    s_waitcnt lgkmcnt(0)
    v_readfirstlane_b32 s61, v2
    s_nop 0
    s_cmp_ge_u32 s61, 52
    s_cbranch_scc1 L_d107
    s_sub_u32 s60, s60, 1
    s_cbranch_scc1 L_d107
    s_branch L_w106
L_d107:
L_c105:
    v_mfma_f32_16x16x32_bf16 v[30:33], v[142:145], v[126:129], v[30:33]
    ds_read_b128 v[94:97], v8 offset:49152
    v_mfma_f32_16x16x32_bf16 v[34:37], v[142:145], v[130:133], v[34:37]
    ds_read_b64_tr_b16 v[110:111], v24 offset:57344
    v_mfma_f32_16x16x32_bf16 v[38:41], v[142:145], v[134:137], v[38:41]
    ds_read_b64_tr_b16 v[112:113], v24 offset:58368
    v_mfma_f32_16x16x32_bf16 v[42:45], v[142:145], v[138:141], v[42:45]
    ds_read_b128 v[98:101], v8 offset:50176
    v_mfma_f32_16x16x32_bf16 v[46:49], v[146:149], v[126:129], v[46:49]
    ds_read_b64_tr_b16 v[114:115], v25 offset:57344
    v_mfma_f32_16x16x32_bf16 v[50:53], v[146:149], v[130:133], v[50:53]
    ds_read_b64_tr_b16 v[116:117], v25 offset:58368
    v_mfma_f32_16x16x32_bf16 v[54:57], v[146:149], v[134:137], v[54:57]
    ds_read_b128 v[102:105], v8 offset:51200
    v_mfma_f32_16x16x32_bf16 v[58:61], v[146:149], v[138:141], v[58:61]
    ds_read_b64_tr_b16 v[118:119], v26 offset:57344
    v_mfma_f32_16x16x32_bf16 v[62:65], v[150:153], v[126:129], v[62:65]
    ds_read_b64_tr_b16 v[120:121], v26 offset:58368
    v_mfma_f32_16x16x32_bf16 v[66:69], v[150:153], v[130:133], v[66:69]
    ds_read_b128 v[106:109], v8 offset:52224
    v_mfma_f32_16x16x32_bf16 v[70:73], v[150:153], v[134:137], v[70:73]
    ds_read_b64_tr_b16 v[122:123], v27 offset:57344
    v_mfma_f32_16x16x32_bf16 v[74:77], v[150:153], v[138:141], v[74:77]
    ds_read_b64_tr_b16 v[124:125], v27 offset:58368
    v_mfma_f32_16x16x32_bf16 v[78:81], v[154:157], v[126:129], v[78:81]
    v_add_u32_dpp v5, v10, v9 quad_perm:[2,2,2,2] row_mask:0xf bank_mask:0xf
    s_add_u32 m0, s31, 32768
    s_nop 0
    buffer_load_dwordx4 v5, s[8:11], 0 offen lds
    s_waitcnt vmcnt(15) lgkmcnt(0)
    s_mov_b64 exec, 1
    ds_add_u32 v28, v29 offset:20
    s_mov_b64 exec, -1
    v_mfma_f32_16x16x32_bf16 v[82:85], v[154:157], v[130:133], v[82:85]
    v_add_u32_dpp v5, v158, v9 quad_perm:[2,2,2,2] row_mask:0xf bank_mask:0xf
    s_add_u32 m0, s31, 33792
    s_nop 0
    buffer_load_dwordx4 v5, s[8:11], 0 offen lds
    v_mfma_f32_16x16x32_bf16 v[86:89], v[154:157], v[134:137], v[86:89]
    s_add_u32 m0, s31, 40960
    s_mov_b32 s30, 851968
    buffer_load_dwordx4 v6, s[12:15], s30 offen lds
    s_add_u32 m0, s31, 41984
    s_mov_b32 s30, 858624
    buffer_load_dwordx4 v6, s[12:15], s30 offen lds
    s_add_u32 s45, s44, 24576
    s_add_u32 m0, s45, 123296
    s_nop 0
    buffer_load_dwordx4 v20, s[48:51], s45 offen sc1 lds
    ds_read_b32 v2, v28 offset:20
    v_mfma_f32_16x16x32_bf16 v[90:93], v[154:157], v[138:141], v[90:93]
    s_add_u32 s45, s44, 28672
    s_add_u32 m0, s45, 123296
    s_nop 0
    buffer_load_dwordx4 v20, s[48:51], s45 offen sc1 lds
    s_waitcnt lgkmcnt(0)
    v_readfirstlane_b32 s61, v2
    s_nop 0
    s_cmp_ge_u32 s61, 56
    s_cbranch_scc1 L_c108
    s_mov_b32 s60, 1048576
L_w109:
    ds_read_b32 v2, v28 offset:20
    s_waitcnt lgkmcnt(0)
    v_readfirstlane_b32 s61, v2
    s_nop 0
    s_cmp_ge_u32 s61, 56
    s_cbranch_scc1 L_d110
    s_sub_u32 s60, s60, 1
    s_cbranch_scc1 L_d110
    s_branch L_w109
L_d110:
L_c108:
    v_mfma_f32_16x16x32_bf16 v[30:33], v[110:113], v[94:97], v[30:33]
    ds_read_b128 v[126:129], v8 offset:0
    v_mfma_f32_16x16x32_bf16 v[34:37], v[110:113], v[98:101], v[34:37]
    ds_read_b64_tr_b16 v[142:143], v24 offset:8192
    v_mfma_f32_16x16x32_bf16 v[38:41], v[110:113], v[102:105], v[38:41]
    ds_read_b64_tr_b16 v[144:145], v24 offset:9216
    v_mfma_f32_16x16x32_bf16 v[42:45], v[110:113], v[106:109], v[42:45]
    ds_read_b128 v[130:133], v8 offset:1024
    v_mfma_f32_16x16x32_bf16 v[46:49], v[114:117], v[94:97], v[46:49]
    ds_read_b64_tr_b16 v[146:147], v25 offset:8192
    v_mfma_f32_16x16x32_bf16 v[50:53], v[114:117], v[98:101], v[50:53]
    ds_read_b64_tr_b16 v[148:149], v25 offset:9216
    v_mfma_f32_16x16x32_bf16 v[54:57], v[114:117], v[102:105], v[54:57]
    ds_read_b128 v[134:137], v8 offset:2048
    v_mfma_f32_16x16x32_bf16 v[58:61], v[114:117], v[106:109], v[58:61]
    ds_read_b64_tr_b16 v[150:151], v26 offset:8192
    v_mfma_f32_16x16x32_bf16 v[62:65], v[118:121], v[94:97], v[62:65]
    ds_read_b64_tr_b16 v[152:153], v26 offset:9216
    v_mfma_f32_16x16x32_bf16 v[66:69], v[118:121], v[98:101], v[66:69]
    ds_read_b128 v[138:141], v8 offset:3072
    v_mfma_f32_16x16x32_bf16 v[70:73], v[118:121], v[102:105], v[70:73]
    ds_read_b64_tr_b16 v[154:155], v27 offset:8192
    v_mfma_f32_16x16x32_bf16 v[74:77], v[118:121], v[106:109], v[74:77]
    ds_read_b64_tr_b16 v[156:157], v27 offset:9216
    v_mfma_f32_16x16x32_bf16 v[78:81], v[122:125], v[94:97], v[78:81]
    v_add_u32_dpp v5, v11, v9 quad_perm:[2,2,2,2] row_mask:0xf bank_mask:0xf
    s_add_u32 m0, s31, 49152
    s_nop 0
    buffer_load_dwordx4 v5, s[8:11], 0 offen lds
    s_waitcnt vmcnt(15) lgkmcnt(0)
    s_mov_b64 exec, 1
    ds_add_u32 v28, v29 offset:20
    s_mov_b64 exec, -1
    v_mfma_f32_16x16x32_bf16 v[82:85], v[122:125], v[98:101], v[82:85]
    v_add_u32_dpp v5, v159, v9 quad_perm:[2,2,2,2] row_mask:0xf bank_mask:0xf
    s_add_u32 m0, s31, 50176
    s_nop 0
    buffer_load_dwordx4 v5, s[8:11], 0 offen lds
    v_mfma_f32_16x16x32_bf16 v[86:89], v[122:125], v[102:105], v[86:89]
    s_add_u32 m0, s31, 57344
    s_mov_b32 s30, 905216
    buffer_load_dwordx4 v6, s[12:15], s30 offen lds
    s_add_u32 m0, s31, 58368
    s_mov_b32 s30, 911872
    buffer_load_dwordx4 v6, s[12:15], s30 offen lds
    s_add_u32 s45, s44, 32768
    s_add_u32 m0, s45, 123296
    s_nop 0
    buffer_load_dwordx4 v20, s[48:51], s45 offen sc1 lds
    ds_read_b32 v2, v28 offset:20
    v_mfma_f32_16x16x32_bf16 v[90:93], v[122:125], v[106:109], v[90:93]
    s_add_u32 s45, s44, 36864
    s_min_u32 s45, s45, 36864
    s_add_u32 m0, s45, 123296
    s_nop 0
    buffer_load_dwordx4 v20, s[48:51], s45 offen sc1 lds
    s_waitcnt lgkmcnt(0)
    v_readfirstlane_b32 s61, v2
    s_nop 0
    s_cmp_ge_u32 s61, 60
    s_cbranch_scc1 L_c111
    s_mov_b32 s60, 1048576
L_w112:
    ds_read_b32 v2, v28 offset:20
    s_waitcnt lgkmcnt(0)
    v_readfirstlane_b32 s61, v2
    s_nop 0
    s_cmp_ge_u32 s61, 60
    s_cbranch_scc1 L_d113
    s_sub_u32 s60, s60, 1
    s_cbranch_scc1 L_d113
    s_branch L_w112
L_d113:
L_c111:
    v_mfma_f32_16x16x32_bf16 v[30:33], v[142:145], v[126:129], v[30:33]
    ds_read_b128 v[94:97], v8 offset:16384
    v_mfma_f32_16x16x32_bf16 v[34:37], v[142:145], v[130:133], v[34:37]
    ds_read_b64_tr_b16 v[110:111], v24 offset:24576
    v_mfma_f32_16x16x32_bf16 v[38:41], v[142:145], v[134:137], v[38:41]
    ds_read_b64_tr_b16 v[112:113], v24 offset:25600
    v_mfma_f32_16x16x32_bf16 v[42:45], v[142:145], v[138:141], v[42:45]
    ds_read_b128 v[98:101], v8 offset:17408
    v_mfma_f32_16x16x32_bf16 v[46:49], v[146:149], v[126:129], v[46:49]
    ds_read_b64_tr_b16 v[114:115], v25 offset:24576
    v_mfma_f32_16x16x32_bf16 v[50:53], v[146:149], v[130:133], v[50:53]
    ds_read_b64_tr_b16 v[116:117], v25 offset:25600
    v_mfma_f32_16x16x32_bf16 v[54:57], v[146:149], v[134:137], v[54:57]
    ds_read_b128 v[102:105], v8 offset:18432
    v_mfma_f32_16x16x32_bf16 v[58:61], v[146:149], v[138:141], v[58:61]
    ds_read_b64_tr_b16 v[118:119], v26 offset:24576
    v_mfma_f32_16x16x32_bf16 v[62:65], v[150:153], v[126:129], v[62:65]
    ds_read_b64_tr_b16 v[120:121], v26 offset:25600
    v_mfma_f32_16x16x32_bf16 v[66:69], v[150:153], v[130:133], v[66:69]
    ds_read_b128 v[106:109], v8 offset:19456
    v_mfma_f32_16x16x32_bf16 v[70:73], v[150:153], v[134:137], v[70:73]
    ds_read_b64_tr_b16 v[122:123], v27 offset:24576
    v_mfma_f32_16x16x32_bf16 v[74:77], v[150:153], v[138:141], v[74:77]
    ds_read_b64_tr_b16 v[124:125], v27 offset:25600
    v_mfma_f32_16x16x32_bf16 v[78:81], v[154:157], v[126:129], v[78:81]
    v_add_u32_dpp v5, v12, v9 quad_perm:[2,2,2,2] row_mask:0xf bank_mask:0xf
    s_add_u32 m0, s31, 0
    s_nop 0
    buffer_load_dwordx4 v5, s[8:11], 0 offen lds
    s_waitcnt vmcnt(15) lgkmcnt(0)
    s_mov_b64 exec, 1
    ds_add_u32 v28, v29 offset:20
    s_mov_b64 exec, -1
    v_mfma_f32_16x16x32_bf16 v[82:85], v[154:157], v[130:133], v[82:85]
    v_add_u32_dpp v5, v160, v9 quad_perm:[2,2,2,2] row_mask:0xf bank_mask:0xf
    s_add_u32 m0, s31, 1024
    s_nop 0
    buffer_load_dwordx4 v5, s[8:11], 0 offen lds
    v_mfma_f32_16x16x32_bf16 v[86:89], v[154:157], v[134:137], v[86:89]
    s_add_u32 m0, s31, 8192
    s_mov_b32 s30, 958464
    buffer_load_dwordx4 v6, s[12:15], s30 offen lds
    ds_read_b32 v2, v28 offset:20
    v_mfma_f32_16x16x32_bf16 v[90:93], v[154:157], v[138:141], v[90:93]
    s_add_u32 m0, s31, 9216
    s_mov_b32 s30, 965120
    buffer_load_dwordx4 v6, s[12:15], s30 offen lds
    s_waitcnt lgkmcnt(0)
    v_readfirstlane_b32 s61, v2
    s_nop 0
    s_cmp_ge_u32 s61, 64
    s_cbranch_scc1 L_c114
    s_mov_b32 s60, 1048576
L_w115:
    ds_read_b32 v2, v28 offset:20
    s_waitcnt lgkmcnt(0)
    v_readfirstlane_b32 s61, v2
    s_nop 0
    s_cmp_ge_u32 s61, 64
    s_cbranch_scc1 L_d116
    s_sub_u32 s60, s60, 1
    s_cbranch_scc1 L_d116
    s_branch L_w115
L_d116:
L_c114:
    v_mfma_f32_16x16x32_bf16 v[30:33], v[110:113], v[94:97], v[30:33]
    ds_read_b128 v[126:129], v0 offset:0
    v_mfma_f32_16x16x32_bf16 v[34:37], v[110:113], v[98:101], v[34:37]
    ds_read_b64_tr_b16 v[142:143], v18 offset:8192
    v_mfma_f32_16x16x32_bf16 v[38:41], v[110:113], v[102:105], v[38:41]
    ds_read_b64_tr_b16 v[144:145], v18 offset:9216
    v_mfma_f32_16x16x32_bf16 v[42:45], v[110:113], v[106:109], v[42:45]
    ds_read_b128 v[130:133], v0 offset:1024
    v_mfma_f32_16x16x32_bf16 v[46:49], v[114:117], v[94:97], v[46:49]
    ds_read_b64_tr_b16 v[146:147], v19 offset:8192
    v_mfma_f32_16x16x32_bf16 v[50:53], v[114:117], v[98:101], v[50:53]
    ds_read_b64_tr_b16 v[148:149], v19 offset:9216
    v_mfma_f32_16x16x32_bf16 v[54:57], v[114:117], v[102:105], v[54:57]
    ds_read_b128 v[134:137], v0 offset:2048
    v_mfma_f32_16x16x32_bf16 v[58:61], v[114:117], v[106:109], v[58:61]
    ds_read_b64_tr_b16 v[150:151], v22 offset:8192
    v_mfma_f32_16x16x32_bf16 v[62:65], v[118:121], v[94:97], v[62:65]
    ds_read_b64_tr_b16 v[152:153], v22 offset:9216
    v_mfma_f32_16x16x32_bf16 v[66:69], v[118:121], v[98:101], v[66:69]
    ds_read_b128 v[138:141], v0 offset:3072
    v_mfma_f32_16x16x32_bf16 v[70:73], v[118:121], v[102:105], v[70:73]
    ds_read_b64_tr_b16 v[154:155], v23 offset:8192
    v_mfma_f32_16x16x32_bf16 v[74:77], v[118:121], v[106:109], v[74:77]
    ds_read_b64_tr_b16 v[156:157], v23 offset:9216
    v_mfma_f32_16x16x32_bf16 v[78:81], v[122:125], v[94:97], v[78:81]
    v_add_u32_dpp v5, v13, v9 quad_perm:[2,2,2,2] row_mask:0xf bank_mask:0xf
    s_add_u32 m0, s31, 16384
    s_nop 0
    buffer_load_dwordx4 v5, s[8:11], 0 offen lds
    s_waitcnt vmcnt(5) lgkmcnt(0)
    s_mov_b64 exec, 1
    ds_add_u32 v28, v29 offset:20
    s_mov_b64 exec, -1
    s_mov_b64 exec, 1
    ds_add_u32 v28, v4 offset:12
    s_mov_b64 exec, -1
    v_mfma_f32_16x16x32_bf16 v[82:85], v[122:125], v[98:101], v[82:85]
    v_add_u32_dpp v5, v161, v9 quad_perm:[2,2,2,2] row_mask:0xf bank_mask:0xf
    s_add_u32 m0, s31, 17408
    s_nop 0
    buffer_load_dwordx4 v5, s[8:11], 0 offen lds
    v_mfma_f32_16x16x32_bf16 v[86:89], v[122:125], v[102:105], v[86:89]
    s_add_u32 m0, s31, 24576
    s_mov_b32 s30, 1011712
    buffer_load_dwordx4 v6, s[12:15], s30 offen lds
    ds_read_b32 v2, v28 offset:20
    v_mfma_f32_16x16x32_bf16 v[90:93], v[122:125], v[106:109], v[90:93]
    s_add_u32 m0, s31, 25600
    s_mov_b32 s30, 1018368
    buffer_load_dwordx4 v6, s[12:15], s30 offen lds
    s_waitcnt lgkmcnt(0)
    v_readfirstlane_b32 s61, v2
    s_nop 0
    s_cmp_ge_u32 s61, 68
    s_cbranch_scc1 L_c117
    s_mov_b32 s60, 1048576
L_w118:
    ds_read_b32 v2, v28 offset:20
    s_waitcnt lgkmcnt(0)
    v_readfirstlane_b32 s61, v2
    s_nop 0
    s_cmp_ge_u32 s61, 68
    s_cbranch_scc1 L_d119
    s_sub_u32 s60, s60, 1
    s_cbranch_scc1 L_d119
    s_branch L_w118
L_d119:
L_c117:
    v_mfma_f32_16x16x32_bf16 v[30:33], v[142:145], v[126:129], v[30:33]
    ds_read_b128 v[94:97], v8 offset:32768
    v_mfma_f32_16x16x32_bf16 v[34:37], v[142:145], v[130:133], v[34:37]
    ds_read_b64_tr_b16 v[110:111], v24 offset:40960
    v_mfma_f32_16x16x32_bf16 v[38:41], v[142:145], v[134:137], v[38:41]
    ds_read_b64_tr_b16 v[112:113], v24 offset:41984
    v_mfma_f32_16x16x32_bf16 v[42:45], v[142:145], v[138:141], v[42:45]
    ds_read_b128 v[98:101], v8 offset:33792
    v_mfma_f32_16x16x32_bf16 v[46:49], v[146:149], v[126:129], v[46:49]
    ds_read_b64_tr_b16 v[114:115], v25 offset:40960
    v_mfma_f32_16x16x32_bf16 v[50:53], v[146:149], v[130:133], v[50:53]
    ds_read_b64_tr_b16 v[116:117], v25 offset:41984
    v_mfma_f32_16x16x32_bf16 v[54:57], v[146:149], v[134:137], v[54:57]
    ds_read_b128 v[102:105], v8 offset:34816
    v_mfma_f32_16x16x32_bf16 v[58:61], v[146:149], v[138:141], v[58:61]
    ds_read_b64_tr_b16 v[118:119], v26 offset:40960
    v_mfma_f32_16x16x32_bf16 v[62:65], v[150:153], v[126:129], v[62:65]
    ds_read_b64_tr_b16 v[120:121], v26 offset:41984
    v_mfma_f32_16x16x32_bf16 v[66:69], v[150:153], v[130:133], v[66:69]
    ds_read_b128 v[106:109], v8 offset:35840
    v_mfma_f32_16x16x32_bf16 v[70:73], v[150:153], v[134:137], v[70:73]
    ds_read_b64_tr_b16 v[122:123], v27 offset:40960
    v_mfma_f32_16x16x32_bf16 v[74:77], v[150:153], v[138:141], v[74:77]
    ds_read_b64_tr_b16 v[124:125], v27 offset:41984
    v_mfma_f32_16x16x32_bf16 v[78:81], v[154:157], v[126:129], v[78:81]
    v_add_u32_dpp v5, v14, v9 quad_perm:[2,2,2,2] row_mask:0xf bank_mask:0xf
    s_add_u32 m0, s31, 65536
    s_nop 0
    buffer_load_dwordx4 v5, s[8:11], 0 offen lds
    s_waitcnt vmcnt(11) lgkmcnt(0)
    s_mov_b64 exec, 1
    ds_add_u32 v28, v29 offset:20
    s_mov_b64 exec, -1
    v_mfma_f32_16x16x32_bf16 v[82:85], v[154:157], v[130:133], v[82:85]
    v_add_u32_dpp v5, v162, v9 quad_perm:[2,2,2,2] row_mask:0xf bank_mask:0xf
    s_add_u32 m0, s31, 66560
    s_nop 0
    buffer_load_dwordx4 v5, s[8:11], 0 offen lds
    v_mfma_f32_16x16x32_bf16 v[86:89], v[154:157], v[134:137], v[86:89]
    s_add_u32 m0, s31, 73728
    s_mov_b32 s30, 1064960
    buffer_load_dwordx4 v6, s[12:15], s30 offen lds
    ds_read_b32 v2, v28 offset:20
    v_mfma_f32_16x16x32_bf16 v[90:93], v[154:157], v[138:141], v[90:93]
    s_add_u32 m0, s31, 74752
    s_mov_b32 s30, 1071616
    buffer_load_dwordx4 v6, s[12:15], s30 offen lds
    s_waitcnt lgkmcnt(0)
    v_readfirstlane_b32 s61, v2
    s_nop 0
    s_cmp_ge_u32 s61, 72
    s_cbranch_scc1 L_c120
    s_mov_b32 s60, 1048576
L_w121:
    ds_read_b32 v2, v28 offset:20
    s_waitcnt lgkmcnt(0)
    v_readfirstlane_b32 s61, v2
    s_nop 0
    s_cmp_ge_u32 s61, 72
    s_cbranch_scc1 L_d122
    s_sub_u32 s60, s60, 1
    s_cbranch_scc1 L_d122
    s_branch L_w121
L_d122:
L_c120:
    v_mfma_f32_16x16x32_bf16 v[30:33], v[110:113], v[94:97], v[30:33]
    ds_read_b128 v[126:129], v8 offset:49152
    v_mfma_f32_16x16x32_bf16 v[34:37], v[110:113], v[98:101], v[34:37]
    ds_read_b64_tr_b16 v[142:143], v24 offset:57344
    v_mfma_f32_16x16x32_bf16 v[38:41], v[110:113], v[102:105], v[38:41]
    ds_read_b64_tr_b16 v[144:145], v24 offset:58368
    v_mfma_f32_16x16x32_bf16 v[42:45], v[110:113], v[106:109], v[42:45]
    ds_read_b128 v[130:133], v8 offset:50176
    v_mfma_f32_16x16x32_bf16 v[46:49], v[114:117], v[94:97], v[46:49]
    ds_read_b64_tr_b16 v[146:147], v25 offset:57344
    v_mfma_f32_16x16x32_bf16 v[50:53], v[114:117], v[98:101], v[50:53]
    ds_read_b64_tr_b16 v[148:149], v25 offset:58368
    v_mfma_f32_16x16x32_bf16 v[54:57], v[114:117], v[102:105], v[54:57]
    ds_read_b128 v[134:137], v8 offset:51200
    v_mfma_f32_16x16x32_bf16 v[58:61], v[114:117], v[106:109], v[58:61]
    ds_read_b64_tr_b16 v[150:151], v26 offset:57344
    v_mfma_f32_16x16x32_bf16 v[62:65], v[118:121], v[94:97], v[62:65]
    ds_read_b64_tr_b16 v[152:153], v26 offset:58368
    v_mfma_f32_16x16x32_bf16 v[66:69], v[118:121], v[98:101], v[66:69]
    ds_read_b128 v[138:141], v8 offset:52224
    v_mfma_f32_16x16x32_bf16 v[70:73], v[118:121], v[102:105], v[70:73]
    ds_read_b64_tr_b16 v[154:155], v27 offset:57344
    v_mfma_f32_16x16x32_bf16 v[74:77], v[118:121], v[106:109], v[74:77]
    ds_read_b64_tr_b16 v[156:157], v27 offset:58368
    v_mfma_f32_16x16x32_bf16 v[78:81], v[122:125], v[94:97], v[78:81]
    v_add_u32_dpp v5, v15, v9 quad_perm:[2,2,2,2] row_mask:0xf bank_mask:0xf
    s_add_u32 m0, s31, 32768
    s_nop 0
    buffer_load_dwordx4 v5, s[8:11], 0 offen lds
    s_waitcnt vmcnt(9) lgkmcnt(0)
    s_mov_b64 exec, 1
    ds_add_u32 v28, v29 offset:20
    s_mov_b64 exec, -1
    v_mfma_f32_16x16x32_bf16 v[82:85], v[122:125], v[98:101], v[82:85]
    v_add_u32_dpp v5, v163, v9 quad_perm:[2,2,2,2] row_mask:0xf bank_mask:0xf
    s_add_u32 m0, s31, 33792
    s_nop 0
    buffer_load_dwordx4 v5, s[8:11], 0 offen lds
    v_mfma_f32_16x16x32_bf16 v[86:89], v[122:125], v[102:105], v[86:89]
    s_add_u32 m0, s31, 40960
    s_mov_b32 s30, 1118208
    buffer_load_dwordx4 v6, s[12:15], s30 offen lds
    ds_read_b32 v2, v28 offset:20
    v_mfma_f32_16x16x32_bf16 v[90:93], v[122:125], v[106:109], v[90:93]
    s_add_u32 m0, s31, 41984
    s_mov_b32 s30, 1124864
    buffer_load_dwordx4 v6, s[12:15], s30 offen lds
    s_waitcnt lgkmcnt(0)
    v_readfirstlane_b32 s61, v2
    s_nop 0
    s_cmp_ge_u32 s61, 76
    s_cbranch_scc1 L_c123
    s_mov_b32 s60, 1048576
L_w124:
    ds_read_b32 v2, v28 offset:20
    s_waitcnt lgkmcnt(0)
    v_readfirstlane_b32 s61, v2
    s_nop 0
    s_cmp_ge_u32 s61, 76
    s_cbranch_scc1 L_d125
    s_sub_u32 s60, s60, 1
    s_cbranch_scc1 L_d125
    s_branch L_w124
L_d125:
L_c123:
    v_mfma_f32_16x16x32_bf16 v[30:33], v[142:145], v[126:129], v[30:33]
    ds_read_b128 v[94:97], v8 offset:0
    v_mfma_f32_16x16x32_bf16 v[34:37], v[142:145], v[130:133], v[34:37]
    ds_read_b64_tr_b16 v[110:111], v24 offset:8192
    v_mfma_f32_16x16x32_bf16 v[38:41], v[142:145], v[134:137], v[38:41]
    ds_read_b64_tr_b16 v[112:113], v24 offset:9216
    v_mfma_f32_16x16x32_bf16 v[42:45], v[142:145], v[138:141], v[42:45]
    ds_read_b128 v[98:101], v8 offset:1024
    v_mfma_f32_16x16x32_bf16 v[46:49], v[146:149], v[126:129], v[46:49]
    ds_read_b64_tr_b16 v[114:115], v25 offset:8192
    v_mfma_f32_16x16x32_bf16 v[50:53], v[146:149], v[130:133], v[50:53]
    ds_read_b64_tr_b16 v[116:117], v25 offset:9216
    v_mfma_f32_16x16x32_bf16 v[54:57], v[146:149], v[134:137], v[54:57]
    ds_read_b128 v[102:105], v8 offset:2048
    v_mfma_f32_16x16x32_bf16 v[58:61], v[146:149], v[138:141], v[58:61]
    ds_read_b64_tr_b16 v[118:119], v26 offset:8192
    v_mfma_f32_16x16x32_bf16 v[62:65], v[150:153], v[126:129], v[62:65]
    ds_read_b64_tr_b16 v[120:121], v26 offset:9216
    v_mfma_f32_16x16x32_bf16 v[66:69], v[150:153], v[130:133], v[66:69]
    ds_read_b128 v[106:109], v8 offset:3072
    v_mfma_f32_16x16x32_bf16 v[70:73], v[150:153], v[134:137], v[70:73]
    ds_read_b64_tr_b16 v[122:123], v27 offset:8192
    v_mfma_f32_16x16x32_bf16 v[74:77], v[150:153], v[138:141], v[74:77]
    ds_read_b64_tr_b16 v[124:125], v27 offset:9216
    v_mfma_f32_16x16x32_bf16 v[78:81], v[154:157], v[126:129], v[78:81]
    v_add_u32_dpp v5, v16, v9 quad_perm:[2,2,2,2] row_mask:0xf bank_mask:0xf
    s_add_u32 m0, s31, 49152
    s_nop 0
    buffer_load_dwordx4 v5, s[8:11], 0 offen lds
    s_waitcnt vmcnt(9) lgkmcnt(0)
    s_mov_b64 exec, 1
    ds_add_u32 v28, v29 offset:20
    s_mov_b64 exec, -1
    v_mfma_f32_16x16x32_bf16 v[82:85], v[154:157], v[130:133], v[82:85]
    v_add_u32_dpp v5, v164, v9 quad_perm:[2,2,2,2] row_mask:0xf bank_mask:0xf
    s_add_u32 m0, s31, 50176
    s_nop 0
    buffer_load_dwordx4 v5, s[8:11], 0 offen lds
    v_mfma_f32_16x16x32_bf16 v[86:89], v[154:157], v[134:137], v[86:89]
    s_add_u32 m0, s31, 57344
    s_mov_b32 s30, 1171456
    buffer_load_dwordx4 v6, s[12:15], s30 offen lds
    ds_read_b32 v2, v28 offset:20
    v_mfma_f32_16x16x32_bf16 v[90:93], v[154:157], v[138:141], v[90:93]
    s_add_u32 m0, s31, 58368
    s_mov_b32 s30, 1178112
    buffer_load_dwordx4 v6, s[12:15], s30 offen lds
    s_waitcnt lgkmcnt(0)
    v_readfirstlane_b32 s61, v2
    s_nop 0
    s_cmp_ge_u32 s61, 80
    s_cbranch_scc1 L_c126
    s_mov_b32 s60, 1048576
L_w127:
    ds_read_b32 v2, v28 offset:20
    s_waitcnt lgkmcnt(0)
    v_readfirstlane_b32 s61, v2
    s_nop 0
    s_cmp_ge_u32 s61, 80
    s_cbranch_scc1 L_d128
    s_sub_u32 s60, s60, 1
    s_cbranch_scc1 L_d128
    s_branch L_w127
L_d128:
L_c126:
    v_mfma_f32_16x16x32_bf16 v[30:33], v[110:113], v[94:97], v[30:33]
    ds_read_b128 v[126:129], v8 offset:16384
    v_mfma_f32_16x16x32_bf16 v[34:37], v[110:113], v[98:101], v[34:37]
    ds_read_b64_tr_b16 v[142:143], v24 offset:24576
    v_mfma_f32_16x16x32_bf16 v[38:41], v[110:113], v[102:105], v[38:41]
    ds_read_b64_tr_b16 v[144:145], v24 offset:25600
    v_mfma_f32_16x16x32_bf16 v[42:45], v[110:113], v[106:109], v[42:45]
    ds_read_b128 v[130:133], v8 offset:17408
    v_mfma_f32_16x16x32_bf16 v[46:49], v[114:117], v[94:97], v[46:49]
    ds_read_b64_tr_b16 v[146:147], v25 offset:24576
    v_mfma_f32_16x16x32_bf16 v[50:53], v[114:117], v[98:101], v[50:53]
    ds_read_b64_tr_b16 v[148:149], v25 offset:25600
    v_mfma_f32_16x16x32_bf16 v[54:57], v[114:117], v[102:105], v[54:57]
    ds_read_b128 v[134:137], v8 offset:18432
    v_mfma_f32_16x16x32_bf16 v[58:61], v[114:117], v[106:109], v[58:61]
    ds_read_b64_tr_b16 v[150:151], v26 offset:24576
    v_mfma_f32_16x16x32_bf16 v[62:65], v[118:121], v[94:97], v[62:65]
    ds_read_b64_tr_b16 v[152:153], v26 offset:25600
    v_mfma_f32_16x16x32_bf16 v[66:69], v[118:121], v[98:101], v[66:69]
    ds_read_b128 v[138:141], v8 offset:19456
    v_mfma_f32_16x16x32_bf16 v[70:73], v[118:121], v[102:105], v[70:73]
    ds_read_b64_tr_b16 v[154:155], v27 offset:24576
    v_mfma_f32_16x16x32_bf16 v[74:77], v[118:121], v[106:109], v[74:77]
    ds_read_b64_tr_b16 v[156:157], v27 offset:25600
    v_mfma_f32_16x16x32_bf16 v[78:81], v[122:125], v[94:97], v[78:81]
    v_add_u32_dpp v5, v17, v9 quad_perm:[2,2,2,2] row_mask:0xf bank_mask:0xf
    s_add_u32 m0, s31, 0
    s_nop 0
    buffer_load_dwordx4 v5, s[8:11], 0 offen lds
    s_waitcnt vmcnt(9) lgkmcnt(0)
    s_mov_b64 exec, 1
    ds_add_u32 v28, v29 offset:20
    s_mov_b64 exec, -1
    v_mfma_f32_16x16x32_bf16 v[82:85], v[122:125], v[98:101], v[82:85]
    v_add_u32_dpp v5, v165, v9 quad_perm:[2,2,2,2] row_mask:0xf bank_mask:0xf
    s_add_u32 m0, s31, 1024
    s_nop 0
    buffer_load_dwordx4 v5, s[8:11], 0 offen lds
    v_mfma_f32_16x16x32_bf16 v[86:89], v[122:125], v[102:105], v[86:89]
    s_add_u32 m0, s31, 8192
    s_mov_b32 s30, 1224704
    buffer_load_dwordx4 v6, s[12:15], s30 offen lds
    ds_read_b32 v2, v28 offset:20
    v_mfma_f32_16x16x32_bf16 v[90:93], v[122:125], v[106:109], v[90:93]
    s_add_u32 m0, s31, 9216
    s_mov_b32 s30, 1231360
    buffer_load_dwordx4 v6, s[12:15], s30 offen lds
    s_waitcnt lgkmcnt(0)
    v_readfirstlane_b32 s61, v2
    s_nop 0
    s_cmp_ge_u32 s61, 84
    s_cbranch_scc1 L_c129
    s_mov_b32 s60, 1048576
L_w130:
    ds_read_b32 v2, v28 offset:20
    s_waitcnt lgkmcnt(0)
    v_readfirstlane_b32 s61, v2
    s_nop 0
    s_cmp_ge_u32 s61, 84
    s_cbranch_scc1 L_d131
    s_sub_u32 s60, s60, 1
    s_cbranch_scc1 L_d131
    s_branch L_w130
L_d131:
L_c129:
    v_mfma_f32_16x16x32_bf16 v[30:33], v[142:145], v[126:129], v[30:33]
    ds_read_b128 v[94:97], v0 offset:0
    v_mfma_f32_16x16x32_bf16 v[34:37], v[142:145], v[130:133], v[34:37]
    ds_read_b64_tr_b16 v[110:111], v18 offset:8192
    v_mfma_f32_16x16x32_bf16 v[38:41], v[142:145], v[134:137], v[38:41]
    ds_read_b64_tr_b16 v[112:113], v18 offset:9216
    v_mfma_f32_16x16x32_bf16 v[42:45], v[142:145], v[138:141], v[42:45]
    ds_read_b128 v[98:101], v0 offset:1024
    v_mfma_f32_16x16x32_bf16 v[46:49], v[146:149], v[126:129], v[46:49]
    ds_read_b64_tr_b16 v[114:115], v19 offset:8192
    v_mfma_f32_16x16x32_bf16 v[50:53], v[146:149], v[130:133], v[50:53]
    ds_read_b64_tr_b16 v[116:117], v19 offset:9216
    v_mfma_f32_16x16x32_bf16 v[54:57], v[146:149], v[134:137], v[54:57]
    ds_read_b128 v[102:105], v0 offset:2048
    v_mfma_f32_16x16x32_bf16 v[58:61], v[146:149], v[138:141], v[58:61]
    ds_read_b64_tr_b16 v[118:119], v22 offset:8192
    v_mfma_f32_16x16x32_bf16 v[62:65], v[150:153], v[126:129], v[62:65]
    ds_read_b64_tr_b16 v[120:121], v22 offset:9216
    v_mfma_f32_16x16x32_bf16 v[66:69], v[150:153], v[130:133], v[66:69]
    ds_read_b128 v[106:109], v0 offset:3072
    v_mfma_f32_16x16x32_bf16 v[70:73], v[150:153], v[134:137], v[70:73]
    ds_read_b64_tr_b16 v[122:123], v23 offset:8192
    v_mfma_f32_16x16x32_bf16 v[74:77], v[150:153], v[138:141], v[74:77]
    ds_read_b64_tr_b16 v[124:125], v23 offset:9216
    v_mfma_f32_16x16x32_bf16 v[78:81], v[154:157], v[126:129], v[78:81]
    v_add_u32_dpp v5, v10, v9 quad_perm:[3,3,3,3] row_mask:0xf bank_mask:0xf
    s_add_u32 m0, s31, 16384
    s_nop 0
    buffer_load_dwordx4 v5, s[8:11], 0 offen lds
    s_waitcnt vmcnt(9) lgkmcnt(0)
    s_mov_b64 exec, 1
    ds_add_u32 v28, v29 offset:20
    s_mov_b64 exec, -1
    v_mfma_f32_16x16x32_bf16 v[82:85], v[154:157], v[130:133], v[82:85]
    v_add_u32_dpp v5, v158, v9 quad_perm:[3,3,3,3] row_mask:0xf bank_mask:0xf
    s_add_u32 m0, s31, 17408
    s_nop 0
    buffer_load_dwordx4 v5, s[8:11], 0 offen lds
    v_mfma_f32_16x16x32_bf16 v[86:89], v[154:157], v[134:137], v[86:89]
    s_add_u32 m0, s31, 24576
    s_mov_b32 s30, 1277952
    buffer_load_dwordx4 v6, s[12:15], s30 offen lds
    ds_read_b32 v2, v28 offset:20
    v_mfma_f32_16x16x32_bf16 v[90:93], v[154:157], v[138:141], v[90:93]
    s_add_u32 m0, s31, 25600
    s_mov_b32 s30, 1284608
    buffer_load_dwordx4 v6, s[12:15], s30 offen lds
    s_waitcnt lgkmcnt(0)
    v_readfirstlane_b32 s61, v2
    s_nop 0
    s_cmp_ge_u32 s61, 88
    s_cbranch_scc1 L_c132
    s_mov_b32 s60, 1048576
L_w133:
    ds_read_b32 v2, v28 offset:20
    s_waitcnt lgkmcnt(0)
    v_readfirstlane_b32 s61, v2
    s_nop 0
    s_cmp_ge_u32 s61, 88
    s_cbranch_scc1 L_d134
    s_sub_u32 s60, s60, 1
    s_cbranch_scc1 L_d134
    s_branch L_w133
L_d134:
L_c132:
    v_mfma_f32_16x16x32_bf16 v[30:33], v[110:113], v[94:97], v[30:33]
    ds_read_b128 v[126:129], v8 offset:32768
    v_mfma_f32_16x16x32_bf16 v[34:37], v[110:113], v[98:101], v[34:37]
    ds_read_b64_tr_b16 v[142:143], v24 offset:40960
    v_mfma_f32_16x16x32_bf16 v[38:41], v[110:113], v[102:105], v[38:41]
    ds_read_b64_tr_b16 v[144:145], v24 offset:41984
    v_mfma_f32_16x16x32_bf16 v[42:45], v[110:113], v[106:109], v[42:45]
    ds_read_b128 v[130:133], v8 offset:33792
    v_mfma_f32_16x16x32_bf16 v[46:49], v[114:117], v[94:97], v[46:49]
    ds_read_b64_tr_b16 v[146:147], v25 offset:40960
    v_mfma_f32_16x16x32_bf16 v[50:53], v[114:117], v[98:101], v[50:53]
    ds_read_b64_tr_b16 v[148:149], v25 offset:41984
    v_mfma_f32_16x16x32_bf16 v[54:57], v[114:117], v[102:105], v[54:57]
    ds_read_b128 v[134:137], v8 offset:34816
    v_mfma_f32_16x16x32_bf16 v[58:61], v[114:117], v[106:109], v[58:61]
    ds_read_b64_tr_b16 v[150:151], v26 offset:40960
    v_mfma_f32_16x16x32_bf16 v[62:65], v[118:121], v[94:97], v[62:65]
    ds_read_b64_tr_b16 v[152:153], v26 offset:41984
    v_mfma_f32_16x16x32_bf16 v[66:69], v[118:121], v[98:101], v[66:69]
    ds_read_b128 v[138:141], v8 offset:35840
    v_mfma_f32_16x16x32_bf16 v[70:73], v[118:121], v[102:105], v[70:73]
    ds_read_b64_tr_b16 v[154:155], v27 offset:40960
    v_mfma_f32_16x16x32_bf16 v[74:77], v[118:121], v[106:109], v[74:77]
    ds_read_b64_tr_b16 v[156:157], v27 offset:41984
    v_mfma_f32_16x16x32_bf16 v[78:81], v[122:125], v[94:97], v[78:81]
    v_add_u32_dpp v5, v11, v9 quad_perm:[3,3,3,3] row_mask:0xf bank_mask:0xf
    s_add_u32 m0, s31, 65536
    s_nop 0
    buffer_load_dwordx4 v5, s[8:11], 0 offen lds
    s_waitcnt vmcnt(9) lgkmcnt(0)
    s_mov_b64 exec, 1
    ds_add_u32 v28, v29 offset:20
    s_mov_b64 exec, -1
    v_mfma_f32_16x16x32_bf16 v[82:85], v[122:125], v[98:101], v[82:85]
    v_add_u32_dpp v5, v159, v9 quad_perm:[3,3,3,3] row_mask:0xf bank_mask:0xf
    s_add_u32 m0, s31, 66560
    s_nop 0
    buffer_load_dwordx4 v5, s[8:11], 0 offen lds
    v_mfma_f32_16x16x32_bf16 v[86:89], v[122:125], v[102:105], v[86:89]
    s_add_u32 m0, s31, 73728
    s_mov_b32 s30, 1331200
    buffer_load_dwordx4 v6, s[12:15], s30 offen lds
    ds_read_b32 v2, v28 offset:20
    v_mfma_f32_16x16x32_bf16 v[90:93], v[122:125], v[106:109], v[90:93]
    s_add_u32 m0, s31, 74752
    s_mov_b32 s30, 1337856
    buffer_load_dwordx4 v6, s[12:15], s30 offen lds
    s_waitcnt lgkmcnt(0)
    v_readfirstlane_b32 s61, v2
    s_nop 0
    s_cmp_ge_u32 s61, 92
    s_cbranch_scc1 L_c135
    s_mov_b32 s60, 1048576
L_w136:
    ds_read_b32 v2, v28 offset:20
    s_waitcnt lgkmcnt(0)
    v_readfirstlane_b32 s61, v2
    s_nop 0
    s_cmp_ge_u32 s61, 92
    s_cbranch_scc1 L_d137
    s_sub_u32 s60, s60, 1
    s_cbranch_scc1 L_d137
    s_branch L_w136
L_d137:
L_c135:
    s_cmp_lg_u32 s3, 0
    s_cbranch_scc1 L_f138
    buffer_load_ubyte v21, v1, s[36:39], 0 offen sc0 sc1
L_f138:
    v_mfma_f32_16x16x32_bf16 v[30:33], v[142:145], v[126:129], v[30:33]
    ds_read_b128 v[94:97], v8 offset:49152
    v_mfma_f32_16x16x32_bf16 v[34:37], v[142:145], v[130:133], v[34:37]
    ds_read_b64_tr_b16 v[110:111], v24 offset:57344
    v_mfma_f32_16x16x32_bf16 v[38:41], v[142:145], v[134:137], v[38:41]
    ds_read_b64_tr_b16 v[112:113], v24 offset:58368
    v_mfma_f32_16x16x32_bf16 v[42:45], v[142:145], v[138:141], v[42:45]
    ds_read_b128 v[98:101], v8 offset:50176
    v_mfma_f32_16x16x32_bf16 v[46:49], v[146:149], v[126:129], v[46:49]
    ds_read_b64_tr_b16 v[114:115], v25 offset:57344
    v_mfma_f32_16x16x32_bf16 v[50:53], v[146:149], v[130:133], v[50:53]
    ds_read_b64_tr_b16 v[116:117], v25 offset:58368
    v_mfma_f32_16x16x32_bf16 v[54:57], v[146:149], v[134:137], v[54:57]
    ds_read_b128 v[102:105], v8 offset:51200
    v_mfma_f32_16x16x32_bf16 v[58:61], v[146:149], v[138:141], v[58:61]
    ds_read_b64_tr_b16 v[118:119], v26 offset:57344
    v_mfma_f32_16x16x32_bf16 v[62:65], v[150:153], v[126:129], v[62:65]
    ds_read_b64_tr_b16 v[120:121], v26 offset:58368
    v_mfma_f32_16x16x32_bf16 v[66:69], v[150:153], v[130:133], v[66:69]
    ds_read_b128 v[106:109], v8 offset:52224
    v_mfma_f32_16x16x32_bf16 v[70:73], v[150:153], v[134:137], v[70:73]
    ds_read_b64_tr_b16 v[122:123], v27 offset:57344
    v_mfma_f32_16x16x32_bf16 v[74:77], v[150:153], v[138:141], v[74:77]
    ds_read_b64_tr_b16 v[124:125], v27 offset:58368
    v_mfma_f32_16x16x32_bf16 v[78:81], v[154:157], v[126:129], v[78:81]
    s_waitcnt vmcnt(8) lgkmcnt(0)
    s_mov_b64 exec, 1
    ds_add_u32 v28, v29 offset:20
    s_mov_b64 exec, -1
    v_mfma_f32_16x16x32_bf16 v[82:85], v[154:157], v[130:133], v[82:85]
    v_mfma_f32_16x16x32_bf16 v[86:89], v[154:157], v[134:137], v[86:89]
    ds_read_b32 v2, v28 offset:20
    v_mfma_f32_16x16x32_bf16 v[90:93], v[154:157], v[138:141], v[90:93]
    s_waitcnt lgkmcnt(0)
    v_readfirstlane_b32 s61, v2
    s_nop 0
    s_cmp_ge_u32 s61, 96
    s_cbranch_scc1 L_c139
    s_mov_b32 s60, 1048576
L_w140:
    ds_read_b32 v2, v28 offset:20
    s_waitcnt lgkmcnt(0)
    v_readfirstlane_b32 s61, v2
    s_nop 0
    s_cmp_ge_u32 s61, 96
    s_cbranch_scc1 L_d141
    s_sub_u32 s60, s60, 1
    s_cbranch_scc1 L_d141
    s_branch L_w140
L_d141:
L_c139:
    v_mfma_f32_16x16x32_bf16 v[30:33], v[110:113], v[94:97], v[30:33]
    ds_read_b128 v[126:129], v8 offset:0
    v_mfma_f32_16x16x32_bf16 v[34:37], v[110:113], v[98:101], v[34:37]
    ds_read_b64_tr_b16 v[142:143], v24 offset:8192
    v_mfma_f32_16x16x32_bf16 v[38:41], v[110:113], v[102:105], v[38:41]
    ds_read_b64_tr_b16 v[144:145], v24 offset:9216
    v_mfma_f32_16x16x32_bf16 v[42:45], v[110:113], v[106:109], v[42:45]
    ds_read_b128 v[130:133], v8 offset:1024
    v_mfma_f32_16x16x32_bf16 v[46:49], v[114:117], v[94:97], v[46:49]
    ds_read_b64_tr_b16 v[146:147], v25 offset:8192
    v_mfma_f32_16x16x32_bf16 v[50:53], v[114:117], v[98:101], v[50:53]
    ds_read_b64_tr_b16 v[148:149], v25 offset:9216
    v_mfma_f32_16x16x32_bf16 v[54:57], v[114:117], v[102:105], v[54:57]
    ds_read_b128 v[134:137], v8 offset:2048
    v_mfma_f32_16x16x32_bf16 v[58:61], v[114:117], v[106:109], v[58:61]
    ds_read_b64_tr_b16 v[150:151], v26 offset:8192
    v_mfma_f32_16x16x32_bf16 v[62:65], v[118:121], v[94:97], v[62:65]
    ds_read_b64_tr_b16 v[152:153], v26 offset:9216
    v_mfma_f32_16x16x32_bf16 v[66:69], v[118:121], v[98:101], v[66:69]
    ds_read_b128 v[138:141], v8 offset:3072
    v_mfma_f32_16x16x32_bf16 v[70:73], v[118:121], v[102:105], v[70:73]
    ds_read_b64_tr_b16 v[154:155], v27 offset:8192
    v_mfma_f32_16x16x32_bf16 v[74:77], v[118:121], v[106:109], v[74:77]
    ds_read_b64_tr_b16 v[156:157], v27 offset:9216
    v_mfma_f32_16x16x32_bf16 v[78:81], v[122:125], v[94:97], v[78:81]
    s_waitcnt vmcnt(4) lgkmcnt(0)
    s_mov_b64 exec, 1
    ds_add_u32 v28, v29 offset:20
    s_mov_b64 exec, -1
    v_mfma_f32_16x16x32_bf16 v[82:85], v[122:125], v[98:101], v[82:85]
    v_mfma_f32_16x16x32_bf16 v[86:89], v[122:125], v[102:105], v[86:89]
    ds_read_b32 v2, v28 offset:20
    v_mfma_f32_16x16x32_bf16 v[90:93], v[122:125], v[106:109], v[90:93]
    s_waitcnt lgkmcnt(0)
    v_readfirstlane_b32 s61, v2
    s_nop 0
    s_cmp_ge_u32 s61, 100
    s_cbranch_scc1 L_c142
    s_mov_b32 s60, 1048576
L_w143:
    ds_read_b32 v2, v28 offset:20
    s_waitcnt lgkmcnt(0)
    v_readfirstlane_b32 s61, v2
    s_nop 0
    s_cmp_ge_u32 s61, 100
    s_cbranch_scc1 L_d144
    s_sub_u32 s60, s60, 1
    s_cbranch_scc1 L_d144
    s_branch L_w143
L_d144:
L_c142:
    v_mfma_f32_16x16x32_bf16 v[30:33], v[142:145], v[126:129], v[30:33]
    ds_read_b128 v[94:97], v8 offset:16384
    v_mfma_f32_16x16x32_bf16 v[34:37], v[142:145], v[130:133], v[34:37]
    ds_read_b64_tr_b16 v[110:111], v24 offset:24576
    v_mfma_f32_16x16x32_bf16 v[38:41], v[142:145], v[134:137], v[38:41]
    ds_read_b64_tr_b16 v[112:113], v24 offset:25600
    v_mfma_f32_16x16x32_bf16 v[42:45], v[142:145], v[138:141], v[42:45]
    ds_read_b128 v[98:101], v8 offset:17408
    v_mfma_f32_16x16x32_bf16 v[46:49], v[146:149], v[126:129], v[46:49]
    ds_read_b64_tr_b16 v[114:115], v25 offset:24576
    v_mfma_f32_16x16x32_bf16 v[50:53], v[146:149], v[130:133], v[50:53]
    ds_read_b64_tr_b16 v[116:117], v25 offset:25600
    v_mfma_f32_16x16x32_bf16 v[54:57], v[146:149], v[134:137], v[54:57]
    ds_read_b128 v[102:105], v8 offset:18432
    v_mfma_f32_16x16x32_bf16 v[58:61], v[146:149], v[138:141], v[58:61]
    ds_read_b64_tr_b16 v[118:119], v26 offset:24576
    v_mfma_f32_16x16x32_bf16 v[62:65], v[150:153], v[126:129], v[62:65]
    ds_read_b64_tr_b16 v[120:121], v26 offset:25600
    v_mfma_f32_16x16x32_bf16 v[66:69], v[150:153], v[130:133], v[66:69]
    ds_read_b128 v[106:109], v8 offset:19456
    v_mfma_f32_16x16x32_bf16 v[70:73], v[150:153], v[134:137], v[70:73]
    ds_read_b64_tr_b16 v[122:123], v27 offset:24576
    v_mfma_f32_16x16x32_bf16 v[74:77], v[150:153], v[138:141], v[74:77]
    ds_read_b64_tr_b16 v[124:125], v27 offset:25600
    v_mfma_f32_16x16x32_bf16 v[78:81], v[154:157], v[126:129], v[78:81]
    s_waitcnt vmcnt(0) lgkmcnt(0)
    s_mov_b64 exec, 1
    ds_add_u32 v28, v29 offset:20
    s_mov_b64 exec, -1
    v_mfma_f32_16x16x32_bf16 v[82:85], v[154:157], v[130:133], v[82:85]
    v_mfma_f32_16x16x32_bf16 v[86:89], v[154:157], v[134:137], v[86:89]
    ds_read_b32 v2, v28 offset:20
    v_mfma_f32_16x16x32_bf16 v[90:93], v[154:157], v[138:141], v[90:93]
    s_waitcnt lgkmcnt(0)
    v_readfirstlane_b32 s61, v2
    s_nop 0
    s_cmp_ge_u32 s61, 104
    s_cbranch_scc1 L_c145
    s_mov_b32 s60, 1048576
L_w146:
    ds_read_b32 v2, v28 offset:20
    s_waitcnt lgkmcnt(0)
    v_readfirstlane_b32 s61, v2
    s_nop 0
    s_cmp_ge_u32 s61, 104
    s_cbranch_scc1 L_d147
    s_sub_u32 s60, s60, 1
    s_cbranch_scc1 L_d147
    s_branch L_w146
L_d147:
L_c145:
    v_mfma_f32_16x16x32_bf16 v[30:33], v[110:113], v[94:97], v[30:33]
    ds_read_b128 v[126:129], v0 offset:0
    v_mfma_f32_16x16x32_bf16 v[34:37], v[110:113], v[98:101], v[34:37]
    ds_read_b64_tr_b16 v[142:143], v18 offset:8192
    v_mfma_f32_16x16x32_bf16 v[38:41], v[110:113], v[102:105], v[38:41]
    ds_read_b64_tr_b16 v[144:145], v18 offset:9216
    v_mfma_f32_16x16x32_bf16 v[42:45], v[110:113], v[106:109], v[42:45]
    ds_read_b128 v[130:133], v0 offset:1024
    v_mfma_f32_16x16x32_bf16 v[46:49], v[114:117], v[94:97], v[46:49]
    ds_read_b64_tr_b16 v[146:147], v19 offset:8192
    v_mfma_f32_16x16x32_bf16 v[50:53], v[114:117], v[98:101], v[50:53]
    ds_read_b64_tr_b16 v[148:149], v19 offset:9216
    v_mfma_f32_16x16x32_bf16 v[54:57], v[114:117], v[102:105], v[54:57]
    ds_read_b128 v[134:137], v0 offset:2048
    v_mfma_f32_16x16x32_bf16 v[58:61], v[114:117], v[106:109], v[58:61]
    ds_read_b64_tr_b16 v[150:151], v22 offset:8192
    v_mfma_f32_16x16x32_bf16 v[62:65], v[118:121], v[94:97], v[62:65]
    ds_read_b64_tr_b16 v[152:153], v22 offset:9216
    v_mfma_f32_16x16x32_bf16 v[66:69], v[118:121], v[98:101], v[66:69]
    ds_read_b128 v[138:141], v0 offset:3072
    v_mfma_f32_16x16x32_bf16 v[70:73], v[118:121], v[102:105], v[70:73]
    ds_read_b64_tr_b16 v[154:155], v23 offset:8192
    v_mfma_f32_16x16x32_bf16 v[74:77], v[118:121], v[106:109], v[74:77]
    ds_read_b64_tr_b16 v[156:157], v23 offset:9216
    v_mfma_f32_16x16x32_bf16 v[78:81], v[122:125], v[94:97], v[78:81]
    s_waitcnt vmcnt(0) lgkmcnt(0)
    s_cmp_lg_u32 s3, 0
    s_cbranch_scc1 L_f148
    s_waitcnt vmcnt(0)
    v_cmp_eq_u32 vcc, 1, v21
    s_nop 0
    s_and_b32 s61, vcc_lo, 0xffffffe0
    s_cmp_eq_u32 s61, 0xffffffe0
    s_cbranch_scc1 L_d149
    s_mov_b32 s60, 1048576
L_p150:
    buffer_load_ubyte v21, v1, s[36:39], 0 offen sc0 sc1
    s_waitcnt vmcnt(0)
    v_cmp_eq_u32 vcc, 1, v21
    s_nop 0
    s_and_b32 s61, vcc_lo, 0xffffffe0
    s_cmp_eq_u32 s61, 0xffffffe0
    s_cbranch_scc1 L_d151
    s_sub_u32 s60, s60, 1
    s_cbranch_scc1 L_d151
    s_sleep 4
    s_branch L_p150
L_d151:
L_d149:
L_f148:
    s_mov_b64 exec, 1
    ds_add_u32 v28, v29 offset:20
    s_mov_b64 exec, -1
    v_mfma_f32_16x16x32_bf16 v[82:85], v[122:125], v[98:101], v[82:85]
    v_mfma_f32_16x16x32_bf16 v[86:89], v[122:125], v[102:105], v[86:89]
    ds_read_b32 v2, v28 offset:20
    v_mfma_f32_16x16x32_bf16 v[90:93], v[122:125], v[106:109], v[90:93]
    v_mfma_f32_16x16x32_bf16 v[30:33], v[142:145], v[126:129], v[30:33]
    v_mfma_f32_16x16x32_bf16 v[34:37], v[142:145], v[130:133], v[34:37]
    v_mfma_f32_16x16x32_bf16 v[38:41], v[142:145], v[134:137], v[38:41]
    v_mfma_f32_16x16x32_bf16 v[42:45], v[142:145], v[138:141], v[42:45]
    v_mfma_f32_16x16x32_bf16 v[46:49], v[146:149], v[126:129], v[46:49]
    v_mfma_f32_16x16x32_bf16 v[50:53], v[146:149], v[130:133], v[50:53]
    v_mfma_f32_16x16x32_bf16 v[54:57], v[146:149], v[134:137], v[54:57]
    v_mfma_f32_16x16x32_bf16 v[58:61], v[146:149], v[138:141], v[58:61]
    v_mfma_f32_16x16x32_bf16 v[62:65], v[150:153], v[126:129], v[62:65]
    v_mfma_f32_16x16x32_bf16 v[66:69], v[150:153], v[130:133], v[66:69]
    v_mfma_f32_16x16x32_bf16 v[70:73], v[150:153], v[134:137], v[70:73]
    v_mfma_f32_16x16x32_bf16 v[74:77], v[150:153], v[138:141], v[74:77]
    s_waitcnt lgkmcnt(0)
    v_readfirstlane_b32 s61, v2
    s_nop 0
    s_cmp_ge_u32 s61, 108
    s_cbranch_scc1 L_c152
    s_mov_b32 s60, 1048576
L_w153:
    ds_read_b32 v2, v28 offset:20
    s_waitcnt lgkmcnt(0)
    v_readfirstlane_b32 s61, v2
    s_nop 0
    s_cmp_ge_u32 s61, 108
    s_cbranch_scc1 L_d154
    s_sub_u32 s60, s60, 1
    s_cbranch_scc1 L_d154
    s_branch L_w153
L_d154:
L_c152:
    s_add_u32 s45, s44, 0
    s_add_u32 m0, s45, 0
    s_nop 0
    buffer_load_dwordx4 v20, s[52:55], s45 offen sc1 lds
    v_mfma_f32_16x16x32_bf16 v[78:81], v[154:157], v[126:129], v[78:81]
    s_add_u32 s45, s44, 4096
    s_add_u32 m0, s45, 0
    s_nop 0
    buffer_load_dwordx4 v20, s[52:55], s45 offen sc1 lds
    v_mfma_f32_16x16x32_bf16 v[82:85], v[154:157], v[130:133], v[82:85]
    s_add_u32 s45, s44, 8192
    s_add_u32 m0, s45, 0
    s_nop 0
    buffer_load_dwordx4 v20, s[52:55], s45 offen sc1 lds
    v_mfma_f32_16x16x32_bf16 v[86:89], v[154:157], v[134:137], v[86:89]
    s_add_u32 s45, s44, 12288
    s_add_u32 m0, s45, 0
    s_nop 0
    buffer_load_dwordx4 v20, s[52:55], s45 offen sc1 lds
    v_mfma_f32_16x16x32_bf16 v[90:93], v[154:157], v[138:141], v[90:93]
    s_add_u32 s45, s44, 16384
    s_add_u32 m0, s45, 0
    s_nop 0
    buffer_load_dwordx4 v20, s[52:55], s45 offen sc1 lds
    s_add_u32 s45, s44, 20480
    s_add_u32 m0, s45, 0
    s_nop 0
    buffer_load_dwordx4 v20, s[52:55], s45 offen sc1 lds
    s_add_u32 s45, s44, 24576
    s_add_u32 m0, s45, 0
    s_nop 0
    buffer_load_dwordx4 v20, s[52:55], s45 offen sc1 lds
    s_add_u32 s45, s44, 28672
    s_add_u32 m0, s45, 0
    s_nop 0
    buffer_load_dwordx4 v20, s[52:55], s45 offen sc1 lds
    s_add_u32 s45, s44, 32768
    s_add_u32 m0, s45, 0
    s_nop 0
    buffer_load_dwordx4 v20, s[52:55], s45 offen sc1 lds
    s_add_u32 s45, s44, 36864
    s_add_u32 m0, s45, 0
    s_nop 0
    buffer_load_dwordx4 v20, s[52:55], s45 offen sc1 lds
    s_add_u32 s45, s44, 40960
    s_add_u32 m0, s45, 0
    s_nop 0
    buffer_load_dwordx4 v20, s[52:55], s45 offen sc1 lds
    s_add_u32 s45, s44, 45056
    s_add_u32 m0, s45, 0
    s_nop 0
    buffer_load_dwordx4 v20, s[52:55], s45 offen sc1 lds
    s_add_u32 s45, s44, 49152
    s_add_u32 m0, s45, 0
    s_nop 0
    buffer_load_dwordx4 v20, s[52:55], s45 offen sc1 lds
    s_add_u32 s45, s44, 53248
    s_add_u32 m0, s45, 0
    s_nop 0
    buffer_load_dwordx4 v20, s[52:55], s45 offen sc1 lds
    s_add_u32 s45, s44, 57344
    s_min_u32 s45, s45, 58368
    s_add_u32 m0, s45, 0
    s_nop 0
    buffer_load_dwordx4 v20, s[52:55], s45 offen sc1 lds
    s_waitcnt vmcnt(0)
    s_mov_b64 exec, 1
    ds_add_u32 v28, v4 offset:16
    s_mov_b64 exec, -1
    s_setprio 0
    v_mov_b32 v8, 0xc0135761
    s_mov_b32 s30, 0xbdd2d3e8
    ds_read_b128 v[94:97], v7 offset:512
    ds_read_b128 v[98:101], v7 offset:576
    ds_read_b128 v[102:105], v7 offset:640
    ds_read_b128 v[106:109], v7 offset:704
    s_waitcnt lgkmcnt(0)
    v_mov_b32 v9, v8
    s_mov_b32 s31, s30
    v_mov_b32 v112, 0
    v_mov_b32 v113, 0
    v_mov_b32 v114, 0
    v_mov_b32 v115, 0
    v_mov_b32 v116, 0
    v_mov_b32 v117, 0
    v_mov_b32 v118, 0
    v_mov_b32 v119, 0
    v_mul_f32 v10, v30, v30
    v_mul_f32 v11, v34, v34
    v_mul_f32 v12, v38, v38
    v_mul_f32 v13, v42, v42
    v_fma_f32 v10, v10, s30, v8
    v_fma_f32 v11, v11, s30, v8
    v_fma_f32 v12, v12, s30, v8
    v_fma_f32 v13, v13, s30, v8
    v_mul_f32 v10, v10, v30
    v_mul_f32 v11, v11, v34
    v_mul_f32 v12, v12, v38
    v_mul_f32 v13, v13, v42
    v_exp_f32 v10, v10
    v_exp_f32 v11, v11
    v_exp_f32 v12, v12
    v_exp_f32 v13, v13
    v_mul_f32 v30, v30, v94
    v_mul_f32 v34, v34, v94
    v_mul_f32 v38, v38, v94
    v_mul_f32 v42, v42, v94
    v_add_f32 v10, 1.0, v10
    v_add_f32 v11, 1.0, v11
    v_add_f32 v12, 1.0, v12
    v_add_f32 v13, 1.0, v13
    v_rcp_f32 v10, v10
    v_rcp_f32 v11, v11
    v_rcp_f32 v12, v12
    v_rcp_f32 v13, v13
    v_mul_f32 v16, v30, v10
    v_mul_f32 v17, v34, v11
    v_mul_f32 v18, v38, v12
    v_mul_f32 v19, v42, v13
    v_mul_f32 v10, v31, v31
    v_mul_f32 v11, v35, v35
    v_mul_f32 v12, v39, v39
    v_mul_f32 v13, v43, v43
    v_fma_f32 v10, v10, s30, v8
    v_fma_f32 v11, v11, s30, v8
    v_fma_f32 v12, v12, s30, v8
    v_fma_f32 v13, v13, s30, v8
    v_mul_f32 v10, v10, v31
    v_mul_f32 v11, v11, v35
    v_mul_f32 v12, v12, v39
    v_mul_f32 v13, v13, v43
    v_exp_f32 v10, v10
    v_exp_f32 v11, v11
    v_exp_f32 v12, v12
    v_exp_f32 v13, v13
    v_mul_f32 v31, v31, v95
    v_mul_f32 v35, v35, v95
    v_mul_f32 v39, v39, v95
    v_mul_f32 v43, v43, v95
    v_add_f32 v10, 1.0, v10
    v_add_f32 v11, 1.0, v11
    v_add_f32 v12, 1.0, v12
    v_add_f32 v13, 1.0, v13
    v_rcp_f32 v10, v10
    v_rcp_f32 v11, v11
    v_rcp_f32 v12, v12
    v_rcp_f32 v13, v13
    v_fmac_f32 v16, v31, v10
    v_fmac_f32 v17, v35, v11
    v_fmac_f32 v18, v39, v12
    v_fmac_f32 v19, v43, v13
    v_mul_f32 v10, v32, v32
    v_mul_f32 v11, v36, v36
    v_mul_f32 v12, v40, v40
    v_mul_f32 v13, v44, v44
    v_fma_f32 v10, v10, s30, v8
    v_fma_f32 v11, v11, s30, v8
    v_fma_f32 v12, v12, s30, v8
    v_fma_f32 v13, v13, s30, v8
    v_mul_f32 v10, v10, v32
    v_mul_f32 v11, v11, v36
    v_mul_f32 v12, v12, v40
    v_mul_f32 v13, v13, v44
    v_exp_f32 v10, v10
    v_exp_f32 v11, v11
    v_exp_f32 v12, v12
    v_exp_f32 v13, v13
    v_mul_f32 v32, v32, v96
    v_mul_f32 v36, v36, v96
    v_mul_f32 v40, v40, v96
    v_mul_f32 v44, v44, v96
    v_add_f32 v10, 1.0, v10
    v_add_f32 v11, 1.0, v11
    v_add_f32 v12, 1.0, v12
    v_add_f32 v13, 1.0, v13
    v_rcp_f32 v10, v10
    v_rcp_f32 v11, v11
    v_rcp_f32 v12, v12
    v_rcp_f32 v13, v13
    v_fmac_f32 v16, v32, v10
    v_fmac_f32 v17, v36, v11
    v_fmac_f32 v18, v40, v12
    v_fmac_f32 v19, v44, v13
    v_mul_f32 v10, v33, v33
    v_mul_f32 v11, v37, v37
    v_mul_f32 v12, v41, v41
    v_mul_f32 v13, v45, v45
    v_fma_f32 v10, v10, s30, v8
    v_fma_f32 v11, v11, s30, v8
    v_fma_f32 v12, v12, s30, v8
    v_fma_f32 v13, v13, s30, v8
    v_mul_f32 v10, v10, v33
    v_mul_f32 v11, v11, v37
    v_mul_f32 v12, v12, v41
    v_mul_f32 v13, v13, v45
    v_exp_f32 v10, v10
    v_exp_f32 v11, v11
    v_exp_f32 v12, v12
    v_exp_f32 v13, v13
    v_mul_f32 v33, v33, v97
    v_mul_f32 v37, v37, v97
    v_mul_f32 v41, v41, v97
    v_mul_f32 v45, v45, v97
    v_add_f32 v10, 1.0, v10
    v_add_f32 v11, 1.0, v11
    v_add_f32 v12, 1.0, v12
    v_add_f32 v13, 1.0, v13
    v_rcp_f32 v10, v10
    v_rcp_f32 v11, v11
    v_rcp_f32 v12, v12
    v_rcp_f32 v13, v13
    v_fmac_f32 v16, v33, v10
    v_fmac_f32 v17, v37, v11
    v_fmac_f32 v18, v41, v12
    v_fmac_f32 v19, v45, v13
    s_setprio 3
    v_pk_mul_f32 v[120:121], v[46:47], v[46:47]
    v_pk_mul_f32 v[122:123], v[50:51], v[50:51]
    v_pk_mul_f32 v[124:125], v[54:55], v[54:55]
    v_pk_mul_f32 v[126:127], v[58:59], v[58:59]
    v_pk_fma_f32 v[120:121], v[120:121], s[30:31], v[8:9]
    v_pk_fma_f32 v[122:123], v[122:123], s[30:31], v[8:9]
    v_pk_fma_f32 v[124:125], v[124:125], s[30:31], v[8:9]
    v_pk_fma_f32 v[126:127], v[126:127], s[30:31], v[8:9]
    v_pk_mul_f32 v[120:121], v[120:121], v[46:47]
    v_pk_mul_f32 v[122:123], v[122:123], v[50:51]
    v_pk_mul_f32 v[124:125], v[124:125], v[54:55]
    v_pk_mul_f32 v[126:127], v[126:127], v[58:59]
    v_pk_mul_f32 v[46:47], v[46:47], v[98:99]
    v_pk_mul_f32 v[50:51], v[50:51], v[98:99]
    v_pk_mul_f32 v[54:55], v[54:55], v[98:99]
    v_pk_mul_f32 v[58:59], v[58:59], v[98:99]
    v_exp_f32 v120, v120
    v_exp_f32 v121, v121
    v_exp_f32 v122, v122
    v_exp_f32 v123, v123
    v_exp_f32 v124, v124
    v_exp_f32 v125, v125
    v_exp_f32 v126, v126
    v_exp_f32 v127, v127
    v_pk_add_f32 v[120:121], v[120:121], 1.0 op_sel_hi:[1,0]
    v_pk_add_f32 v[122:123], v[122:123], 1.0 op_sel_hi:[1,0]
    v_pk_add_f32 v[124:125], v[124:125], 1.0 op_sel_hi:[1,0]
    v_pk_add_f32 v[126:127], v[126:127], 1.0 op_sel_hi:[1,0]
    v_rcp_f32 v120, v120
    v_rcp_f32 v121, v121
    v_rcp_f32 v122, v122
    v_rcp_f32 v123, v123
    v_rcp_f32 v124, v124
    v_rcp_f32 v125, v125
    v_rcp_f32 v126, v126
    v_rcp_f32 v127, v127
    v_pk_fma_f32 v[112:113], v[46:47], v[120:121], v[112:113]
    v_pk_fma_f32 v[114:115], v[50:51], v[122:123], v[114:115]
    v_pk_fma_f32 v[116:117], v[54:55], v[124:125], v[116:117]
    v_pk_fma_f32 v[118:119], v[58:59], v[126:127], v[118:119]
    v_pk_mul_f32 v[120:121], v[48:49], v[48:49]
    v_pk_mul_f32 v[122:123], v[52:53], v[52:53]
    v_pk_mul_f32 v[124:125], v[56:57], v[56:57]
    v_pk_mul_f32 v[126:127], v[60:61], v[60:61]
    v_pk_fma_f32 v[120:121], v[120:121], s[30:31], v[8:9]
    v_pk_fma_f32 v[122:123], v[122:123], s[30:31], v[8:9]
    v_pk_fma_f32 v[124:125], v[124:125], s[30:31], v[8:9]
    v_pk_fma_f32 v[126:127], v[126:127], s[30:31], v[8:9]
    v_pk_mul_f32 v[120:121], v[120:121], v[48:49]
    v_pk_mul_f32 v[122:123], v[122:123], v[52:53]
    v_pk_mul_f32 v[124:125], v[124:125], v[56:57]
    v_pk_mul_f32 v[126:127], v[126:127], v[60:61]
    v_pk_mul_f32 v[48:49], v[48:49], v[100:101]
    v_pk_mul_f32 v[52:53], v[52:53], v[100:101]
    v_pk_mul_f32 v[56:57], v[56:57], v[100:101]
    v_pk_mul_f32 v[60:61], v[60:61], v[100:101]
    v_exp_f32 v120, v120
    v_exp_f32 v121, v121
    v_exp_f32 v122, v122
    v_exp_f32 v123, v123
    v_exp_f32 v124, v124
    v_exp_f32 v125, v125
    v_exp_f32 v126, v126
    v_exp_f32 v127, v127
    v_pk_add_f32 v[120:121], v[120:121], 1.0 op_sel_hi:[1,0]
    v_pk_add_f32 v[122:123], v[122:123], 1.0 op_sel_hi:[1,0]
    v_pk_add_f32 v[124:125], v[124:125], 1.0 op_sel_hi:[1,0]
    v_pk_add_f32 v[126:127], v[126:127], 1.0 op_sel_hi:[1,0]
    v_rcp_f32 v120, v120
    v_rcp_f32 v121, v121
    v_rcp_f32 v122, v122
    v_rcp_f32 v123, v123
    v_rcp_f32 v124, v124
    v_rcp_f32 v125, v125
    v_rcp_f32 v126, v126
    v_rcp_f32 v127, v127
    v_pk_fma_f32 v[112:113], v[48:49], v[120:121], v[112:113]
    v_pk_fma_f32 v[114:115], v[52:53], v[122:123], v[114:115]
    v_pk_fma_f32 v[116:117], v[56:57], v[124:125], v[116:117]
    v_pk_fma_f32 v[118:119], v[60:61], v[126:127], v[118:119]
    v_pk_mul_f32 v[120:121], v[62:63], v[62:63]
    v_pk_mul_f32 v[122:123], v[66:67], v[66:67]
    v_pk_mul_f32 v[124:125], v[70:71], v[70:71]
    v_pk_mul_f32 v[126:127], v[74:75], v[74:75]
    v_pk_fma_f32 v[120:121], v[120:121], s[30:31], v[8:9]
    v_pk_fma_f32 v[122:123], v[122:123], s[30:31], v[8:9]
    v_pk_fma_f32 v[124:125], v[124:125], s[30:31], v[8:9]
    v_pk_fma_f32 v[126:127], v[126:127], s[30:31], v[8:9]
    v_pk_mul_f32 v[120:121], v[120:121], v[62:63]
    v_pk_mul_f32 v[122:123], v[122:123], v[66:67]
    v_pk_mul_f32 v[124:125], v[124:125], v[70:71]
    v_pk_mul_f32 v[126:127], v[126:127], v[74:75]
    v_pk_mul_f32 v[62:63], v[62:63], v[102:103]
    v_pk_mul_f32 v[66:67], v[66:67], v[102:103]
    v_pk_mul_f32 v[70:71], v[70:71], v[102:103]
    v_pk_mul_f32 v[74:75], v[74:75], v[102:103]
    v_exp_f32 v120, v120
    v_exp_f32 v121, v121
    v_exp_f32 v122, v122
    v_exp_f32 v123, v123
    v_exp_f32 v124, v124
    v_exp_f32 v125, v125
    v_exp_f32 v126, v126
    v_exp_f32 v127, v127
    v_pk_add_f32 v[120:121], v[120:121], 1.0 op_sel_hi:[1,0]
    v_pk_add_f32 v[122:123], v[122:123], 1.0 op_sel_hi:[1,0]
    v_pk_add_f32 v[124:125], v[124:125], 1.0 op_sel_hi:[1,0]
    v_pk_add_f32 v[126:127], v[126:127], 1.0 op_sel_hi:[1,0]
    v_rcp_f32 v120, v120
    v_rcp_f32 v121, v121
    v_rcp_f32 v122, v122
    v_rcp_f32 v123, v123
    v_rcp_f32 v124, v124
    v_rcp_f32 v125, v125
    v_rcp_f32 v126, v126
    v_rcp_f32 v127, v127
    v_pk_fma_f32 v[112:113], v[62:63], v[120:121], v[112:113]
    v_pk_fma_f32 v[114:115], v[66:67], v[122:123], v[114:115]
    v_pk_fma_f32 v[116:117], v[70:71], v[124:125], v[116:117]
    v_pk_fma_f32 v[118:119], v[74:75], v[126:127], v[118:119]
    v_pk_mul_f32 v[120:121], v[64:65], v[64:65]
    v_pk_mul_f32 v[122:123], v[68:69], v[68:69]
    v_pk_mul_f32 v[124:125], v[72:73], v[72:73]
    v_pk_mul_f32 v[126:127], v[76:77], v[76:77]
    v_pk_fma_f32 v[120:121], v[120:121], s[30:31], v[8:9]
    v_pk_fma_f32 v[122:123], v[122:123], s[30:31], v[8:9]
    v_pk_fma_f32 v[124:125], v[124:125], s[30:31], v[8:9]
    v_pk_fma_f32 v[126:127], v[126:127], s[30:31], v[8:9]
    v_pk_mul_f32 v[120:121], v[120:121], v[64:65]
    v_pk_mul_f32 v[122:123], v[122:123], v[68:69]
    v_pk_mul_f32 v[124:125], v[124:125], v[72:73]
    v_pk_mul_f32 v[126:127], v[126:127], v[76:77]
    v_pk_mul_f32 v[64:65], v[64:65], v[104:105]
    v_pk_mul_f32 v[68:69], v[68:69], v[104:105]
    v_pk_mul_f32 v[72:73], v[72:73], v[104:105]
    v_pk_mul_f32 v[76:77], v[76:77], v[104:105]
    v_exp_f32 v120, v120
    v_exp_f32 v121, v121
    v_exp_f32 v122, v122
    v_exp_f32 v123, v123
    v_exp_f32 v124, v124
    v_exp_f32 v125, v125
    v_exp_f32 v126, v126
    v_exp_f32 v127, v127
    v_pk_add_f32 v[120:121], v[120:121], 1.0 op_sel_hi:[1,0]
    v_pk_add_f32 v[122:123], v[122:123], 1.0 op_sel_hi:[1,0]
    v_pk_add_f32 v[124:125], v[124:125], 1.0 op_sel_hi:[1,0]
    v_pk_add_f32 v[126:127], v[126:127], 1.0 op_sel_hi:[1,0]
    v_rcp_f32 v120, v120
    v_rcp_f32 v121, v121
    v_rcp_f32 v122, v122
    v_rcp_f32 v123, v123
    v_rcp_f32 v124, v124
    v_rcp_f32 v125, v125
    v_rcp_f32 v126, v126
    v_rcp_f32 v127, v127
    v_pk_fma_f32 v[112:113], v[64:65], v[120:121], v[112:113]
    v_pk_fma_f32 v[114:115], v[68:69], v[122:123], v[114:115]
    v_pk_fma_f32 v[116:117], v[72:73], v[124:125], v[116:117]
    v_pk_fma_f32 v[118:119], v[76:77], v[126:127], v[118:119]
    v_pk_mul_f32 v[120:121], v[78:79], v[78:79]
    v_pk_mul_f32 v[122:123], v[82:83], v[82:83]
    v_pk_mul_f32 v[124:125], v[86:87], v[86:87]
    v_pk_mul_f32 v[126:127], v[90:91], v[90:91]
    v_pk_fma_f32 v[120:121], v[120:121], s[30:31], v[8:9]
    v_pk_fma_f32 v[122:123], v[122:123], s[30:31], v[8:9]
    v_pk_fma_f32 v[124:125], v[124:125], s[30:31], v[8:9]
    v_pk_fma_f32 v[126:127], v[126:127], s[30:31], v[8:9]
    v_pk_mul_f32 v[120:121], v[120:121], v[78:79]
    v_pk_mul_f32 v[122:123], v[122:123], v[82:83]
    v_pk_mul_f32 v[124:125], v[124:125], v[86:87]
    v_pk_mul_f32 v[126:127], v[126:127], v[90:91]
    v_pk_mul_f32 v[78:79], v[78:79], v[106:107]
    v_pk_mul_f32 v[82:83], v[82:83], v[106:107]
    v_pk_mul_f32 v[86:87], v[86:87], v[106:107]
    v_pk_mul_f32 v[90:91], v[90:91], v[106:107]
    v_exp_f32 v120, v120
    v_exp_f32 v121, v121
    v_exp_f32 v122, v122
    v_exp_f32 v123, v123
    v_exp_f32 v124, v124
    v_exp_f32 v125, v125
    v_exp_f32 v126, v126
    v_exp_f32 v127, v127
    v_pk_add_f32 v[120:121], v[120:121], 1.0 op_sel_hi:[1,0]
    v_pk_add_f32 v[122:123], v[122:123], 1.0 op_sel_hi:[1,0]
    v_pk_add_f32 v[124:125], v[124:125], 1.0 op_sel_hi:[1,0]
    v_pk_add_f32 v[126:127], v[126:127], 1.0 op_sel_hi:[1,0]
    v_rcp_f32 v120, v120
    v_rcp_f32 v121, v121
    v_rcp_f32 v122, v122
    v_rcp_f32 v123, v123
    v_rcp_f32 v124, v124
    v_rcp_f32 v125, v125
    v_rcp_f32 v126, v126
    v_rcp_f32 v127, v127
    v_pk_fma_f32 v[112:113], v[78:79], v[120:121], v[112:113]
    v_pk_fma_f32 v[114:115], v[82:83], v[122:123], v[114:115]
    v_pk_fma_f32 v[116:117], v[86:87], v[124:125], v[116:117]
    v_pk_fma_f32 v[118:119], v[90:91], v[126:127], v[118:119]
    v_pk_mul_f32 v[120:121], v[80:81], v[80:81]
    v_pk_mul_f32 v[122:123], v[84:85], v[84:85]
    v_pk_mul_f32 v[124:125], v[88:89], v[88:89]
    v_pk_mul_f32 v[126:127], v[92:93], v[92:93]
    v_pk_fma_f32 v[120:121], v[120:121], s[30:31], v[8:9]
    v_pk_fma_f32 v[122:123], v[122:123], s[30:31], v[8:9]
    v_pk_fma_f32 v[124:125], v[124:125], s[30:31], v[8:9]
    v_pk_fma_f32 v[126:127], v[126:127], s[30:31], v[8:9]
    v_pk_mul_f32 v[120:121], v[120:121], v[80:81]
    v_pk_mul_f32 v[122:123], v[122:123], v[84:85]
    v_pk_mul_f32 v[124:125], v[124:125], v[88:89]
    v_pk_mul_f32 v[126:127], v[126:127], v[92:93]
    v_pk_mul_f32 v[80:81], v[80:81], v[108:109]
    v_pk_mul_f32 v[84:85], v[84:85], v[108:109]
    v_pk_mul_f32 v[88:89], v[88:89], v[108:109]
    v_pk_mul_f32 v[92:93], v[92:93], v[108:109]
    v_exp_f32 v120, v120
    v_exp_f32 v121, v121
    v_exp_f32 v122, v122
    v_exp_f32 v123, v123
    v_exp_f32 v124, v124
    v_exp_f32 v125, v125
    v_exp_f32 v126, v126
    v_exp_f32 v127, v127
    v_pk_add_f32 v[120:121], v[120:121], 1.0 op_sel_hi:[1,0]
    v_pk_add_f32 v[122:123], v[122:123], 1.0 op_sel_hi:[1,0]
    v_pk_add_f32 v[124:125], v[124:125], 1.0 op_sel_hi:[1,0]
    v_pk_add_f32 v[126:127], v[126:127], 1.0 op_sel_hi:[1,0]
    v_rcp_f32 v120, v120
    v_rcp_f32 v121, v121
    v_rcp_f32 v122, v122
    v_rcp_f32 v123, v123
    v_rcp_f32 v124, v124
    v_rcp_f32 v125, v125
    v_rcp_f32 v126, v126
    v_rcp_f32 v127, v127
    v_pk_fma_f32 v[112:113], v[80:81], v[120:121], v[112:113]
    v_pk_fma_f32 v[114:115], v[84:85], v[122:123], v[114:115]
    v_pk_fma_f32 v[116:117], v[88:89], v[124:125], v[116:117]
    v_pk_fma_f32 v[118:119], v[92:93], v[126:127], v[118:119]
    v_add_f32 v16, v16, v112
    v_add_f32 v17, v17, v114
    v_add_f32 v18, v18, v116
    v_add_f32 v19, v19, v118
    v_add_f32 v16, v16, v113
    v_add_f32 v17, v17, v115
    v_add_f32 v18, v18, v117
    v_add_f32 v19, v19, v119
    s_nop 0
    v_permlane32_swap_b32 v16, v18
    v_permlane32_swap_b32 v17, v19
    v_add_f32 v16, v16, v18
    v_add_f32 v17, v17, v19
    s_nop 1
    v_permlane16_swap_b32 v16, v17
    v_add_f32 v16, v16, v17
    s_add_u32 s20, s84, 0x40000
    s_addc_u32 s21, s85, 0
    s_mov_b32 s22, 0x38000
    s_mov_b32 s23, 0x20000
    s_mul_i32 s28, s4, 7
    s_add_u32 s28, s28, s35
    s_lshl_b32 s28, s28, 1
    s_add_u32 s28, s28, s33
    s_lshl_b32 s28, s28, 9
    s_lshl_b32 s29, s32, 8
    s_add_u32 s28, s28, s29
    v_lshlrev_b32 v4, 2, v1
    v_min_u32 v16, -2, v16
    buffer_store_dword v16, v4, s[20:23], s28 offen sc0 sc1
    s_cmp_lg_u32 s3, 0
    s_cbranch_scc1 L_dnn_end
L_collect:
    s_add_u32 s40, s84, 0x40000
    s_addc_u32 s41, s85, 0
    s_mov_b32 s42, 0x38000
    s_mov_b32 s43, 0x20000
    s_mov_b32 s48, s78
    s_mov_b32 s49, s79
    s_mov_b32 s50, 0x2
    s_mov_b32 s51, 0x20000
    s_mul_i32 s45, s4, 7168
    s_lshl_b32 s46, s5, 6
    s_add_u32 s45, s45, s46
    v_and_b32 v3, 15, v1
    v_lshlrev_b32 v3, 2, v3
    v_lshrrev_b32 v4, 4, v1
    v_lshl_add_u32 v3, v4, 9, v3
    v_add_u32 v5, 6144, v3
    v_mov_b32 v6, 0x7ffffff0
    v_cmp_gt_u32 vcc, 32, v1
    s_nop 1
    v_cndmask_b32 v5, v6, v5, vcc
    v_lshlrev_b32 v4, 4, v4
    v_mov_b32 v14, 0
    buffer_load_short_d16_hi v14, v4, s[48:51], 0 offen
    v_add_u32 v7, 4096, v3
    s_mov_b32 s60, 1048576
L_w155:
    ds_read_b32 v2, v28 offset:44
    s_waitcnt lgkmcnt(0)
    v_readfirstlane_b32 s61, v2
    s_nop 0
    s_cmp_ge_u32 s61, 1
    s_cbranch_scc1 L_d156
    s_sub_u32 s60, s60, 1
    s_cbranch_scc1 L_d156
    s_sleep 4
    s_branch L_w155
L_d156:
    s_mov_b32 s60, 1048576
L_cpoll:
    buffer_load_dword v10, v3, s[40:43], s45 offen sc0 sc1
    buffer_load_dword v11, v3, s[40:43], s45 offen offset:2048 sc0 sc1
    buffer_load_dword v12, v7, s[40:43], s45 offen sc0 sc1
    buffer_load_dword v13, v5, s[40:43], s45 offen sc0 sc1
    s_waitcnt vmcnt(0)
    v_max_u32 v15, v10, v11
    v_max3_u32 v15, v15, v12, v13
    v_cmp_eq_u32 vcc, -1, v15
    s_nop 4
    s_cbranch_vccz L_cdone
    s_sub_u32 s60, s60, 1
    s_cbranch_scc1 L_cdone
    s_sleep 2
    s_branch L_cpoll
L_cdone:
    v_lshlrev_b32 v3, 2, v1
    v_add_u32 v3, 162816, v3
    v_add_f32 v10, v10, v11
    v_add_f32 v12, v12, v13
    v_add_f32 v10, v10, v14
    v_add_f32 v10, v10, v12
    ds_write_b32 v3, v10
    s_waitcnt lgkmcnt(0)
    v_mov_b32 v4, 16
    s_mov_b64 exec, 1
    ds_add_u32 v28, v4 offset:24
    s_mov_b64 exec, -1
L_dnn_end:
    s_endpgm
.section .rodata,"a"
.p2align 6
.amdhsa_kernel standalone__deep_cross_xdeepfm__recsys_kernel
  .amdhsa_next_free_vgpr 168
  .amdhsa_next_free_sgpr 102
  .amdhsa_accum_offset 168
  .amdhsa_group_segment_fixed_size 0
  .amdhsa_kernarg_size 88
  .amdhsa_user_sgpr_count 2
  .amdhsa_user_sgpr_kernarg_segment_ptr 1
  .amdhsa_system_sgpr_workgroup_id_x 1
.end_amdhsa_kernel
```
